```python
import torch

def _softmax(x, axis=-1):
    return torch.softmax(x, dim=axis)
def _gelu(x):
    return torch.nn.functional.gelu(x, approximate="tanh")
def _silu(x):
    return torch.nn.functional.silu(x)
def _sigmoid(x):
    return torch.sigmoid(x)
def _layernorm(x, axis=-1, eps=1e-5):
    m = x.mean(dim=axis, keepdim=True)
    v = x.var(dim=axis, keepdim=True, unbiased=False)
    return (x - m) / torch.sqrt(v + eps)
def _scatter_add(tgt, idx, src, axis=0):
    return tgt.clone().index_add_(axis, idx, src)
def _segment_sum(src, seg, n):
    out = torch.zeros((n,) + src.shape[1:], dtype=src.dtype)
    return out.index_add_(0, seg, src)
def _pad(x, pw):
    flat = tuple(v for pair in reversed(pw) for v in pair)
    return torch.nn.functional.pad(x, flat)

kernel_name = 'interleave_layers__mha_block__glu_gated_glu__prompt'

def setup_inputs():

    _w = (lambda a: (lambda t: t.to(torch.bfloat16) if t.is_floating_point() else t)(torch.as_tensor(a)))
    def _A_setup():
        B, S, D, H = 1, 2048, 448, 16
        return {
            "x": _w((lambda *s: torch.randn(*s, dtype=torch.bfloat16) * 0.05)(B, S, D)),
            "wqkv": _w((lambda *s: torch.randn(*s, dtype=torch.bfloat16) * 0.05)(D, 3 * D)),
            "wo": _w((lambda *s: torch.randn(*s, dtype=torch.bfloat16) * 0.05)(D, D)),
        }
    _A_in = _A_setup()

    def _B_setup():
        B, S, D, F = 1, 2048, 448, 1792
        return {
            "x": _w((lambda *s: torch.randn(*s, dtype=torch.bfloat16) * 0.05)(B, S, D)),
            "w_gate": _w((lambda *s: torch.randn(*s, dtype=torch.bfloat16) * 0.05)(D, F)),
            "w_up": _w((lambda *s: torch.randn(*s, dtype=torch.bfloat16) * 0.05)(D, F)),
            "w_down": _w((lambda *s: torch.randn(*s, dtype=torch.bfloat16) * 0.05)(F, D)),
        }
    _B_in = _B_setup()

    return {
        "A_x": _A_in["x"],
        "A_wqkv": _A_in["wqkv"],
        "A_wo": _A_in["wo"],
        "B_x": _B_in["x"],
        "B_w_gate": _B_in["w_gate"],
        "B_w_up": _B_in["w_up"],
        "B_w_down": _B_in["w_down"],
    }

def reference(A_x, A_wqkv, A_wo, B_x, B_w_gate, B_w_up, B_w_down):
    def _A_ref(x, wqkv, wo):
        B, S, D = x.shape
        H = 16
        Dh = D // H
        qkv = (lambda x, *d: x.permute(*d))((x @ wqkv).reshape(B, S, 3, H, Dh), 2, 0, 3, 1, 4)
        q, k, v = qkv[0], qkv[1], qkv[2]
        scores = torch.einsum("bhqd,bhkd->bhqk", q, k) * (Dh ** -0.5)
        p = _softmax(scores, axis=-1)
        o = torch.einsum("bhqk,bhkd->bhqd", p, v)
        return (lambda x, *d: x.permute(*d))(o, 0, 2, 1, 3).reshape(B, S, D) @ wo

    def _B_ref(x, w_gate, w_up, w_down):
        g = torch.einsum("bsd,df->bsf", x, w_gate)
        u = torch.einsum("bsd,df->bsf", x, w_up)
        h = _sigmoid(g) * u
        return torch.einsum("bsf,fd->bsd", h, w_down)

    x = A_x
    x = x + _A_ref(_layernorm(x, axis=-1), A_wqkv, A_wo)
    x = x + _B_ref(_layernorm(x, axis=-1), B_w_gate, B_w_up, B_w_down)
    x = x + _A_ref(_layernorm(x, axis=-1), A_wqkv, A_wo)
    x = x + _B_ref(_layernorm(x, axis=-1), B_w_gate, B_w_up, B_w_down)
    return x
```

```asm
; @launch kernel=prep_kernel grid=(1751,1,1) block=(256,1,1) lds=8192
; @launch kernel=k1a_kernel grid=(192,1,1) block=(256,1,1) lds=117760
; @launch kernel=k2a_kernel grid=(512,1,1) block=(256,1,1) lds=33792
; @launch kernel=k3a_kernel grid=(224,1,1) block=(256,1,1) lds=65536
; @launch kernel=k4a_kernel grid=(224,1,1) block=(256,1,1) lds=117760
; @launch kernel=k5a_kernel grid=(224,1,1) block=(256,1,1) lds=65536
; @launch kernel=k1b_kernel grid=(192,1,1) block=(256,1,1) lds=117760
; @launch kernel=k2b_kernel grid=(512,1,1) block=(256,1,1) lds=33792
; @launch kernel=k3b_kernel grid=(224,1,1) block=(256,1,1) lds=65536
; @launch kernel=k4b_kernel grid=(224,1,1) block=(256,1,1) lds=117760
; @launch kernel=k5b_kernel grid=(224,1,1) block=(256,1,1) lds=65536
.amdgcn_target "amdgcn-amd-amdhsa--gfx950"
.text
.globl prep_kernel
.p2align 8
.type prep_kernel,@function
prep_kernel:
    s_cmp_ge_u32 s2, 1751
    s_cbranch_scc0 prep_kernel_go1
    s_endpgm
prep_kernel_go1:
    s_load_dwordx2 s[4:5], s[0:1], 72
    s_waitcnt lgkmcnt(0)
    s_cmp_ge_u32 s2, 336
    s_cbranch_scc1 prep_kernel_job2
    s_sub_u32 s20, s2, 0
    s_load_dwordx2 s[6:7], s[0:1], 8
    s_waitcnt lgkmcnt(0)
    s_mov_b32 s12, s6
    s_mov_b32 s13, s7
    s_mov_b32 s14, 1204224
    s_mov_b32 s15, 0x00020000
    s_mov_b32 s16, s4
    s_mov_b32 s17, s5
    s_mov_b32 s18, 1376256
    s_mov_b32 s19, 0x00020000
    v_lshrrev_b32 v1, 6, v0
    s_nop 0
    v_readfirstlane_b32 s30, v1
    s_lshl_b32 s31, s20, 2
    s_add_u32 s31, s31, s30
    s_mov_b32 s33, 153391690
    s_mul_hi_u32 s32, s31, s33
    s_mul_i32 s33, s32, 28
    s_sub_u32 s33, s31, s33
    v_and_b32 v1, 63, v0
    v_and_b32 v2, 31, v1
    v_lshrrev_b32 v3, 5, v1
    s_lshl_b32 s35, s33, 4
    v_lshlrev_b32 v5, 3, v3
    v_add_u32 v5, s35, v5
    s_mul_i32 s36, s32, 28
    v_add_u32 v6, s36, v2
    s_mov_b32 s37, 2688
    v_mul_lo_u32 v7, v5, s37
    v_lshlrev_b32 v6, 1, v6
    v_add_u32 v7, v7, v6
    v_cmp_gt_u32 vcc, 28, v2
    v_mov_b32 v8, 0x7fffff00
    s_nop 0
    v_cndmask_b32 v7, v8, v7, vcc
    s_mov_b32 s40, 0
    s_mov_b32 s41, 2688
    s_mov_b32 s42, 5376
    s_mov_b32 s43, 8064
    s_mov_b32 s44, 10752
    s_mov_b32 s45, 13440
    s_mov_b32 s46, 16128
    s_mov_b32 s47, 18816
    buffer_load_ushort v10, v7, s[12:15], s40 offen
    buffer_load_ushort v11, v7, s[12:15], s41 offen
    buffer_load_ushort v12, v7, s[12:15], s42 offen
    buffer_load_ushort v13, v7, s[12:15], s43 offen
    buffer_load_ushort v14, v7, s[12:15], s44 offen
    buffer_load_ushort v15, v7, s[12:15], s45 offen
    buffer_load_ushort v16, v7, s[12:15], s46 offen
    buffer_load_ushort v17, v7, s[12:15], s47 offen
    s_waitcnt vmcnt(6)
    v_lshl_or_b32 v20, v11, 16, v10
    s_waitcnt vmcnt(4)
    v_lshl_or_b32 v21, v13, 16, v12
    s_waitcnt vmcnt(2)
    v_lshl_or_b32 v22, v15, 16, v14
    s_waitcnt vmcnt(0)
    v_lshl_or_b32 v23, v17, 16, v16
    s_lshl_b32 s37, s31, 10
    v_lshlrev_b32 v8, 4, v1
    buffer_store_dwordx4 v[20:23], v8, s[16:19], s37 offen
    s_endpgm
prep_kernel_job2:
    s_cmp_ge_u32 s2, 434
    s_cbranch_scc1 prep_kernel_job3
    s_sub_u32 s20, s2, 336
    s_load_dwordx2 s[6:7], s[0:1], 16
    s_waitcnt lgkmcnt(0)
    s_mov_b32 s12, s6
    s_mov_b32 s13, s7
    s_mov_b32 s14, 401408
    s_mov_b32 s15, 0x00020000
    s_add_u32 s16, s4, 1441792
    s_addc_u32 s17, s5, 0
    s_mov_b32 s18, 401408
    s_mov_b32 s19, 0x00020000
    v_lshrrev_b32 v1, 6, v0
    s_nop 0
    v_readfirstlane_b32 s30, v1
    s_lshl_b32 s31, s20, 2
    s_add_u32 s31, s31, s30
    s_mov_b32 s33, 153391690
    s_mul_hi_u32 s32, s31, s33
    s_mul_i32 s33, s32, 28
    s_sub_u32 s33, s31, s33
    v_and_b32 v1, 63, v0
    v_and_b32 v2, 31, v1
    v_lshrrev_b32 v3, 5, v1
    s_lshl_b32 s35, s33, 4
    v_lshlrev_b32 v5, 3, v3
    v_add_u32 v5, s35, v5
    s_lshl_b32 s36, s32, 5
    v_add_u32 v6, s36, v2
    s_mov_b32 s37, 896
    v_mul_lo_u32 v7, v5, s37
    v_lshlrev_b32 v6, 1, v6
    v_add_u32 v7, v7, v6
    s_mov_b32 s40, 0
    s_mov_b32 s41, 896
    s_mov_b32 s42, 1792
    s_mov_b32 s43, 2688
    s_mov_b32 s44, 3584
    s_mov_b32 s45, 4480
    s_mov_b32 s46, 5376
    s_mov_b32 s47, 6272
    buffer_load_ushort v10, v7, s[12:15], s40 offen
    buffer_load_ushort v11, v7, s[12:15], s41 offen
    buffer_load_ushort v12, v7, s[12:15], s42 offen
    buffer_load_ushort v13, v7, s[12:15], s43 offen
    buffer_load_ushort v14, v7, s[12:15], s44 offen
    buffer_load_ushort v15, v7, s[12:15], s45 offen
    buffer_load_ushort v16, v7, s[12:15], s46 offen
    buffer_load_ushort v17, v7, s[12:15], s47 offen
    s_waitcnt vmcnt(6)
    v_lshl_or_b32 v20, v11, 16, v10
    s_waitcnt vmcnt(4)
    v_lshl_or_b32 v21, v13, 16, v12
    s_waitcnt vmcnt(2)
    v_lshl_or_b32 v22, v15, 16, v14
    s_waitcnt vmcnt(0)
    v_lshl_or_b32 v23, v17, 16, v16
    s_lshl_b32 s37, s31, 10
    v_lshlrev_b32 v8, 4, v1
    buffer_store_dwordx4 v[20:23], v8, s[16:19], s37 offen
    s_endpgm
prep_kernel_job3:
    s_cmp_ge_u32 s2, 826
    s_cbranch_scc1 prep_kernel_job4
    s_sub_u32 s20, s2, 434
    s_load_dwordx2 s[6:7], s[0:1], 32
    s_waitcnt lgkmcnt(0)
    s_mov_b32 s12, s6
    s_mov_b32 s13, s7
    s_mov_b32 s14, 1605632
    s_mov_b32 s15, 0x00020000
    s_add_u32 s16, s4, 2097152
    s_addc_u32 s17, s5, 0
    s_mov_b32 s18, 1605632
    s_mov_b32 s19, 0x00020000
    v_lshrrev_b32 v1, 6, v0
    s_nop 0
    v_readfirstlane_b32 s30, v1
    s_lshl_b32 s31, s20, 2
    s_add_u32 s31, s31, s30
    s_mov_b32 s33, 153391690
    s_mul_hi_u32 s32, s31, s33
    s_mul_i32 s33, s32, 28
    s_sub_u32 s33, s31, s33
    v_and_b32 v1, 63, v0
    v_and_b32 v2, 31, v1
    v_lshrrev_b32 v3, 5, v1
    s_lshl_b32 s35, s33, 4
    v_lshlrev_b32 v5, 3, v3
    v_add_u32 v5, s35, v5
    s_lshl_b32 s36, s32, 5
    v_add_u32 v6, s36, v2
    s_mov_b32 s37, 3584
    v_mul_lo_u32 v7, v5, s37
    v_lshlrev_b32 v6, 1, v6
    v_add_u32 v7, v7, v6
    s_mov_b32 s40, 0
    s_mov_b32 s41, 3584
    s_mov_b32 s42, 7168
    s_mov_b32 s43, 10752
    s_mov_b32 s44, 14336
    s_mov_b32 s45, 17920
    s_mov_b32 s46, 21504
    s_mov_b32 s47, 25088
    buffer_load_ushort v10, v7, s[12:15], s40 offen
    buffer_load_ushort v11, v7, s[12:15], s41 offen
    buffer_load_ushort v12, v7, s[12:15], s42 offen
    buffer_load_ushort v13, v7, s[12:15], s43 offen
    buffer_load_ushort v14, v7, s[12:15], s44 offen
    buffer_load_ushort v15, v7, s[12:15], s45 offen
    buffer_load_ushort v16, v7, s[12:15], s46 offen
    buffer_load_ushort v17, v7, s[12:15], s47 offen
    s_waitcnt vmcnt(6)
    v_lshl_or_b32 v20, v11, 16, v10
    s_waitcnt vmcnt(4)
    v_lshl_or_b32 v21, v13, 16, v12
    s_waitcnt vmcnt(2)
    v_lshl_or_b32 v22, v15, 16, v14
    s_waitcnt vmcnt(0)
    v_lshl_or_b32 v23, v17, 16, v16
    s_lshl_b32 s37, s31, 10
    v_lshlrev_b32 v8, 4, v1
    buffer_store_dwordx4 v[20:23], v8, s[16:19], s37 offen
    s_endpgm
prep_kernel_job4:
    s_cmp_ge_u32 s2, 1218
    s_cbranch_scc1 prep_kernel_job5
    s_sub_u32 s20, s2, 826
    s_load_dwordx2 s[6:7], s[0:1], 40
    s_waitcnt lgkmcnt(0)
    s_mov_b32 s12, s6
    s_mov_b32 s13, s7
    s_mov_b32 s14, 1605632
    s_mov_b32 s15, 0x00020000
    s_add_u32 s16, s4, 4194304
    s_addc_u32 s17, s5, 0
    s_mov_b32 s18, 1605632
    s_mov_b32 s19, 0x00020000
    v_lshrrev_b32 v1, 6, v0
    s_nop 0
    v_readfirstlane_b32 s30, v1
    s_lshl_b32 s31, s20, 2
    s_add_u32 s31, s31, s30
    s_mov_b32 s33, 153391690
    s_mul_hi_u32 s32, s31, s33
    s_mul_i32 s33, s32, 28
    s_sub_u32 s33, s31, s33
    v_and_b32 v1, 63, v0
    v_and_b32 v2, 31, v1
    v_lshrrev_b32 v3, 5, v1
    s_lshl_b32 s35, s33, 4
    v_lshlrev_b32 v5, 3, v3
    v_add_u32 v5, s35, v5
    s_lshl_b32 s36, s32, 5
    v_add_u32 v6, s36, v2
    s_mov_b32 s37, 3584
    v_mul_lo_u32 v7, v5, s37
    v_lshlrev_b32 v6, 1, v6
    v_add_u32 v7, v7, v6
    s_mov_b32 s40, 0
    s_mov_b32 s41, 3584
    s_mov_b32 s42, 7168
    s_mov_b32 s43, 10752
    s_mov_b32 s44, 14336
    s_mov_b32 s45, 17920
    s_mov_b32 s46, 21504
    s_mov_b32 s47, 25088
    buffer_load_ushort v10, v7, s[12:15], s40 offen
    buffer_load_ushort v11, v7, s[12:15], s41 offen
    buffer_load_ushort v12, v7, s[12:15], s42 offen
    buffer_load_ushort v13, v7, s[12:15], s43 offen
    buffer_load_ushort v14, v7, s[12:15], s44 offen
    buffer_load_ushort v15, v7, s[12:15], s45 offen
    buffer_load_ushort v16, v7, s[12:15], s46 offen
    buffer_load_ushort v17, v7, s[12:15], s47 offen
    s_waitcnt vmcnt(6)
    v_lshl_or_b32 v20, v11, 16, v10
    s_waitcnt vmcnt(4)
    v_lshl_or_b32 v21, v13, 16, v12
    s_waitcnt vmcnt(2)
    v_lshl_or_b32 v22, v15, 16, v14
    s_waitcnt vmcnt(0)
    v_lshl_or_b32 v23, v17, 16, v16
    s_lshl_b32 s37, s31, 10
    v_lshlrev_b32 v8, 4, v1
    buffer_store_dwordx4 v[20:23], v8, s[16:19], s37 offen
    s_endpgm
prep_kernel_job5:
    s_cmp_ge_u32 s2, 1610
    s_cbranch_scc1 prep_kernel_job6
    s_sub_u32 s20, s2, 1218
    s_load_dwordx2 s[6:7], s[0:1], 48
    s_waitcnt lgkmcnt(0)
    s_mov_b32 s12, s6
    s_mov_b32 s13, s7
    s_mov_b32 s14, 1605632
    s_mov_b32 s15, 0x00020000
    s_add_u32 s16, s4, 6291456
    s_addc_u32 s17, s5, 0
    s_mov_b32 s18, 1605632
    s_mov_b32 s19, 0x00020000
    v_lshrrev_b32 v1, 6, v0
    s_nop 0
    v_readfirstlane_b32 s30, v1
    s_lshl_b32 s31, s20, 2
    s_add_u32 s31, s31, s30
    s_mov_b32 s33, 38347923
    s_mul_hi_u32 s32, s31, s33
    s_mul_i32 s33, s32, 112
    s_sub_u32 s33, s31, s33
    v_and_b32 v1, 63, v0
    v_and_b32 v2, 31, v1
    v_lshrrev_b32 v3, 5, v1
    s_lshl_b32 s35, s33, 4
    v_lshlrev_b32 v5, 3, v3
    v_add_u32 v5, s35, v5
    s_lshl_b32 s36, s32, 5
    v_add_u32 v6, s36, v2
    s_mov_b32 s37, 896
    v_mul_lo_u32 v7, v5, s37
    v_lshlrev_b32 v6, 1, v6
    v_add_u32 v7, v7, v6
    s_mov_b32 s40, 0
    s_mov_b32 s41, 896
    s_mov_b32 s42, 1792
    s_mov_b32 s43, 2688
    s_mov_b32 s44, 3584
    s_mov_b32 s45, 4480
    s_mov_b32 s46, 5376
    s_mov_b32 s47, 6272
    buffer_load_ushort v10, v7, s[12:15], s40 offen
    buffer_load_ushort v11, v7, s[12:15], s41 offen
    buffer_load_ushort v12, v7, s[12:15], s42 offen
    buffer_load_ushort v13, v7, s[12:15], s43 offen
    buffer_load_ushort v14, v7, s[12:15], s44 offen
    buffer_load_ushort v15, v7, s[12:15], s45 offen
    buffer_load_ushort v16, v7, s[12:15], s46 offen
    buffer_load_ushort v17, v7, s[12:15], s47 offen
    s_waitcnt vmcnt(6)
    v_lshl_or_b32 v20, v11, 16, v10
    s_waitcnt vmcnt(4)
    v_lshl_or_b32 v21, v13, 16, v12
    s_waitcnt vmcnt(2)
    v_lshl_or_b32 v22, v15, 16, v14
    s_waitcnt vmcnt(0)
    v_lshl_or_b32 v23, v17, 16, v16
    s_lshl_b32 s37, s31, 10
    v_lshlrev_b32 v8, 4, v1
    buffer_store_dwordx4 v[20:23], v8, s[16:19], s37 offen
    s_endpgm
prep_kernel_job6:
    s_cmp_ge_u32 s2, 1687
    s_cbranch_scc1 prep_kernel_job7
    s_sub_u32 s20, s2, 1610
    s_cmp_lt_u32 s20, 21
    s_cbranch_scc1 prep_kernel_csq8
    s_cmp_lt_u32 s20, 49
    s_cbranch_scc1 prep_kernel_csg9
    s_sub_u32 s21, s20, 49
    s_load_dwordx2 s[6:7], s[0:1], 40
    s_waitcnt lgkmcnt(0)
    s_mov_b32 s22, 8142848
    s_mov_b32 s23, 3584
    s_mov_b32 s24, 0
    s_branch prep_kernel_csgo10
prep_kernel_csg9:
    s_sub_u32 s21, s20, 21
    s_load_dwordx2 s[6:7], s[0:1], 32
    s_waitcnt lgkmcnt(0)
    s_mov_b32 s22, 8134656
    s_mov_b32 s23, 3584
    s_mov_b32 s24, 0
    s_branch prep_kernel_csgo10
prep_kernel_csq8:
    s_mov_b32 s21, s20
    s_load_dwordx2 s[6:7], s[0:1], 8
    s_waitcnt lgkmcnt(0)
    s_mov_b32 s22, 8126464
    s_mov_b32 s23, 2688
    s_mov_b32 s24, 1
prep_kernel_csgo10:
    s_waitcnt lgkmcnt(0)
    s_mov_b32 s12, s6
    s_mov_b32 s13, s7
    s_mul_i32 s14, s23, 448
    s_mov_b32 s15, 0x00020000
    s_add_u32 s16, s4, s22
    s_addc_u32 s17, s5, 0
    s_mov_b32 s18, 8192
    s_mov_b32 s19, 0x00020000
    s_lshl_b32 s25, s21, 7
    v_and_b32 v1, 7, v0
    v_lshrrev_b32 v2, 3, v0
    v_lshlrev_b32 v3, 4, v2
    v_mul_lo_u32 v3, v3, s23
    v_lshlrev_b32 v4, 4, v1
    v_add3_u32 v3, v3, v4, s25
    buffer_load_dwordx4 v[32:35], v3, s[12:15], 0 offen
    v_add_u32 v3, s23, v3
    buffer_load_dwordx4 v[36:39], v3, s[12:15], 0 offen
    v_add_u32 v3, s23, v3
    buffer_load_dwordx4 v[40:43], v3, s[12:15], 0 offen
    v_add_u32 v3, s23, v3
    buffer_load_dwordx4 v[44:47], v3, s[12:15], 0 offen
    v_add_u32 v3, s23, v3
    buffer_load_dwordx4 v[48:51], v3, s[12:15], 0 offen
    v_add_u32 v3, s23, v3
    buffer_load_dwordx4 v[52:55], v3, s[12:15], 0 offen
    v_add_u32 v3, s23, v3
    buffer_load_dwordx4 v[56:59], v3, s[12:15], 0 offen
    v_add_u32 v3, s23, v3
    buffer_load_dwordx4 v[60:63], v3, s[12:15], 0 offen
    v_add_u32 v3, s23, v3
    buffer_load_dwordx4 v[64:67], v3, s[12:15], 0 offen
    v_add_u32 v3, s23, v3
    buffer_load_dwordx4 v[68:71], v3, s[12:15], 0 offen
    v_add_u32 v3, s23, v3
    buffer_load_dwordx4 v[72:75], v3, s[12:15], 0 offen
    v_add_u32 v3, s23, v3
    buffer_load_dwordx4 v[76:79], v3, s[12:15], 0 offen
    v_add_u32 v3, s23, v3
    buffer_load_dwordx4 v[80:83], v3, s[12:15], 0 offen
    v_add_u32 v3, s23, v3
    buffer_load_dwordx4 v[84:87], v3, s[12:15], 0 offen
    v_add_u32 v3, s23, v3
    buffer_load_dwordx4 v[88:91], v3, s[12:15], 0 offen
    v_add_u32 v3, s23, v3
    buffer_load_dwordx4 v[92:95], v3, s[12:15], 0 offen
    v_mov_b32 v16, 0
    v_mov_b32 v17, 0
    v_mov_b32 v18, 0
    v_mov_b32 v19, 0
    v_mov_b32 v20, 0
    v_mov_b32 v21, 0
    v_mov_b32 v22, 0
    v_mov_b32 v23, 0
    s_waitcnt vmcnt(15)
    v_lshlrev_b32 v5, 16, v32
    v_and_b32 v6, 0xffff0000, v32
    v_add_f32 v16, v16, v5
    v_add_f32 v17, v17, v6
    v_lshlrev_b32 v5, 16, v33
    v_and_b32 v6, 0xffff0000, v33
    v_add_f32 v18, v18, v5
    v_add_f32 v19, v19, v6
    v_lshlrev_b32 v5, 16, v34
    v_and_b32 v6, 0xffff0000, v34
    v_add_f32 v20, v20, v5
    v_add_f32 v21, v21, v6
    v_lshlrev_b32 v5, 16, v35
    v_and_b32 v6, 0xffff0000, v35
    v_add_f32 v22, v22, v5
    v_add_f32 v23, v23, v6
    s_waitcnt vmcnt(14)
    v_lshlrev_b32 v5, 16, v36
    v_and_b32 v6, 0xffff0000, v36
    v_add_f32 v16, v16, v5
    v_add_f32 v17, v17, v6
    v_lshlrev_b32 v5, 16, v37
    v_and_b32 v6, 0xffff0000, v37
    v_add_f32 v18, v18, v5
    v_add_f32 v19, v19, v6
    v_lshlrev_b32 v5, 16, v38
    v_and_b32 v6, 0xffff0000, v38
    v_add_f32 v20, v20, v5
    v_add_f32 v21, v21, v6
    v_lshlrev_b32 v5, 16, v39
    v_and_b32 v6, 0xffff0000, v39
    v_add_f32 v22, v22, v5
    v_add_f32 v23, v23, v6
    s_waitcnt vmcnt(13)
    v_lshlrev_b32 v5, 16, v40
    v_and_b32 v6, 0xffff0000, v40
    v_add_f32 v16, v16, v5
    v_add_f32 v17, v17, v6
    v_lshlrev_b32 v5, 16, v41
    v_and_b32 v6, 0xffff0000, v41
    v_add_f32 v18, v18, v5
    v_add_f32 v19, v19, v6
    v_lshlrev_b32 v5, 16, v42
    v_and_b32 v6, 0xffff0000, v42
    v_add_f32 v20, v20, v5
    v_add_f32 v21, v21, v6
    v_lshlrev_b32 v5, 16, v43
    v_and_b32 v6, 0xffff0000, v43
    v_add_f32 v22, v22, v5
    v_add_f32 v23, v23, v6
    s_waitcnt vmcnt(12)
    v_lshlrev_b32 v5, 16, v44
    v_and_b32 v6, 0xffff0000, v44
    v_add_f32 v16, v16, v5
    v_add_f32 v17, v17, v6
    v_lshlrev_b32 v5, 16, v45
    v_and_b32 v6, 0xffff0000, v45
    v_add_f32 v18, v18, v5
    v_add_f32 v19, v19, v6
    v_lshlrev_b32 v5, 16, v46
    v_and_b32 v6, 0xffff0000, v46
    v_add_f32 v20, v20, v5
    v_add_f32 v21, v21, v6
    v_lshlrev_b32 v5, 16, v47
    v_and_b32 v6, 0xffff0000, v47
    v_add_f32 v22, v22, v5
    v_add_f32 v23, v23, v6
    s_waitcnt vmcnt(11)
    v_lshlrev_b32 v5, 16, v48
    v_and_b32 v6, 0xffff0000, v48
    v_add_f32 v16, v16, v5
    v_add_f32 v17, v17, v6
    v_lshlrev_b32 v5, 16, v49
    v_and_b32 v6, 0xffff0000, v49
    v_add_f32 v18, v18, v5
    v_add_f32 v19, v19, v6
    v_lshlrev_b32 v5, 16, v50
    v_and_b32 v6, 0xffff0000, v50
    v_add_f32 v20, v20, v5
    v_add_f32 v21, v21, v6
    v_lshlrev_b32 v5, 16, v51
    v_and_b32 v6, 0xffff0000, v51
    v_add_f32 v22, v22, v5
    v_add_f32 v23, v23, v6
    s_waitcnt vmcnt(10)
    v_lshlrev_b32 v5, 16, v52
    v_and_b32 v6, 0xffff0000, v52
    v_add_f32 v16, v16, v5
    v_add_f32 v17, v17, v6
    v_lshlrev_b32 v5, 16, v53
    v_and_b32 v6, 0xffff0000, v53
    v_add_f32 v18, v18, v5
    v_add_f32 v19, v19, v6
    v_lshlrev_b32 v5, 16, v54
    v_and_b32 v6, 0xffff0000, v54
    v_add_f32 v20, v20, v5
    v_add_f32 v21, v21, v6
    v_lshlrev_b32 v5, 16, v55
    v_and_b32 v6, 0xffff0000, v55
    v_add_f32 v22, v22, v5
    v_add_f32 v23, v23, v6
    s_waitcnt vmcnt(9)
    v_lshlrev_b32 v5, 16, v56
    v_and_b32 v6, 0xffff0000, v56
    v_add_f32 v16, v16, v5
    v_add_f32 v17, v17, v6
    v_lshlrev_b32 v5, 16, v57
    v_and_b32 v6, 0xffff0000, v57
    v_add_f32 v18, v18, v5
    v_add_f32 v19, v19, v6
    v_lshlrev_b32 v5, 16, v58
    v_and_b32 v6, 0xffff0000, v58
    v_add_f32 v20, v20, v5
    v_add_f32 v21, v21, v6
    v_lshlrev_b32 v5, 16, v59
    v_and_b32 v6, 0xffff0000, v59
    v_add_f32 v22, v22, v5
    v_add_f32 v23, v23, v6
    s_waitcnt vmcnt(8)
    v_lshlrev_b32 v5, 16, v60
    v_and_b32 v6, 0xffff0000, v60
    v_add_f32 v16, v16, v5
    v_add_f32 v17, v17, v6
    v_lshlrev_b32 v5, 16, v61
    v_and_b32 v6, 0xffff0000, v61
    v_add_f32 v18, v18, v5
    v_add_f32 v19, v19, v6
    v_lshlrev_b32 v5, 16, v62
    v_and_b32 v6, 0xffff0000, v62
    v_add_f32 v20, v20, v5
    v_add_f32 v21, v21, v6
    v_lshlrev_b32 v5, 16, v63
    v_and_b32 v6, 0xffff0000, v63
    v_add_f32 v22, v22, v5
    v_add_f32 v23, v23, v6
    s_waitcnt vmcnt(7)
    v_lshlrev_b32 v5, 16, v64
    v_and_b32 v6, 0xffff0000, v64
    v_add_f32 v16, v16, v5
    v_add_f32 v17, v17, v6
    v_lshlrev_b32 v5, 16, v65
    v_and_b32 v6, 0xffff0000, v65
    v_add_f32 v18, v18, v5
    v_add_f32 v19, v19, v6
    v_lshlrev_b32 v5, 16, v66
    v_and_b32 v6, 0xffff0000, v66
    v_add_f32 v20, v20, v5
    v_add_f32 v21, v21, v6
    v_lshlrev_b32 v5, 16, v67
    v_and_b32 v6, 0xffff0000, v67
    v_add_f32 v22, v22, v5
    v_add_f32 v23, v23, v6
    s_waitcnt vmcnt(6)
    v_lshlrev_b32 v5, 16, v68
    v_and_b32 v6, 0xffff0000, v68
    v_add_f32 v16, v16, v5
    v_add_f32 v17, v17, v6
    v_lshlrev_b32 v5, 16, v69
    v_and_b32 v6, 0xffff0000, v69
    v_add_f32 v18, v18, v5
    v_add_f32 v19, v19, v6
    v_lshlrev_b32 v5, 16, v70
    v_and_b32 v6, 0xffff0000, v70
    v_add_f32 v20, v20, v5
    v_add_f32 v21, v21, v6
    v_lshlrev_b32 v5, 16, v71
    v_and_b32 v6, 0xffff0000, v71
    v_add_f32 v22, v22, v5
    v_add_f32 v23, v23, v6
    s_waitcnt vmcnt(5)
    v_lshlrev_b32 v5, 16, v72
    v_and_b32 v6, 0xffff0000, v72
    v_add_f32 v16, v16, v5
    v_add_f32 v17, v17, v6
    v_lshlrev_b32 v5, 16, v73
    v_and_b32 v6, 0xffff0000, v73
    v_add_f32 v18, v18, v5
    v_add_f32 v19, v19, v6
    v_lshlrev_b32 v5, 16, v74
    v_and_b32 v6, 0xffff0000, v74
    v_add_f32 v20, v20, v5
    v_add_f32 v21, v21, v6
    v_lshlrev_b32 v5, 16, v75
    v_and_b32 v6, 0xffff0000, v75
    v_add_f32 v22, v22, v5
    v_add_f32 v23, v23, v6
    s_waitcnt vmcnt(4)
    v_lshlrev_b32 v5, 16, v76
    v_and_b32 v6, 0xffff0000, v76
    v_add_f32 v16, v16, v5
    v_add_f32 v17, v17, v6
    v_lshlrev_b32 v5, 16, v77
    v_and_b32 v6, 0xffff0000, v77
    v_add_f32 v18, v18, v5
    v_add_f32 v19, v19, v6
    v_lshlrev_b32 v5, 16, v78
    v_and_b32 v6, 0xffff0000, v78
    v_add_f32 v20, v20, v5
    v_add_f32 v21, v21, v6
    v_lshlrev_b32 v5, 16, v79
    v_and_b32 v6, 0xffff0000, v79
    v_add_f32 v22, v22, v5
    v_add_f32 v23, v23, v6
    s_waitcnt vmcnt(3)
    v_lshlrev_b32 v5, 16, v80
    v_and_b32 v6, 0xffff0000, v80
    v_add_f32 v16, v16, v5
    v_add_f32 v17, v17, v6
    v_lshlrev_b32 v5, 16, v81
    v_and_b32 v6, 0xffff0000, v81
    v_add_f32 v18, v18, v5
    v_add_f32 v19, v19, v6
    v_lshlrev_b32 v5, 16, v82
    v_and_b32 v6, 0xffff0000, v82
    v_add_f32 v20, v20, v5
    v_add_f32 v21, v21, v6
    v_lshlrev_b32 v5, 16, v83
    v_and_b32 v6, 0xffff0000, v83
    v_add_f32 v22, v22, v5
    v_add_f32 v23, v23, v6
    s_waitcnt vmcnt(2)
    v_lshlrev_b32 v5, 16, v84
    v_and_b32 v6, 0xffff0000, v84
    v_add_f32 v16, v16, v5
    v_add_f32 v17, v17, v6
    v_lshlrev_b32 v5, 16, v85
    v_and_b32 v6, 0xffff0000, v85
    v_add_f32 v18, v18, v5
    v_add_f32 v19, v19, v6
    v_lshlrev_b32 v5, 16, v86
    v_and_b32 v6, 0xffff0000, v86
    v_add_f32 v20, v20, v5
    v_add_f32 v21, v21, v6
    v_lshlrev_b32 v5, 16, v87
    v_and_b32 v6, 0xffff0000, v87
    v_add_f32 v22, v22, v5
    v_add_f32 v23, v23, v6
    s_waitcnt vmcnt(1)
    v_lshlrev_b32 v5, 16, v88
    v_and_b32 v6, 0xffff0000, v88
    v_add_f32 v16, v16, v5
    v_add_f32 v17, v17, v6
    v_lshlrev_b32 v5, 16, v89
    v_and_b32 v6, 0xffff0000, v89
    v_add_f32 v18, v18, v5
    v_add_f32 v19, v19, v6
    v_lshlrev_b32 v5, 16, v90
    v_and_b32 v6, 0xffff0000, v90
    v_add_f32 v20, v20, v5
    v_add_f32 v21, v21, v6
    v_lshlrev_b32 v5, 16, v91
    v_and_b32 v6, 0xffff0000, v91
    v_add_f32 v22, v22, v5
    v_add_f32 v23, v23, v6
    s_waitcnt vmcnt(0)
    v_lshlrev_b32 v5, 16, v92
    v_and_b32 v6, 0xffff0000, v92
    v_add_f32 v16, v16, v5
    v_add_f32 v17, v17, v6
    v_lshlrev_b32 v5, 16, v93
    v_and_b32 v6, 0xffff0000, v93
    v_add_f32 v18, v18, v5
    v_add_f32 v19, v19, v6
    v_lshlrev_b32 v5, 16, v94
    v_and_b32 v6, 0xffff0000, v94
    v_add_f32 v20, v20, v5
    v_add_f32 v21, v21, v6
    v_lshlrev_b32 v5, 16, v95
    v_and_b32 v6, 0xffff0000, v95
    v_add_f32 v22, v22, v5
    v_add_f32 v23, v23, v6
    v_lshlrev_b32 v5, 8, v2
    v_lshl_add_u32 v5, v1, 5, v5
    ds_write_b128 v5, v[16:19]
    ds_write_b128 v5, v[20:23] offset:16
    s_waitcnt lgkmcnt(0)
    s_barrier
    v_cmp_gt_u32 vcc, 64, v0
    s_and_saveexec_b64 s[26:27], vcc
    s_cbranch_execz prep_kernel_csskip11
    v_lshlrev_b32 v5, 2, v0
    ds_read_b32 v32, v5 offset:0
    ds_read_b32 v33, v5 offset:256
    ds_read_b32 v34, v5 offset:512
    ds_read_b32 v35, v5 offset:768
    ds_read_b32 v36, v5 offset:1024
    ds_read_b32 v37, v5 offset:1280
    ds_read_b32 v38, v5 offset:1536
    ds_read_b32 v39, v5 offset:1792
    ds_read_b32 v40, v5 offset:2048
    ds_read_b32 v41, v5 offset:2304
    ds_read_b32 v42, v5 offset:2560
    ds_read_b32 v43, v5 offset:2816
    ds_read_b32 v44, v5 offset:3072
    ds_read_b32 v45, v5 offset:3328
    ds_read_b32 v46, v5 offset:3584
    ds_read_b32 v47, v5 offset:3840
    ds_read_b32 v48, v5 offset:4096
    ds_read_b32 v49, v5 offset:4352
    ds_read_b32 v50, v5 offset:4608
    ds_read_b32 v51, v5 offset:4864
    ds_read_b32 v52, v5 offset:5120
    ds_read_b32 v53, v5 offset:5376
    ds_read_b32 v54, v5 offset:5632
    ds_read_b32 v55, v5 offset:5888
    ds_read_b32 v56, v5 offset:6144
    ds_read_b32 v57, v5 offset:6400
    ds_read_b32 v58, v5 offset:6656
    ds_read_b32 v59, v5 offset:6912
    ds_read_b32 v60, v5 offset:7168
    ds_read_b32 v61, v5 offset:7424
    ds_read_b32 v62, v5 offset:7680
    ds_read_b32 v63, v5 offset:7936
    v_mov_b32 v6, 0
    s_waitcnt lgkmcnt(15)
    v_add_f32 v6, v6, v32
    v_add_f32 v6, v6, v33
    v_add_f32 v6, v6, v34
    v_add_f32 v6, v6, v35
    v_add_f32 v6, v6, v36
    v_add_f32 v6, v6, v37
    v_add_f32 v6, v6, v38
    v_add_f32 v6, v6, v39
    v_add_f32 v6, v6, v40
    v_add_f32 v6, v6, v41
    v_add_f32 v6, v6, v42
    v_add_f32 v6, v6, v43
    v_add_f32 v6, v6, v44
    v_add_f32 v6, v6, v45
    v_add_f32 v6, v6, v46
    v_add_f32 v6, v6, v47
    v_add_f32 v6, v6, v48
    s_waitcnt lgkmcnt(14)
    v_add_f32 v6, v6, v49
    s_waitcnt lgkmcnt(13)
    v_add_f32 v6, v6, v50
    s_waitcnt lgkmcnt(12)
    v_add_f32 v6, v6, v51
    s_waitcnt lgkmcnt(11)
    v_add_f32 v6, v6, v52
    s_waitcnt lgkmcnt(10)
    v_add_f32 v6, v6, v53
    s_waitcnt lgkmcnt(9)
    v_add_f32 v6, v6, v54
    s_waitcnt lgkmcnt(8)
    v_add_f32 v6, v6, v55
    s_waitcnt lgkmcnt(7)
    v_add_f32 v6, v6, v56
    s_waitcnt lgkmcnt(6)
    v_add_f32 v6, v6, v57
    s_waitcnt lgkmcnt(5)
    v_add_f32 v6, v6, v58
    s_waitcnt lgkmcnt(4)
    v_add_f32 v6, v6, v59
    s_waitcnt lgkmcnt(3)
    v_add_f32 v6, v6, v60
    s_waitcnt lgkmcnt(2)
    v_add_f32 v6, v6, v61
    s_waitcnt lgkmcnt(1)
    v_add_f32 v6, v6, v62
    s_waitcnt lgkmcnt(0)
    v_add_f32 v6, v6, v63
    s_lshr_b32 s25, s25, 1
    v_add_u32 v7, s25, v0
    s_cmp_eq_u32 s24, 0
    s_cbranch_scc1 prep_kernel_csnp12
    s_mov_b32 s28, 153391690
    v_mul_hi_u32 v8, v7, s28
    v_lshlrev_b32 v9, 2, v8
    v_add_u32 v7, v7, v9
prep_kernel_csnp12:
    v_lshlrev_b32 v7, 2, v7
    buffer_store_dword v6, v7, s[16:19], 0 offen
prep_kernel_csskip11:
    s_mov_b64 exec, s[26:27]
    s_cmp_lg_u32 s20, 0
    s_cbranch_scc1 prep_kernel_csend13
    v_subrev_u32 v5, 64, v0
    v_cmp_le_u32 vcc, 64, v0
    s_and_saveexec_b64 s[26:27], vcc
    s_cbranch_execz prep_kernel_csend13
    v_lshrrev_b32 v6, 2, v5
    v_lshlrev_b32 v6, 5, v6
    v_and_b32 v7, 3, v5
    v_add3_u32 v6, v6, v7, 28
    v_lshlrev_b32 v6, 2, v6
    v_mov_b32 v8, 0
    buffer_store_dword v8, v6, s[16:19], 0 offen
prep_kernel_csend13:
    s_endpgm
prep_kernel_job7:
    s_sub_u32 s20, s2, 1687
    s_load_dwordx2 s[6:7], s[0:1], 0
    s_waitcnt lgkmcnt(0)
    s_mov_b32 s12, s6
    s_mov_b32 s13, s7
    s_mov_b32 s14, 1835008
    s_mov_b32 s15, 0x00020000
    s_add_u32 s16, s4, 31457280
    s_addc_u32 s17, s5, 0
    s_mov_b32 s18, 229376
    s_mov_b32 s19, 0x00020000
    v_lshrrev_b32 v1, 3, v0
    s_lshl_b32 s21, s20, 5
    v_add_u32 v1, s21, v1
    v_and_b32 v2, 7, v0
    v_mul_u32_u24 v3, 896, v1
    v_lshl_add_u32 v3, v2, 4, v3
    buffer_load_dwordx4 v[16:19], v3, s[12:15], 0 offen offset:0
    buffer_load_dwordx4 v[20:23], v3, s[12:15], 0 offen offset:128
    buffer_load_dwordx4 v[24:27], v3, s[12:15], 0 offen offset:256
    buffer_load_dwordx4 v[28:31], v3, s[12:15], 0 offen offset:384
    buffer_load_dwordx4 v[32:35], v3, s[12:15], 0 offen offset:512
    buffer_load_dwordx4 v[36:39], v3, s[12:15], 0 offen offset:640
    buffer_load_dwordx4 v[40:43], v3, s[12:15], 0 offen offset:768
    v_mov_b32 v8, 0
    v_mov_b32 v9, 0
    s_waitcnt vmcnt(6)
    v_lshlrev_b32 v5, 16, v16
    v_and_b32 v6, 0xffff0000, v16
    v_add_f32 v8, v8, v5
    v_fma_f32 v9, v5, v5, v9
    v_add_f32 v8, v8, v6
    v_fma_f32 v9, v6, v6, v9
    v_lshlrev_b32 v5, 16, v17
    v_and_b32 v6, 0xffff0000, v17
    v_add_f32 v8, v8, v5
    v_fma_f32 v9, v5, v5, v9
    v_add_f32 v8, v8, v6
    v_fma_f32 v9, v6, v6, v9
    v_lshlrev_b32 v5, 16, v18
    v_and_b32 v6, 0xffff0000, v18
    v_add_f32 v8, v8, v5
    v_fma_f32 v9, v5, v5, v9
    v_add_f32 v8, v8, v6
    v_fma_f32 v9, v6, v6, v9
    v_lshlrev_b32 v5, 16, v19
    v_and_b32 v6, 0xffff0000, v19
    v_add_f32 v8, v8, v5
    v_fma_f32 v9, v5, v5, v9
    v_add_f32 v8, v8, v6
    v_fma_f32 v9, v6, v6, v9
    s_waitcnt vmcnt(5)
    v_lshlrev_b32 v5, 16, v20
    v_and_b32 v6, 0xffff0000, v20
    v_add_f32 v8, v8, v5
    v_fma_f32 v9, v5, v5, v9
    v_add_f32 v8, v8, v6
    v_fma_f32 v9, v6, v6, v9
    v_lshlrev_b32 v5, 16, v21
    v_and_b32 v6, 0xffff0000, v21
    v_add_f32 v8, v8, v5
    v_fma_f32 v9, v5, v5, v9
    v_add_f32 v8, v8, v6
    v_fma_f32 v9, v6, v6, v9
    v_lshlrev_b32 v5, 16, v22
    v_and_b32 v6, 0xffff0000, v22
    v_add_f32 v8, v8, v5
    v_fma_f32 v9, v5, v5, v9
    v_add_f32 v8, v8, v6
    v_fma_f32 v9, v6, v6, v9
    v_lshlrev_b32 v5, 16, v23
    v_and_b32 v6, 0xffff0000, v23
    v_add_f32 v8, v8, v5
    v_fma_f32 v9, v5, v5, v9
    v_add_f32 v8, v8, v6
    v_fma_f32 v9, v6, v6, v9
    s_waitcnt vmcnt(4)
    v_lshlrev_b32 v5, 16, v24
    v_and_b32 v6, 0xffff0000, v24
    v_add_f32 v8, v8, v5
    v_fma_f32 v9, v5, v5, v9
    v_add_f32 v8, v8, v6
    v_fma_f32 v9, v6, v6, v9
    v_lshlrev_b32 v5, 16, v25
    v_and_b32 v6, 0xffff0000, v25
    v_add_f32 v8, v8, v5
    v_fma_f32 v9, v5, v5, v9
    v_add_f32 v8, v8, v6
    v_fma_f32 v9, v6, v6, v9
    v_lshlrev_b32 v5, 16, v26
    v_and_b32 v6, 0xffff0000, v26
    v_add_f32 v8, v8, v5
    v_fma_f32 v9, v5, v5, v9
    v_add_f32 v8, v8, v6
    v_fma_f32 v9, v6, v6, v9
    v_lshlrev_b32 v5, 16, v27
    v_and_b32 v6, 0xffff0000, v27
    v_add_f32 v8, v8, v5
    v_fma_f32 v9, v5, v5, v9
    v_add_f32 v8, v8, v6
    v_fma_f32 v9, v6, v6, v9
    s_waitcnt vmcnt(3)
    v_lshlrev_b32 v5, 16, v28
    v_and_b32 v6, 0xffff0000, v28
    v_add_f32 v8, v8, v5
    v_fma_f32 v9, v5, v5, v9
    v_add_f32 v8, v8, v6
    v_fma_f32 v9, v6, v6, v9
    v_lshlrev_b32 v5, 16, v29
    v_and_b32 v6, 0xffff0000, v29
    v_add_f32 v8, v8, v5
    v_fma_f32 v9, v5, v5, v9
    v_add_f32 v8, v8, v6
    v_fma_f32 v9, v6, v6, v9
    v_lshlrev_b32 v5, 16, v30
    v_and_b32 v6, 0xffff0000, v30
    v_add_f32 v8, v8, v5
    v_fma_f32 v9, v5, v5, v9
    v_add_f32 v8, v8, v6
    v_fma_f32 v9, v6, v6, v9
    v_lshlrev_b32 v5, 16, v31
    v_and_b32 v6, 0xffff0000, v31
    v_add_f32 v8, v8, v5
    v_fma_f32 v9, v5, v5, v9
    v_add_f32 v8, v8, v6
    v_fma_f32 v9, v6, v6, v9
    s_waitcnt vmcnt(2)
    v_lshlrev_b32 v5, 16, v32
    v_and_b32 v6, 0xffff0000, v32
    v_add_f32 v8, v8, v5
    v_fma_f32 v9, v5, v5, v9
    v_add_f32 v8, v8, v6
    v_fma_f32 v9, v6, v6, v9
    v_lshlrev_b32 v5, 16, v33
    v_and_b32 v6, 0xffff0000, v33
    v_add_f32 v8, v8, v5
    v_fma_f32 v9, v5, v5, v9
    v_add_f32 v8, v8, v6
    v_fma_f32 v9, v6, v6, v9
    v_lshlrev_b32 v5, 16, v34
    v_and_b32 v6, 0xffff0000, v34
    v_add_f32 v8, v8, v5
    v_fma_f32 v9, v5, v5, v9
    v_add_f32 v8, v8, v6
    v_fma_f32 v9, v6, v6, v9
    v_lshlrev_b32 v5, 16, v35
    v_and_b32 v6, 0xffff0000, v35
    v_add_f32 v8, v8, v5
    v_fma_f32 v9, v5, v5, v9
    v_add_f32 v8, v8, v6
    v_fma_f32 v9, v6, v6, v9
    s_waitcnt vmcnt(1)
    v_lshlrev_b32 v5, 16, v36
    v_and_b32 v6, 0xffff0000, v36
    v_add_f32 v8, v8, v5
    v_fma_f32 v9, v5, v5, v9
    v_add_f32 v8, v8, v6
    v_fma_f32 v9, v6, v6, v9
    v_lshlrev_b32 v5, 16, v37
    v_and_b32 v6, 0xffff0000, v37
    v_add_f32 v8, v8, v5
    v_fma_f32 v9, v5, v5, v9
    v_add_f32 v8, v8, v6
    v_fma_f32 v9, v6, v6, v9
    v_lshlrev_b32 v5, 16, v38
    v_and_b32 v6, 0xffff0000, v38
    v_add_f32 v8, v8, v5
    v_fma_f32 v9, v5, v5, v9
    v_add_f32 v8, v8, v6
    v_fma_f32 v9, v6, v6, v9
    v_lshlrev_b32 v5, 16, v39
    v_and_b32 v6, 0xffff0000, v39
    v_add_f32 v8, v8, v5
    v_fma_f32 v9, v5, v5, v9
    v_add_f32 v8, v8, v6
    v_fma_f32 v9, v6, v6, v9
    s_waitcnt vmcnt(0)
    v_lshlrev_b32 v5, 16, v40
    v_and_b32 v6, 0xffff0000, v40
    v_add_f32 v8, v8, v5
    v_fma_f32 v9, v5, v5, v9
    v_add_f32 v8, v8, v6
    v_fma_f32 v9, v6, v6, v9
    v_lshlrev_b32 v5, 16, v41
    v_and_b32 v6, 0xffff0000, v41
    v_add_f32 v8, v8, v5
    v_fma_f32 v9, v5, v5, v9
    v_add_f32 v8, v8, v6
    v_fma_f32 v9, v6, v6, v9
    v_lshlrev_b32 v5, 16, v42
    v_and_b32 v6, 0xffff0000, v42
    v_add_f32 v8, v8, v5
    v_fma_f32 v9, v5, v5, v9
    v_add_f32 v8, v8, v6
    v_fma_f32 v9, v6, v6, v9
    v_lshlrev_b32 v5, 16, v43
    v_and_b32 v6, 0xffff0000, v43
    v_add_f32 v8, v8, v5
    v_fma_f32 v9, v5, v5, v9
    v_add_f32 v8, v8, v6
    v_fma_f32 v9, v6, v6, v9
    s_nop 0
    v_add_f32_dpp v8, v8, v8 quad_perm:[1,0,3,2] row_mask:0xf bank_mask:0xf
    v_add_f32_dpp v9, v9, v9 quad_perm:[1,0,3,2] row_mask:0xf bank_mask:0xf
    s_nop 0
    v_add_f32_dpp v8, v8, v8 quad_perm:[2,3,0,1] row_mask:0xf bank_mask:0xf
    v_add_f32_dpp v9, v9, v9 quad_perm:[2,3,0,1] row_mask:0xf bank_mask:0xf
    s_nop 0
    v_add_f32_dpp v8, v8, v8 row_half_mirror row_mask:0xf bank_mask:0xf
    v_add_f32_dpp v9, v9, v9 row_half_mirror row_mask:0xf bank_mask:0xf
    v_cmp_eq_u32 vcc, 0, v2
    s_nop 1
    v_cndmask_b32 v10, 0, v8, vcc
    v_cndmask_b32 v11, 0, v9, vcc
    v_mov_b32 v12, 0
    v_mov_b32 v13, 0
    v_mul_u32_u24 v3, 112, v1
    v_lshl_add_u32 v3, v2, 4, v3
    v_cmp_gt_u32 vcc, 7, v2
    s_and_saveexec_b64 s[26:27], vcc
    buffer_store_dwordx4 v[10:13], v3, s[16:19], 0 offen
    s_endpgm
.section .rodata,"a"
.p2align 6
.amdhsa_kernel prep_kernel
  .amdhsa_next_free_vgpr 100
  .amdhsa_next_free_sgpr 64
  .amdhsa_accum_offset 100
  .amdhsa_group_segment_fixed_size 0
  .amdhsa_kernarg_size 80
  .amdhsa_user_sgpr_count 2
  .amdhsa_user_sgpr_kernarg_segment_ptr 1
  .amdhsa_system_sgpr_workgroup_id_x 1
.end_amdhsa_kernel
.text
.globl k1a_kernel
.p2align 8
.type k1a_kernel,@function
k1a_kernel:
    s_cmp_ge_u32 s2, 192
    s_cbranch_scc0 k1a_kernel_go1
    s_endpgm
k1a_kernel_go1:
    s_load_dwordx2 s[4:5], s[0:1], 72
    s_load_dwordx2 s[6:7], s[0:1], 0
    s_waitcnt lgkmcnt(0)
    s_mov_b32 s12, s6
    s_mov_b32 s13, s7
    s_mov_b32 s14, 1835008
    s_mov_b32 s15, 0x00020000
    s_mov_b32 s16, s4
    s_mov_b32 s17, s5
    s_mov_b32 s18, 1376256
    s_mov_b32 s19, 0x00020000
    s_add_u32 s20, s4, 31457280
    s_addc_u32 s21, s5, 0
    s_mov_b32 s22, 229376
    s_mov_b32 s23, 0x00020000
    s_add_u32 s24, s4, 8126464
    s_addc_u32 s25, s5, 0
    s_mov_b32 s26, 6144
    s_mov_b32 s27, 0x00020000
    v_lshrrev_b32 v1, 6, v0
    s_nop 0
    v_readfirstlane_b32 s32, v1
    s_lshr_b32 s30, s2, 4
    s_and_b32 s31, s2, 15
    s_lshl_b32 s34, s31, 7
    s_lshl_b32 s33, s30, 2
    s_add_u32 s33, s33, s32
    s_mul_i32 s35, s33, 28672
    v_and_b32 v1, 63, v0
    v_lshlrev_b32 v2, 4, v1
    s_add_u32 s36, s35, 0
    buffer_load_dwordx4 v[16:19], v2, s[16:19], s36 offen offset:0
    buffer_load_dwordx4 v[20:23], v2, s[16:19], s36 offen offset:1024
    buffer_load_dwordx4 v[24:27], v2, s[16:19], s36 offen offset:2048
    buffer_load_dwordx4 v[28:31], v2, s[16:19], s36 offen offset:3072
    s_add_u32 s36, s35, 4096
    buffer_load_dwordx4 v[32:35], v2, s[16:19], s36 offen offset:0
    buffer_load_dwordx4 v[36:39], v2, s[16:19], s36 offen offset:1024
    buffer_load_dwordx4 v[40:43], v2, s[16:19], s36 offen offset:2048
    buffer_load_dwordx4 v[44:47], v2, s[16:19], s36 offen offset:3072
    s_add_u32 s36, s35, 8192
    buffer_load_dwordx4 v[48:51], v2, s[16:19], s36 offen offset:0
    buffer_load_dwordx4 v[52:55], v2, s[16:19], s36 offen offset:1024
    buffer_load_dwordx4 v[56:59], v2, s[16:19], s36 offen offset:2048
    buffer_load_dwordx4 v[60:63], v2, s[16:19], s36 offen offset:3072
    s_add_u32 s36, s35, 12288
    buffer_load_dwordx4 v[64:67], v2, s[16:19], s36 offen offset:0
    buffer_load_dwordx4 v[68:71], v2, s[16:19], s36 offen offset:1024
    buffer_load_dwordx4 v[72:75], v2, s[16:19], s36 offen offset:2048
    buffer_load_dwordx4 v[76:79], v2, s[16:19], s36 offen offset:3072
    s_add_u32 s36, s35, 16384
    buffer_load_dwordx4 v[80:83], v2, s[16:19], s36 offen offset:0
    buffer_load_dwordx4 v[84:87], v2, s[16:19], s36 offen offset:1024
    buffer_load_dwordx4 v[88:91], v2, s[16:19], s36 offen offset:2048
    buffer_load_dwordx4 v[92:95], v2, s[16:19], s36 offen offset:3072
    s_add_u32 s36, s35, 20480
    buffer_load_dwordx4 v[96:99], v2, s[16:19], s36 offen offset:0
    buffer_load_dwordx4 v[100:103], v2, s[16:19], s36 offen offset:1024
    buffer_load_dwordx4 v[104:107], v2, s[16:19], s36 offen offset:2048
    buffer_load_dwordx4 v[108:111], v2, s[16:19], s36 offen offset:3072
    s_add_u32 s36, s35, 24576
    buffer_load_dwordx4 v[112:115], v2, s[16:19], s36 offen offset:0
    buffer_load_dwordx4 v[116:119], v2, s[16:19], s36 offen offset:1024
    buffer_load_dwordx4 v[120:123], v2, s[16:19], s36 offen offset:2048
    buffer_load_dwordx4 v[124:127], v2, s[16:19], s36 offen offset:3072
    v_lshlrev_b32 v3, 4, v0
    s_mul_i32 s40, s34, 896
    s_add_u32 s41, s40, 0
    buffer_load_dwordx4 v[128:131], v3, s[12:15], s41 offen
    s_add_u32 s41, s40, 4096
    buffer_load_dwordx4 v[132:135], v3, s[12:15], s41 offen
    s_add_u32 s41, s40, 8192
    buffer_load_dwordx4 v[136:139], v3, s[12:15], s41 offen
    s_add_u32 s41, s40, 12288
    buffer_load_dwordx4 v[140:143], v3, s[12:15], s41 offen
    s_add_u32 s41, s40, 16384
    buffer_load_dwordx4 v[144:147], v3, s[12:15], s41 offen
    s_add_u32 s41, s40, 20480
    buffer_load_dwordx4 v[148:151], v3, s[12:15], s41 offen
    s_add_u32 s41, s40, 24576
    buffer_load_dwordx4 v[152:155], v3, s[12:15], s41 offen
    s_add_u32 s41, s40, 28672
    buffer_load_dwordx4 v[156:159], v3, s[12:15], s41 offen
    s_add_u32 s41, s40, 32768
    buffer_load_dwordx4 v[160:163], v3, s[12:15], s41 offen
    s_add_u32 s41, s40, 36864
    buffer_load_dwordx4 v[164:167], v3, s[12:15], s41 offen
    s_add_u32 s41, s40, 40960
    buffer_load_dwordx4 v[168:171], v3, s[12:15], s41 offen
    s_add_u32 s41, s40, 45056
    buffer_load_dwordx4 v[172:175], v3, s[12:15], s41 offen
    s_add_u32 s41, s40, 49152
    buffer_load_dwordx4 v[176:179], v3, s[12:15], s41 offen
    s_add_u32 s41, s40, 53248
    buffer_load_dwordx4 v[180:183], v3, s[12:15], s41 offen
    s_add_u32 s41, s40, 57344
    buffer_load_dwordx4 v[184:187], v3, s[12:15], s41 offen
    s_add_u32 s41, s40, 61440
    buffer_load_dwordx4 v[188:191], v3, s[12:15], s41 offen
    s_add_u32 s41, s40, 65536
    buffer_load_dwordx4 v[192:195], v3, s[12:15], s41 offen
    s_add_u32 s41, s40, 69632
    buffer_load_dwordx4 v[196:199], v3, s[12:15], s41 offen
    s_add_u32 s41, s40, 73728
    buffer_load_dwordx4 v[200:203], v3, s[12:15], s41 offen
    s_add_u32 s41, s40, 77824
    buffer_load_dwordx4 v[204:207], v3, s[12:15], s41 offen
    s_add_u32 s41, s40, 81920
    buffer_load_dwordx4 v[208:211], v3, s[12:15], s41 offen
    s_add_u32 s41, s40, 86016
    buffer_load_dwordx4 v[212:215], v3, s[12:15], s41 offen
    s_add_u32 s41, s40, 90112
    buffer_load_dwordx4 v[216:219], v3, s[12:15], s41 offen
    s_add_u32 s41, s40, 94208
    buffer_load_dwordx4 v[220:223], v3, s[12:15], s41 offen
    s_add_u32 s41, s40, 98304
    buffer_load_dwordx4 v[224:227], v3, s[12:15], s41 offen
    s_add_u32 s41, s40, 102400
    buffer_load_dwordx4 v[228:231], v3, s[12:15], s41 offen
    s_add_u32 s41, s40, 106496
    buffer_load_dwordx4 v[232:235], v3, s[12:15], s41 offen
    s_add_u32 s41, s40, 110592
    buffer_load_dwordx4 v[236:239], v3, s[12:15], s41 offen
    v_add_u32 v4, 0, v0
    v_mul_u32_u24 v5, 9363, v4
    v_lshrrev_b32 v5, 19, v5
    v_add_lshl_u32 v4, v4, v5, 4
    s_waitcnt vmcnt(27)
    ds_write_b128 v4, v[128:131] offset:1024
    v_add_u32 v4, 256, v0
    v_mul_u32_u24 v5, 9363, v4
    v_lshrrev_b32 v5, 19, v5
    v_add_lshl_u32 v4, v4, v5, 4
    s_waitcnt vmcnt(26)
    ds_write_b128 v4, v[132:135] offset:1024
    v_add_u32 v4, 512, v0
    v_mul_u32_u24 v5, 9363, v4
    v_lshrrev_b32 v5, 19, v5
    v_add_lshl_u32 v4, v4, v5, 4
    s_waitcnt vmcnt(25)
    ds_write_b128 v4, v[136:139] offset:1024
    v_add_u32 v4, 768, v0
    v_mul_u32_u24 v5, 9363, v4
    v_lshrrev_b32 v5, 19, v5
    v_add_lshl_u32 v4, v4, v5, 4
    s_waitcnt vmcnt(24)
    ds_write_b128 v4, v[140:143] offset:1024
    v_add_u32 v4, 1024, v0
    v_mul_u32_u24 v5, 9363, v4
    v_lshrrev_b32 v5, 19, v5
    v_add_lshl_u32 v4, v4, v5, 4
    s_waitcnt vmcnt(23)
    ds_write_b128 v4, v[144:147] offset:1024
    v_add_u32 v4, 1280, v0
    v_mul_u32_u24 v5, 9363, v4
    v_lshrrev_b32 v5, 19, v5
    v_add_lshl_u32 v4, v4, v5, 4
    s_waitcnt vmcnt(22)
    ds_write_b128 v4, v[148:151] offset:1024
    v_add_u32 v4, 1536, v0
    v_mul_u32_u24 v5, 9363, v4
    v_lshrrev_b32 v5, 19, v5
    v_add_lshl_u32 v4, v4, v5, 4
    s_waitcnt vmcnt(21)
    ds_write_b128 v4, v[152:155] offset:1024
    s_waitcnt lgkmcnt(0)
    v_add_u32 v7, s34, v0
    v_and_b32 v7, 2047, v7
    v_mul_u32_u24 v7, 112, v7
    buffer_load_dwordx4 v[128:131], v7, s[20:23], 0 offen offset:0
    buffer_load_dwordx4 v[132:135], v7, s[20:23], 0 offen offset:16
    buffer_load_dwordx4 v[136:139], v7, s[20:23], 0 offen offset:32
    buffer_load_dwordx4 v[140:143], v7, s[20:23], 0 offen offset:48
    buffer_load_dwordx4 v[144:147], v7, s[20:23], 0 offen offset:64
    buffer_load_dwordx4 v[148:151], v7, s[20:23], 0 offen offset:80
    buffer_load_dwordx4 v[152:155], v7, s[20:23], 0 offen offset:96
    v_add_u32 v4, 1792, v0
    v_mul_u32_u24 v5, 9363, v4
    v_lshrrev_b32 v5, 19, v5
    v_add_lshl_u32 v4, v4, v5, 4
    s_waitcnt vmcnt(27)
    ds_write_b128 v4, v[156:159] offset:1024
    v_add_u32 v4, 2048, v0
    v_mul_u32_u24 v5, 9363, v4
    v_lshrrev_b32 v5, 19, v5
    v_add_lshl_u32 v4, v4, v5, 4
    s_waitcnt vmcnt(26)
    ds_write_b128 v4, v[160:163] offset:1024
    v_add_u32 v4, 2304, v0
    v_mul_u32_u24 v5, 9363, v4
    v_lshrrev_b32 v5, 19, v5
    v_add_lshl_u32 v4, v4, v5, 4
    s_waitcnt vmcnt(25)
    ds_write_b128 v4, v[164:167] offset:1024
    v_add_u32 v4, 2560, v0
    v_mul_u32_u24 v5, 9363, v4
    v_lshrrev_b32 v5, 19, v5
    v_add_lshl_u32 v4, v4, v5, 4
    s_waitcnt vmcnt(24)
    ds_write_b128 v4, v[168:171] offset:1024
    v_add_u32 v4, 2816, v0
    v_mul_u32_u24 v5, 9363, v4
    v_lshrrev_b32 v5, 19, v5
    v_add_lshl_u32 v4, v4, v5, 4
    s_waitcnt vmcnt(23)
    ds_write_b128 v4, v[172:175] offset:1024
    v_add_u32 v4, 3072, v0
    v_mul_u32_u24 v5, 9363, v4
    v_lshrrev_b32 v5, 19, v5
    v_add_lshl_u32 v4, v4, v5, 4
    s_waitcnt vmcnt(22)
    ds_write_b128 v4, v[176:179] offset:1024
    v_add_u32 v4, 3328, v0
    v_mul_u32_u24 v5, 9363, v4
    v_lshrrev_b32 v5, 19, v5
    v_add_lshl_u32 v4, v4, v5, 4
    s_waitcnt vmcnt(21)
    ds_write_b128 v4, v[180:183] offset:1024
    v_add_u32 v4, 3584, v0
    v_mul_u32_u24 v5, 9363, v4
    v_lshrrev_b32 v5, 19, v5
    v_add_lshl_u32 v4, v4, v5, 4
    s_waitcnt vmcnt(20)
    ds_write_b128 v4, v[184:187] offset:1024
    v_add_u32 v4, 3840, v0
    v_mul_u32_u24 v5, 9363, v4
    v_lshrrev_b32 v5, 19, v5
    v_add_lshl_u32 v4, v4, v5, 4
    s_waitcnt vmcnt(19)
    ds_write_b128 v4, v[188:191] offset:1024
    v_add_u32 v4, 4096, v0
    v_mul_u32_u24 v5, 9363, v4
    v_lshrrev_b32 v5, 19, v5
    v_add_lshl_u32 v4, v4, v5, 4
    s_waitcnt vmcnt(18)
    ds_write_b128 v4, v[192:195] offset:1024
    v_add_u32 v4, 4352, v0
    v_mul_u32_u24 v5, 9363, v4
    v_lshrrev_b32 v5, 19, v5
    v_add_lshl_u32 v4, v4, v5, 4
    s_waitcnt vmcnt(17)
    ds_write_b128 v4, v[196:199] offset:1024
    v_add_u32 v4, 4608, v0
    v_mul_u32_u24 v5, 9363, v4
    v_lshrrev_b32 v5, 19, v5
    v_add_lshl_u32 v4, v4, v5, 4
    s_waitcnt vmcnt(16)
    ds_write_b128 v4, v[200:203] offset:1024
    v_add_u32 v4, 4864, v0
    v_mul_u32_u24 v5, 9363, v4
    v_lshrrev_b32 v5, 19, v5
    v_add_lshl_u32 v4, v4, v5, 4
    s_waitcnt vmcnt(15)
    ds_write_b128 v4, v[204:207] offset:1024
    v_add_u32 v4, 5120, v0
    v_mul_u32_u24 v5, 9363, v4
    v_lshrrev_b32 v5, 19, v5
    v_add_lshl_u32 v4, v4, v5, 4
    s_waitcnt vmcnt(14)
    ds_write_b128 v4, v[208:211] offset:1024
    v_add_u32 v4, 5376, v0
    v_mul_u32_u24 v5, 9363, v4
    v_lshrrev_b32 v5, 19, v5
    v_add_lshl_u32 v4, v4, v5, 4
    s_waitcnt vmcnt(13)
    ds_write_b128 v4, v[212:215] offset:1024
    v_add_u32 v4, 5632, v0
    v_mul_u32_u24 v5, 9363, v4
    v_lshrrev_b32 v5, 19, v5
    v_add_lshl_u32 v4, v4, v5, 4
    s_waitcnt vmcnt(12)
    ds_write_b128 v4, v[216:219] offset:1024
    v_add_u32 v4, 5888, v0
    v_mul_u32_u24 v5, 9363, v4
    v_lshrrev_b32 v5, 19, v5
    v_add_lshl_u32 v4, v4, v5, 4
    s_waitcnt vmcnt(11)
    ds_write_b128 v4, v[220:223] offset:1024
    v_add_u32 v4, 6144, v0
    v_mul_u32_u24 v5, 9363, v4
    v_lshrrev_b32 v5, 19, v5
    v_add_lshl_u32 v4, v4, v5, 4
    s_waitcnt vmcnt(10)
    ds_write_b128 v4, v[224:227] offset:1024
    v_add_u32 v4, 6400, v0
    v_mul_u32_u24 v5, 9363, v4
    v_lshrrev_b32 v5, 19, v5
    v_add_lshl_u32 v4, v4, v5, 4
    s_waitcnt vmcnt(9)
    ds_write_b128 v4, v[228:231] offset:1024
    v_add_u32 v4, 6656, v0
    v_mul_u32_u24 v5, 9363, v4
    v_lshrrev_b32 v5, 19, v5
    v_add_lshl_u32 v4, v4, v5, 4
    s_waitcnt vmcnt(8)
    ds_write_b128 v4, v[232:235] offset:1024
    v_add_u32 v4, 6912, v0
    v_mul_u32_u24 v5, 9363, v4
    v_lshrrev_b32 v5, 19, v5
    v_add_lshl_u32 v4, v4, v5, 4
    s_waitcnt vmcnt(7)
    ds_write_b128 v4, v[236:239] offset:1024
    v_cmp_gt_u32 vcc, 128, v0
    s_and_saveexec_b64 s[42:43], vcc
    s_cbranch_execz k1a_kernel_st2
    v_mov_b32 v5, 0
    v_mov_b32 v6, 0
    s_waitcnt vmcnt(6)
    v_add_f32 v5, v5, v128
    v_add_f32 v6, v6, v129
    v_add_f32 v5, v5, v130
    v_add_f32 v6, v6, v131
    s_waitcnt vmcnt(5)
    v_add_f32 v5, v5, v132
    v_add_f32 v6, v6, v133
    v_add_f32 v5, v5, v134
    v_add_f32 v6, v6, v135
    s_waitcnt vmcnt(4)
    v_add_f32 v5, v5, v136
    v_add_f32 v6, v6, v137
    v_add_f32 v5, v5, v138
    v_add_f32 v6, v6, v139
    s_waitcnt vmcnt(3)
    v_add_f32 v5, v5, v140
    v_add_f32 v6, v6, v141
    v_add_f32 v5, v5, v142
    v_add_f32 v6, v6, v143
    s_waitcnt vmcnt(2)
    v_add_f32 v5, v5, v144
    v_add_f32 v6, v6, v145
    v_add_f32 v5, v5, v146
    v_add_f32 v6, v6, v147
    s_waitcnt vmcnt(1)
    v_add_f32 v5, v5, v148
    v_add_f32 v6, v6, v149
    v_add_f32 v5, v5, v150
    v_add_f32 v6, v6, v151
    s_waitcnt vmcnt(0)
    v_add_f32 v5, v5, v152
    v_add_f32 v6, v6, v153
    v_add_f32 v5, v5, v154
    v_add_f32 v6, v6, v155
    v_mul_f32 v5, 0.002232142857142857, v5
    v_mul_f32 v6, 0.002232142857142857, v6
    v_fma_f32 v6, -v5, v5, v6
    v_max_f32 v6, 0, v6
    v_add_f32 v6, 1e-05, v6
    v_rsq_f32 v6, v6
    s_nop 0
    v_mul_f32 v5, v5, v6
    v_lshlrev_b32 v4, 2, v0
    ds_write_b32 v4, v6 offset:0
    ds_write_b32 v4, v5 offset:512
k1a_kernel_st2:
    s_waitcnt vmcnt(0)
    s_mov_b64 exec, s[42:43]
    s_waitcnt lgkmcnt(0)
    s_barrier
    v_and_b32 v3, 31, v1
    v_mul_u32_u24 v3, 912, v3
    v_lshrrev_b32 v4, 5, v1
    v_lshl_add_u32 v8, v4, 4, v3
    v_add_u32 v9, 58368, v8
    s_cmp_ge_u32 s30, 8
    s_cbranch_scc1 k1a_kernel_vpath3
    ds_read_b128 v[192:195], v8 offset:1024
    ds_read_b128 v[196:199], v8 offset:30208
    ds_read_b128 v[200:203], v9 offset:1024
    ds_read_b128 v[204:207], v9 offset:30208
    ds_read_b128 v[208:211], v8 offset:1056
    ds_read_b128 v[212:215], v8 offset:30240
    ds_read_b128 v[216:219], v9 offset:1056
    ds_read_b128 v[220:223], v9 offset:30240
    s_waitcnt lgkmcnt(7)
    v_mfma_f32_32x32x16_bf16 v[128:143], v[16:19], v[192:195], 0
    s_waitcnt lgkmcnt(6)
    v_mfma_f32_32x32x16_bf16 v[144:159], v[16:19], v[196:199], 0
    s_waitcnt lgkmcnt(5)
    v_mfma_f32_32x32x16_bf16 v[160:175], v[16:19], v[200:203], 0
    s_waitcnt lgkmcnt(4)
    v_mfma_f32_32x32x16_bf16 v[176:191], v[16:19], v[204:207], 0
    ds_read_b128 v[192:195], v8 offset:1088
    ds_read_b128 v[196:199], v8 offset:30272
    ds_read_b128 v[200:203], v9 offset:1088
    ds_read_b128 v[204:207], v9 offset:30272
    s_waitcnt lgkmcnt(7)
    v_mfma_f32_32x32x16_bf16 v[128:143], v[20:23], v[208:211], v[128:143]
    s_waitcnt lgkmcnt(6)
    v_mfma_f32_32x32x16_bf16 v[144:159], v[20:23], v[212:215], v[144:159]
    s_waitcnt lgkmcnt(5)
    v_mfma_f32_32x32x16_bf16 v[160:175], v[20:23], v[216:219], v[160:175]
    s_waitcnt lgkmcnt(4)
    v_mfma_f32_32x32x16_bf16 v[176:191], v[20:23], v[220:223], v[176:191]
    ds_read_b128 v[208:211], v8 offset:1120
    ds_read_b128 v[212:215], v8 offset:30304
    ds_read_b128 v[216:219], v9 offset:1120
    ds_read_b128 v[220:223], v9 offset:30304
    s_waitcnt lgkmcnt(7)
    v_mfma_f32_32x32x16_bf16 v[128:143], v[24:27], v[192:195], v[128:143]
    s_waitcnt lgkmcnt(6)
    v_mfma_f32_32x32x16_bf16 v[144:159], v[24:27], v[196:199], v[144:159]
    s_waitcnt lgkmcnt(5)
    v_mfma_f32_32x32x16_bf16 v[160:175], v[24:27], v[200:203], v[160:175]
    s_waitcnt lgkmcnt(4)
    v_mfma_f32_32x32x16_bf16 v[176:191], v[24:27], v[204:207], v[176:191]
    ds_read_b128 v[192:195], v8 offset:1152
    ds_read_b128 v[196:199], v8 offset:30336
    ds_read_b128 v[200:203], v9 offset:1152
    ds_read_b128 v[204:207], v9 offset:30336
    s_waitcnt lgkmcnt(7)
    v_mfma_f32_32x32x16_bf16 v[128:143], v[28:31], v[208:211], v[128:143]
    s_waitcnt lgkmcnt(6)
    v_mfma_f32_32x32x16_bf16 v[144:159], v[28:31], v[212:215], v[144:159]
    s_waitcnt lgkmcnt(5)
    v_mfma_f32_32x32x16_bf16 v[160:175], v[28:31], v[216:219], v[160:175]
    s_waitcnt lgkmcnt(4)
    v_mfma_f32_32x32x16_bf16 v[176:191], v[28:31], v[220:223], v[176:191]
    ds_read_b128 v[208:211], v8 offset:1184
    ds_read_b128 v[212:215], v8 offset:30368
    ds_read_b128 v[216:219], v9 offset:1184
    ds_read_b128 v[220:223], v9 offset:30368
    s_waitcnt lgkmcnt(7)
    v_mfma_f32_32x32x16_bf16 v[128:143], v[32:35], v[192:195], v[128:143]
    s_waitcnt lgkmcnt(6)
    v_mfma_f32_32x32x16_bf16 v[144:159], v[32:35], v[196:199], v[144:159]
    s_waitcnt lgkmcnt(5)
    v_mfma_f32_32x32x16_bf16 v[160:175], v[32:35], v[200:203], v[160:175]
    s_waitcnt lgkmcnt(4)
    v_mfma_f32_32x32x16_bf16 v[176:191], v[32:35], v[204:207], v[176:191]
    ds_read_b128 v[192:195], v8 offset:1216
    ds_read_b128 v[196:199], v8 offset:30400
    ds_read_b128 v[200:203], v9 offset:1216
    ds_read_b128 v[204:207], v9 offset:30400
    s_waitcnt lgkmcnt(7)
    v_mfma_f32_32x32x16_bf16 v[128:143], v[36:39], v[208:211], v[128:143]
    s_waitcnt lgkmcnt(6)
    v_mfma_f32_32x32x16_bf16 v[144:159], v[36:39], v[212:215], v[144:159]
    s_waitcnt lgkmcnt(5)
    v_mfma_f32_32x32x16_bf16 v[160:175], v[36:39], v[216:219], v[160:175]
    s_waitcnt lgkmcnt(4)
    v_mfma_f32_32x32x16_bf16 v[176:191], v[36:39], v[220:223], v[176:191]
    ds_read_b128 v[208:211], v8 offset:1248
    ds_read_b128 v[212:215], v8 offset:30432
    ds_read_b128 v[216:219], v9 offset:1248
    ds_read_b128 v[220:223], v9 offset:30432
    s_waitcnt lgkmcnt(7)
    v_mfma_f32_32x32x16_bf16 v[128:143], v[40:43], v[192:195], v[128:143]
    s_waitcnt lgkmcnt(6)
    v_mfma_f32_32x32x16_bf16 v[144:159], v[40:43], v[196:199], v[144:159]
    s_waitcnt lgkmcnt(5)
    v_mfma_f32_32x32x16_bf16 v[160:175], v[40:43], v[200:203], v[160:175]
    s_waitcnt lgkmcnt(4)
    v_mfma_f32_32x32x16_bf16 v[176:191], v[40:43], v[204:207], v[176:191]
    ds_read_b128 v[192:195], v8 offset:1280
    ds_read_b128 v[196:199], v8 offset:30464
    ds_read_b128 v[200:203], v9 offset:1280
    ds_read_b128 v[204:207], v9 offset:30464
    s_waitcnt lgkmcnt(7)
    v_mfma_f32_32x32x16_bf16 v[128:143], v[44:47], v[208:211], v[128:143]
    s_waitcnt lgkmcnt(6)
    v_mfma_f32_32x32x16_bf16 v[144:159], v[44:47], v[212:215], v[144:159]
    s_waitcnt lgkmcnt(5)
    v_mfma_f32_32x32x16_bf16 v[160:175], v[44:47], v[216:219], v[160:175]
    s_waitcnt lgkmcnt(4)
    v_mfma_f32_32x32x16_bf16 v[176:191], v[44:47], v[220:223], v[176:191]
    ds_read_b128 v[208:211], v8 offset:1312
    ds_read_b128 v[212:215], v8 offset:30496
    ds_read_b128 v[216:219], v9 offset:1312
    ds_read_b128 v[220:223], v9 offset:30496
    s_waitcnt lgkmcnt(7)
    v_mfma_f32_32x32x16_bf16 v[128:143], v[48:51], v[192:195], v[128:143]
    s_waitcnt lgkmcnt(6)
    v_mfma_f32_32x32x16_bf16 v[144:159], v[48:51], v[196:199], v[144:159]
    s_waitcnt lgkmcnt(5)
    v_mfma_f32_32x32x16_bf16 v[160:175], v[48:51], v[200:203], v[160:175]
    s_waitcnt lgkmcnt(4)
    v_mfma_f32_32x32x16_bf16 v[176:191], v[48:51], v[204:207], v[176:191]
    ds_read_b128 v[192:195], v8 offset:1344
    ds_read_b128 v[196:199], v8 offset:30528
    ds_read_b128 v[200:203], v9 offset:1344
    ds_read_b128 v[204:207], v9 offset:30528
    s_waitcnt lgkmcnt(7)
    v_mfma_f32_32x32x16_bf16 v[128:143], v[52:55], v[208:211], v[128:143]
    s_waitcnt lgkmcnt(6)
    v_mfma_f32_32x32x16_bf16 v[144:159], v[52:55], v[212:215], v[144:159]
    s_waitcnt lgkmcnt(5)
    v_mfma_f32_32x32x16_bf16 v[160:175], v[52:55], v[216:219], v[160:175]
    s_waitcnt lgkmcnt(4)
    v_mfma_f32_32x32x16_bf16 v[176:191], v[52:55], v[220:223], v[176:191]
    ds_read_b128 v[208:211], v8 offset:1376
    ds_read_b128 v[212:215], v8 offset:30560
    ds_read_b128 v[216:219], v9 offset:1376
    ds_read_b128 v[220:223], v9 offset:30560
    s_waitcnt lgkmcnt(7)
    v_mfma_f32_32x32x16_bf16 v[128:143], v[56:59], v[192:195], v[128:143]
    s_waitcnt lgkmcnt(6)
    v_mfma_f32_32x32x16_bf16 v[144:159], v[56:59], v[196:199], v[144:159]
    s_waitcnt lgkmcnt(5)
    v_mfma_f32_32x32x16_bf16 v[160:175], v[56:59], v[200:203], v[160:175]
    s_waitcnt lgkmcnt(4)
    v_mfma_f32_32x32x16_bf16 v[176:191], v[56:59], v[204:207], v[176:191]
    ds_read_b128 v[192:195], v8 offset:1408
    ds_read_b128 v[196:199], v8 offset:30592
    ds_read_b128 v[200:203], v9 offset:1408
    ds_read_b128 v[204:207], v9 offset:30592
    s_waitcnt lgkmcnt(7)
    v_mfma_f32_32x32x16_bf16 v[128:143], v[60:63], v[208:211], v[128:143]
    s_waitcnt lgkmcnt(6)
    v_mfma_f32_32x32x16_bf16 v[144:159], v[60:63], v[212:215], v[144:159]
    s_waitcnt lgkmcnt(5)
    v_mfma_f32_32x32x16_bf16 v[160:175], v[60:63], v[216:219], v[160:175]
    s_waitcnt lgkmcnt(4)
    v_mfma_f32_32x32x16_bf16 v[176:191], v[60:63], v[220:223], v[176:191]
    ds_read_b128 v[208:211], v8 offset:1440
    ds_read_b128 v[212:215], v8 offset:30624
    ds_read_b128 v[216:219], v9 offset:1440
    ds_read_b128 v[220:223], v9 offset:30624
    s_waitcnt lgkmcnt(7)
    v_mfma_f32_32x32x16_bf16 v[128:143], v[64:67], v[192:195], v[128:143]
    s_waitcnt lgkmcnt(6)
    v_mfma_f32_32x32x16_bf16 v[144:159], v[64:67], v[196:199], v[144:159]
    s_waitcnt lgkmcnt(5)
    v_mfma_f32_32x32x16_bf16 v[160:175], v[64:67], v[200:203], v[160:175]
    s_waitcnt lgkmcnt(4)
    v_mfma_f32_32x32x16_bf16 v[176:191], v[64:67], v[204:207], v[176:191]
    ds_read_b128 v[192:195], v8 offset:1472
    ds_read_b128 v[196:199], v8 offset:30656
    ds_read_b128 v[200:203], v9 offset:1472
    ds_read_b128 v[204:207], v9 offset:30656
    s_waitcnt lgkmcnt(7)
    v_mfma_f32_32x32x16_bf16 v[128:143], v[68:71], v[208:211], v[128:143]
    s_waitcnt lgkmcnt(6)
    v_mfma_f32_32x32x16_bf16 v[144:159], v[68:71], v[212:215], v[144:159]
    s_waitcnt lgkmcnt(5)
    v_mfma_f32_32x32x16_bf16 v[160:175], v[68:71], v[216:219], v[160:175]
    s_waitcnt lgkmcnt(4)
    v_mfma_f32_32x32x16_bf16 v[176:191], v[68:71], v[220:223], v[176:191]
    ds_read_b128 v[208:211], v8 offset:1504
    ds_read_b128 v[212:215], v8 offset:30688
    ds_read_b128 v[216:219], v9 offset:1504
    ds_read_b128 v[220:223], v9 offset:30688
    s_waitcnt lgkmcnt(7)
    v_mfma_f32_32x32x16_bf16 v[128:143], v[72:75], v[192:195], v[128:143]
    s_waitcnt lgkmcnt(6)
    v_mfma_f32_32x32x16_bf16 v[144:159], v[72:75], v[196:199], v[144:159]
    s_waitcnt lgkmcnt(5)
    v_mfma_f32_32x32x16_bf16 v[160:175], v[72:75], v[200:203], v[160:175]
    s_waitcnt lgkmcnt(4)
    v_mfma_f32_32x32x16_bf16 v[176:191], v[72:75], v[204:207], v[176:191]
    ds_read_b128 v[192:195], v8 offset:1536
    ds_read_b128 v[196:199], v8 offset:30720
    ds_read_b128 v[200:203], v9 offset:1536
    ds_read_b128 v[204:207], v9 offset:30720
    s_waitcnt lgkmcnt(7)
    v_mfma_f32_32x32x16_bf16 v[128:143], v[76:79], v[208:211], v[128:143]
    s_waitcnt lgkmcnt(6)
    v_mfma_f32_32x32x16_bf16 v[144:159], v[76:79], v[212:215], v[144:159]
    s_waitcnt lgkmcnt(5)
    v_mfma_f32_32x32x16_bf16 v[160:175], v[76:79], v[216:219], v[160:175]
    s_waitcnt lgkmcnt(4)
    v_mfma_f32_32x32x16_bf16 v[176:191], v[76:79], v[220:223], v[176:191]
    ds_read_b128 v[208:211], v8 offset:1568
    ds_read_b128 v[212:215], v8 offset:30752
    ds_read_b128 v[216:219], v9 offset:1568
    ds_read_b128 v[220:223], v9 offset:30752
    s_waitcnt lgkmcnt(7)
    v_mfma_f32_32x32x16_bf16 v[128:143], v[80:83], v[192:195], v[128:143]
    s_waitcnt lgkmcnt(6)
    v_mfma_f32_32x32x16_bf16 v[144:159], v[80:83], v[196:199], v[144:159]
    s_waitcnt lgkmcnt(5)
    v_mfma_f32_32x32x16_bf16 v[160:175], v[80:83], v[200:203], v[160:175]
    s_waitcnt lgkmcnt(4)
    v_mfma_f32_32x32x16_bf16 v[176:191], v[80:83], v[204:207], v[176:191]
    ds_read_b128 v[192:195], v8 offset:1600
    ds_read_b128 v[196:199], v8 offset:30784
    ds_read_b128 v[200:203], v9 offset:1600
    ds_read_b128 v[204:207], v9 offset:30784
    s_waitcnt lgkmcnt(7)
    v_mfma_f32_32x32x16_bf16 v[128:143], v[84:87], v[208:211], v[128:143]
    s_waitcnt lgkmcnt(6)
    v_mfma_f32_32x32x16_bf16 v[144:159], v[84:87], v[212:215], v[144:159]
    s_waitcnt lgkmcnt(5)
    v_mfma_f32_32x32x16_bf16 v[160:175], v[84:87], v[216:219], v[160:175]
    s_waitcnt lgkmcnt(4)
    v_mfma_f32_32x32x16_bf16 v[176:191], v[84:87], v[220:223], v[176:191]
    ds_read_b128 v[208:211], v8 offset:1632
    ds_read_b128 v[212:215], v8 offset:30816
    ds_read_b128 v[216:219], v9 offset:1632
    ds_read_b128 v[220:223], v9 offset:30816
    s_waitcnt lgkmcnt(7)
    v_mfma_f32_32x32x16_bf16 v[128:143], v[88:91], v[192:195], v[128:143]
    s_waitcnt lgkmcnt(6)
    v_mfma_f32_32x32x16_bf16 v[144:159], v[88:91], v[196:199], v[144:159]
    s_waitcnt lgkmcnt(5)
    v_mfma_f32_32x32x16_bf16 v[160:175], v[88:91], v[200:203], v[160:175]
    s_waitcnt lgkmcnt(4)
    v_mfma_f32_32x32x16_bf16 v[176:191], v[88:91], v[204:207], v[176:191]
    ds_read_b128 v[192:195], v8 offset:1664
    ds_read_b128 v[196:199], v8 offset:30848
    ds_read_b128 v[200:203], v9 offset:1664
    ds_read_b128 v[204:207], v9 offset:30848
    s_waitcnt lgkmcnt(7)
    v_mfma_f32_32x32x16_bf16 v[128:143], v[92:95], v[208:211], v[128:143]
    s_waitcnt lgkmcnt(6)
    v_mfma_f32_32x32x16_bf16 v[144:159], v[92:95], v[212:215], v[144:159]
    s_waitcnt lgkmcnt(5)
    v_mfma_f32_32x32x16_bf16 v[160:175], v[92:95], v[216:219], v[160:175]
    s_waitcnt lgkmcnt(4)
    v_mfma_f32_32x32x16_bf16 v[176:191], v[92:95], v[220:223], v[176:191]
    ds_read_b128 v[208:211], v8 offset:1696
    ds_read_b128 v[212:215], v8 offset:30880
    ds_read_b128 v[216:219], v9 offset:1696
    ds_read_b128 v[220:223], v9 offset:30880
    s_waitcnt lgkmcnt(7)
    v_mfma_f32_32x32x16_bf16 v[128:143], v[96:99], v[192:195], v[128:143]
    s_waitcnt lgkmcnt(6)
    v_mfma_f32_32x32x16_bf16 v[144:159], v[96:99], v[196:199], v[144:159]
    s_waitcnt lgkmcnt(5)
    v_mfma_f32_32x32x16_bf16 v[160:175], v[96:99], v[200:203], v[160:175]
    s_waitcnt lgkmcnt(4)
    v_mfma_f32_32x32x16_bf16 v[176:191], v[96:99], v[204:207], v[176:191]
    ds_read_b128 v[192:195], v8 offset:1728
    ds_read_b128 v[196:199], v8 offset:30912
    ds_read_b128 v[200:203], v9 offset:1728
    ds_read_b128 v[204:207], v9 offset:30912
    s_waitcnt lgkmcnt(7)
    v_mfma_f32_32x32x16_bf16 v[128:143], v[100:103], v[208:211], v[128:143]
    s_waitcnt lgkmcnt(6)
    v_mfma_f32_32x32x16_bf16 v[144:159], v[100:103], v[212:215], v[144:159]
    s_waitcnt lgkmcnt(5)
    v_mfma_f32_32x32x16_bf16 v[160:175], v[100:103], v[216:219], v[160:175]
    s_waitcnt lgkmcnt(4)
    v_mfma_f32_32x32x16_bf16 v[176:191], v[100:103], v[220:223], v[176:191]
    ds_read_b128 v[208:211], v8 offset:1760
    ds_read_b128 v[212:215], v8 offset:30944
    ds_read_b128 v[216:219], v9 offset:1760
    ds_read_b128 v[220:223], v9 offset:30944
    s_waitcnt lgkmcnt(7)
    v_mfma_f32_32x32x16_bf16 v[128:143], v[104:107], v[192:195], v[128:143]
    s_waitcnt lgkmcnt(6)
    v_mfma_f32_32x32x16_bf16 v[144:159], v[104:107], v[196:199], v[144:159]
    s_waitcnt lgkmcnt(5)
    v_mfma_f32_32x32x16_bf16 v[160:175], v[104:107], v[200:203], v[160:175]
    s_waitcnt lgkmcnt(4)
    v_mfma_f32_32x32x16_bf16 v[176:191], v[104:107], v[204:207], v[176:191]
    ds_read_b128 v[192:195], v8 offset:1792
    ds_read_b128 v[196:199], v8 offset:30976
    ds_read_b128 v[200:203], v9 offset:1792
    ds_read_b128 v[204:207], v9 offset:30976
    s_waitcnt lgkmcnt(7)
    v_mfma_f32_32x32x16_bf16 v[128:143], v[108:111], v[208:211], v[128:143]
    s_waitcnt lgkmcnt(6)
    v_mfma_f32_32x32x16_bf16 v[144:159], v[108:111], v[212:215], v[144:159]
    s_waitcnt lgkmcnt(5)
    v_mfma_f32_32x32x16_bf16 v[160:175], v[108:111], v[216:219], v[160:175]
    s_waitcnt lgkmcnt(4)
    v_mfma_f32_32x32x16_bf16 v[176:191], v[108:111], v[220:223], v[176:191]
    ds_read_b128 v[208:211], v8 offset:1824
    ds_read_b128 v[212:215], v8 offset:31008
    ds_read_b128 v[216:219], v9 offset:1824
    ds_read_b128 v[220:223], v9 offset:31008
    s_waitcnt lgkmcnt(7)
    v_mfma_f32_32x32x16_bf16 v[128:143], v[112:115], v[192:195], v[128:143]
    s_waitcnt lgkmcnt(6)
    v_mfma_f32_32x32x16_bf16 v[144:159], v[112:115], v[196:199], v[144:159]
    s_waitcnt lgkmcnt(5)
    v_mfma_f32_32x32x16_bf16 v[160:175], v[112:115], v[200:203], v[160:175]
    s_waitcnt lgkmcnt(4)
    v_mfma_f32_32x32x16_bf16 v[176:191], v[112:115], v[204:207], v[176:191]
    ds_read_b128 v[192:195], v8 offset:1856
    ds_read_b128 v[196:199], v8 offset:31040
    ds_read_b128 v[200:203], v9 offset:1856
    ds_read_b128 v[204:207], v9 offset:31040
    s_waitcnt lgkmcnt(7)
    v_mfma_f32_32x32x16_bf16 v[128:143], v[116:119], v[208:211], v[128:143]
    s_waitcnt lgkmcnt(6)
    v_mfma_f32_32x32x16_bf16 v[144:159], v[116:119], v[212:215], v[144:159]
    s_waitcnt lgkmcnt(5)
    v_mfma_f32_32x32x16_bf16 v[160:175], v[116:119], v[216:219], v[160:175]
    s_waitcnt lgkmcnt(4)
    v_mfma_f32_32x32x16_bf16 v[176:191], v[116:119], v[220:223], v[176:191]
    ds_read_b128 v[208:211], v8 offset:1888
    ds_read_b128 v[212:215], v8 offset:31072
    ds_read_b128 v[216:219], v9 offset:1888
    ds_read_b128 v[220:223], v9 offset:31072
    s_waitcnt lgkmcnt(7)
    v_mfma_f32_32x32x16_bf16 v[128:143], v[120:123], v[192:195], v[128:143]
    s_waitcnt lgkmcnt(6)
    v_mfma_f32_32x32x16_bf16 v[144:159], v[120:123], v[196:199], v[144:159]
    s_waitcnt lgkmcnt(5)
    v_mfma_f32_32x32x16_bf16 v[160:175], v[120:123], v[200:203], v[160:175]
    s_waitcnt lgkmcnt(4)
    v_mfma_f32_32x32x16_bf16 v[176:191], v[120:123], v[204:207], v[176:191]
    s_waitcnt lgkmcnt(3)
    v_mfma_f32_32x32x16_bf16 v[128:143], v[124:127], v[208:211], v[128:143]
    s_waitcnt lgkmcnt(2)
    v_mfma_f32_32x32x16_bf16 v[144:159], v[124:127], v[212:215], v[144:159]
    s_waitcnt lgkmcnt(1)
    v_mfma_f32_32x32x16_bf16 v[160:175], v[124:127], v[216:219], v[160:175]
    s_waitcnt lgkmcnt(0)
    v_mfma_f32_32x32x16_bf16 v[176:191], v[124:127], v[220:223], v[176:191]
    s_cmp_lt_u32 s30, 4
    s_mov_b32 s36, 10485760
    s_cselect_b32 s36, 8388608, s36
    s_add_u32 s28, s4, s36
    s_addc_u32 s29, s5, 0
    s_mov_b32 s30, 2097152
    s_mov_b32 s31, 0x00020000
    s_and_b32 s36, s33, 15
    s_lshl_b32 s36, s36, 17
    v_lshrrev_b32 v4, 5, v1
    v_lshlrev_b32 v4, 4, v4
    s_lshl_b32 s37, s33, 7
    buffer_load_dwordx4 v[16:19], v4, s[24:27], s37 offen offset:0
    buffer_load_dwordx4 v[20:23], v4, s[24:27], s37 offen offset:32
    buffer_load_dwordx4 v[24:27], v4, s[24:27], s37 offen offset:64
    buffer_load_dwordx4 v[28:31], v4, s[24:27], s37 offen offset:96
    v_and_b32 v5, 31, v1
    v_lshlrev_b32 v5, 2, v5
    ds_read_b32 v32, v5 offset:0
    ds_read_b32 v36, v5 offset:512
    ds_read_b32 v33, v5 offset:128
    ds_read_b32 v37, v5 offset:640
    ds_read_b32 v34, v5 offset:256
    ds_read_b32 v38, v5 offset:768
    ds_read_b32 v35, v5 offset:384
    ds_read_b32 v39, v5 offset:896
    s_cmp_lt_u32 s33, 16
    s_cselect_b32 s38, 0x3e8b97f6, 1.0
    s_waitcnt lgkmcnt(7)
    v_mul_f32 v32, s38, v32
    s_waitcnt lgkmcnt(6)
    v_mul_f32 v36, s38, v36
    s_waitcnt lgkmcnt(5)
    v_mul_f32 v33, s38, v33
    s_waitcnt lgkmcnt(4)
    v_mul_f32 v37, s38, v37
    s_waitcnt lgkmcnt(3)
    v_mul_f32 v34, s38, v34
    s_waitcnt lgkmcnt(2)
    v_mul_f32 v38, s38, v38
    s_waitcnt lgkmcnt(1)
    v_mul_f32 v35, s38, v35
    s_waitcnt lgkmcnt(0)
    v_mul_f32 v39, s38, v39
    v_and_b32 v5, 31, v1
    v_lshlrev_b32 v5, 4, v5
    v_lshrrev_b32 v6, 5, v1
    v_lshl_add_u32 v5, v6, 3, v5
    s_lshl_b32 s37, s34, 6
    s_add_u32 s36, s36, s37
    v_mul_f32 v128, v128, v32
    s_waitcnt vmcnt(3)
    v_fma_f32 v128, -v36, v16, v128
    v_mul_f32 v129, v129, v32
    v_fma_f32 v129, -v36, v17, v129
    v_mul_f32 v130, v130, v32
    v_fma_f32 v130, -v36, v18, v130
    v_mul_f32 v131, v131, v32
    v_fma_f32 v131, -v36, v19, v131
    v_cvt_pk_bf16_f32 v40, v128, v129
    v_cvt_pk_bf16_f32 v41, v130, v131
    buffer_store_dwordx2 v[40:41], v5, s[28:31], s36 offen offset:0
    v_mul_f32 v132, v132, v32
    s_waitcnt vmcnt(3)
    v_fma_f32 v132, -v36, v20, v132
    v_mul_f32 v133, v133, v32
    v_fma_f32 v133, -v36, v21, v133
    v_mul_f32 v134, v134, v32
    v_fma_f32 v134, -v36, v22, v134
    v_mul_f32 v135, v135, v32
    v_fma_f32 v135, -v36, v23, v135
    v_cvt_pk_bf16_f32 v40, v132, v133
    v_cvt_pk_bf16_f32 v41, v134, v135
    buffer_store_dwordx2 v[40:41], v5, s[28:31], s36 offen offset:512
    v_mul_f32 v136, v136, v32
    s_waitcnt vmcnt(3)
    v_fma_f32 v136, -v36, v24, v136
    v_mul_f32 v137, v137, v32
    v_fma_f32 v137, -v36, v25, v137
    v_mul_f32 v138, v138, v32
    v_fma_f32 v138, -v36, v26, v138
    v_mul_f32 v139, v139, v32
    v_fma_f32 v139, -v36, v27, v139
    v_cvt_pk_bf16_f32 v40, v136, v137
    v_cvt_pk_bf16_f32 v41, v138, v139
    buffer_store_dwordx2 v[40:41], v5, s[28:31], s36 offen offset:1024
    v_mul_f32 v140, v140, v32
    s_waitcnt vmcnt(3)
    v_fma_f32 v140, -v36, v28, v140
    v_mul_f32 v141, v141, v32
    v_fma_f32 v141, -v36, v29, v141
    v_mul_f32 v142, v142, v32
    v_fma_f32 v142, -v36, v30, v142
    v_mul_f32 v143, v143, v32
    v_fma_f32 v143, -v36, v31, v143
    v_cvt_pk_bf16_f32 v40, v140, v141
    v_cvt_pk_bf16_f32 v41, v142, v143
    buffer_store_dwordx2 v[40:41], v5, s[28:31], s36 offen offset:1536
    s_add_u32 s36, s36, 2048
    v_mul_f32 v144, v144, v33
    v_fma_f32 v144, -v37, v16, v144
    v_mul_f32 v145, v145, v33
    v_fma_f32 v145, -v37, v17, v145
    v_mul_f32 v146, v146, v33
    v_fma_f32 v146, -v37, v18, v146
    v_mul_f32 v147, v147, v33
    v_fma_f32 v147, -v37, v19, v147
    v_cvt_pk_bf16_f32 v40, v144, v145
    v_cvt_pk_bf16_f32 v41, v146, v147
    buffer_store_dwordx2 v[40:41], v5, s[28:31], s36 offen offset:0
    v_mul_f32 v148, v148, v33
    v_fma_f32 v148, -v37, v20, v148
    v_mul_f32 v149, v149, v33
    v_fma_f32 v149, -v37, v21, v149
    v_mul_f32 v150, v150, v33
    v_fma_f32 v150, -v37, v22, v150
    v_mul_f32 v151, v151, v33
    v_fma_f32 v151, -v37, v23, v151
    v_cvt_pk_bf16_f32 v40, v148, v149
    v_cvt_pk_bf16_f32 v41, v150, v151
    buffer_store_dwordx2 v[40:41], v5, s[28:31], s36 offen offset:512
    v_mul_f32 v152, v152, v33
    v_fma_f32 v152, -v37, v24, v152
    v_mul_f32 v153, v153, v33
    v_fma_f32 v153, -v37, v25, v153
    v_mul_f32 v154, v154, v33
    v_fma_f32 v154, -v37, v26, v154
    v_mul_f32 v155, v155, v33
    v_fma_f32 v155, -v37, v27, v155
    v_cvt_pk_bf16_f32 v40, v152, v153
    v_cvt_pk_bf16_f32 v41, v154, v155
    buffer_store_dwordx2 v[40:41], v5, s[28:31], s36 offen offset:1024
    v_mul_f32 v156, v156, v33
    v_fma_f32 v156, -v37, v28, v156
    v_mul_f32 v157, v157, v33
    v_fma_f32 v157, -v37, v29, v157
    v_mul_f32 v158, v158, v33
    v_fma_f32 v158, -v37, v30, v158
    v_mul_f32 v159, v159, v33
    v_fma_f32 v159, -v37, v31, v159
    v_cvt_pk_bf16_f32 v40, v156, v157
    v_cvt_pk_bf16_f32 v41, v158, v159
    buffer_store_dwordx2 v[40:41], v5, s[28:31], s36 offen offset:1536
    s_add_u32 s36, s36, 2048
    v_mul_f32 v160, v160, v34
    v_fma_f32 v160, -v38, v16, v160
    v_mul_f32 v161, v161, v34
    v_fma_f32 v161, -v38, v17, v161
    v_mul_f32 v162, v162, v34
    v_fma_f32 v162, -v38, v18, v162
    v_mul_f32 v163, v163, v34
    v_fma_f32 v163, -v38, v19, v163
    v_cvt_pk_bf16_f32 v40, v160, v161
    v_cvt_pk_bf16_f32 v41, v162, v163
    buffer_store_dwordx2 v[40:41], v5, s[28:31], s36 offen offset:0
    v_mul_f32 v164, v164, v34
    v_fma_f32 v164, -v38, v20, v164
    v_mul_f32 v165, v165, v34
    v_fma_f32 v165, -v38, v21, v165
    v_mul_f32 v166, v166, v34
    v_fma_f32 v166, -v38, v22, v166
    v_mul_f32 v167, v167, v34
    v_fma_f32 v167, -v38, v23, v167
    v_cvt_pk_bf16_f32 v40, v164, v165
    v_cvt_pk_bf16_f32 v41, v166, v167
    buffer_store_dwordx2 v[40:41], v5, s[28:31], s36 offen offset:512
    v_mul_f32 v168, v168, v34
    v_fma_f32 v168, -v38, v24, v168
    v_mul_f32 v169, v169, v34
    v_fma_f32 v169, -v38, v25, v169
    v_mul_f32 v170, v170, v34
    v_fma_f32 v170, -v38, v26, v170
    v_mul_f32 v171, v171, v34
    v_fma_f32 v171, -v38, v27, v171
    v_cvt_pk_bf16_f32 v40, v168, v169
    v_cvt_pk_bf16_f32 v41, v170, v171
    buffer_store_dwordx2 v[40:41], v5, s[28:31], s36 offen offset:1024
    v_mul_f32 v172, v172, v34
    v_fma_f32 v172, -v38, v28, v172
    v_mul_f32 v173, v173, v34
    v_fma_f32 v173, -v38, v29, v173
    v_mul_f32 v174, v174, v34
    v_fma_f32 v174, -v38, v30, v174
    v_mul_f32 v175, v175, v34
    v_fma_f32 v175, -v38, v31, v175
    v_cvt_pk_bf16_f32 v40, v172, v173
    v_cvt_pk_bf16_f32 v41, v174, v175
    buffer_store_dwordx2 v[40:41], v5, s[28:31], s36 offen offset:1536
    s_add_u32 s36, s36, 2048
    v_mul_f32 v176, v176, v35
    v_fma_f32 v176, -v39, v16, v176
    v_mul_f32 v177, v177, v35
    v_fma_f32 v177, -v39, v17, v177
    v_mul_f32 v178, v178, v35
    v_fma_f32 v178, -v39, v18, v178
    v_mul_f32 v179, v179, v35
    v_fma_f32 v179, -v39, v19, v179
    v_cvt_pk_bf16_f32 v40, v176, v177
    v_cvt_pk_bf16_f32 v41, v178, v179
    buffer_store_dwordx2 v[40:41], v5, s[28:31], s36 offen offset:0
    v_mul_f32 v180, v180, v35
    v_fma_f32 v180, -v39, v20, v180
    v_mul_f32 v181, v181, v35
    v_fma_f32 v181, -v39, v21, v181
    v_mul_f32 v182, v182, v35
    v_fma_f32 v182, -v39, v22, v182
    v_mul_f32 v183, v183, v35
    v_fma_f32 v183, -v39, v23, v183
    v_cvt_pk_bf16_f32 v40, v180, v181
    v_cvt_pk_bf16_f32 v41, v182, v183
    buffer_store_dwordx2 v[40:41], v5, s[28:31], s36 offen offset:512
    v_mul_f32 v184, v184, v35
    v_fma_f32 v184, -v39, v24, v184
    v_mul_f32 v185, v185, v35
    v_fma_f32 v185, -v39, v25, v185
    v_mul_f32 v186, v186, v35
    v_fma_f32 v186, -v39, v26, v186
    v_mul_f32 v187, v187, v35
    v_fma_f32 v187, -v39, v27, v187
    v_cvt_pk_bf16_f32 v40, v184, v185
    v_cvt_pk_bf16_f32 v41, v186, v187
    buffer_store_dwordx2 v[40:41], v5, s[28:31], s36 offen offset:1024
    v_mul_f32 v188, v188, v35
    v_fma_f32 v188, -v39, v28, v188
    v_mul_f32 v189, v189, v35
    v_fma_f32 v189, -v39, v29, v189
    v_mul_f32 v190, v190, v35
    v_fma_f32 v190, -v39, v30, v190
    v_mul_f32 v191, v191, v35
    v_fma_f32 v191, -v39, v31, v191
    v_cvt_pk_bf16_f32 v40, v188, v189
    v_cvt_pk_bf16_f32 v41, v190, v191
    buffer_store_dwordx2 v[40:41], v5, s[28:31], s36 offen offset:1536
    s_add_u32 s36, s36, 2048
    s_endpgm
k1a_kernel_vpath3:
    ds_read_b128 v[192:195], v8 offset:1024
    ds_read_b128 v[196:199], v8 offset:30208
    ds_read_b128 v[200:203], v9 offset:1024
    ds_read_b128 v[204:207], v9 offset:30208
    ds_read_b128 v[208:211], v8 offset:1056
    ds_read_b128 v[212:215], v8 offset:30240
    ds_read_b128 v[216:219], v9 offset:1056
    ds_read_b128 v[220:223], v9 offset:30240
    s_waitcnt lgkmcnt(7)
    v_mfma_f32_32x32x16_bf16 v[128:143], v[192:195], v[16:19], 0
    s_waitcnt lgkmcnt(6)
    v_mfma_f32_32x32x16_bf16 v[144:159], v[196:199], v[16:19], 0
    s_waitcnt lgkmcnt(5)
    v_mfma_f32_32x32x16_bf16 v[160:175], v[200:203], v[16:19], 0
    s_waitcnt lgkmcnt(4)
    v_mfma_f32_32x32x16_bf16 v[176:191], v[204:207], v[16:19], 0
    ds_read_b128 v[192:195], v8 offset:1088
    ds_read_b128 v[196:199], v8 offset:30272
    ds_read_b128 v[200:203], v9 offset:1088
    ds_read_b128 v[204:207], v9 offset:30272
    s_waitcnt lgkmcnt(7)
    v_mfma_f32_32x32x16_bf16 v[128:143], v[208:211], v[20:23], v[128:143]
    s_waitcnt lgkmcnt(6)
    v_mfma_f32_32x32x16_bf16 v[144:159], v[212:215], v[20:23], v[144:159]
    s_waitcnt lgkmcnt(5)
    v_mfma_f32_32x32x16_bf16 v[160:175], v[216:219], v[20:23], v[160:175]
    s_waitcnt lgkmcnt(4)
    v_mfma_f32_32x32x16_bf16 v[176:191], v[220:223], v[20:23], v[176:191]
    ds_read_b128 v[208:211], v8 offset:1120
    ds_read_b128 v[212:215], v8 offset:30304
    ds_read_b128 v[216:219], v9 offset:1120
    ds_read_b128 v[220:223], v9 offset:30304
    s_waitcnt lgkmcnt(7)
    v_mfma_f32_32x32x16_bf16 v[128:143], v[192:195], v[24:27], v[128:143]
    s_waitcnt lgkmcnt(6)
    v_mfma_f32_32x32x16_bf16 v[144:159], v[196:199], v[24:27], v[144:159]
    s_waitcnt lgkmcnt(5)
    v_mfma_f32_32x32x16_bf16 v[160:175], v[200:203], v[24:27], v[160:175]
    s_waitcnt lgkmcnt(4)
    v_mfma_f32_32x32x16_bf16 v[176:191], v[204:207], v[24:27], v[176:191]
    ds_read_b128 v[192:195], v8 offset:1152
    ds_read_b128 v[196:199], v8 offset:30336
    ds_read_b128 v[200:203], v9 offset:1152
    ds_read_b128 v[204:207], v9 offset:30336
    s_waitcnt lgkmcnt(7)
    v_mfma_f32_32x32x16_bf16 v[128:143], v[208:211], v[28:31], v[128:143]
    s_waitcnt lgkmcnt(6)
    v_mfma_f32_32x32x16_bf16 v[144:159], v[212:215], v[28:31], v[144:159]
    s_waitcnt lgkmcnt(5)
    v_mfma_f32_32x32x16_bf16 v[160:175], v[216:219], v[28:31], v[160:175]
    s_waitcnt lgkmcnt(4)
    v_mfma_f32_32x32x16_bf16 v[176:191], v[220:223], v[28:31], v[176:191]
    ds_read_b128 v[208:211], v8 offset:1184
    ds_read_b128 v[212:215], v8 offset:30368
    ds_read_b128 v[216:219], v9 offset:1184
    ds_read_b128 v[220:223], v9 offset:30368
    s_waitcnt lgkmcnt(7)
    v_mfma_f32_32x32x16_bf16 v[128:143], v[192:195], v[32:35], v[128:143]
    s_waitcnt lgkmcnt(6)
    v_mfma_f32_32x32x16_bf16 v[144:159], v[196:199], v[32:35], v[144:159]
    s_waitcnt lgkmcnt(5)
    v_mfma_f32_32x32x16_bf16 v[160:175], v[200:203], v[32:35], v[160:175]
    s_waitcnt lgkmcnt(4)
    v_mfma_f32_32x32x16_bf16 v[176:191], v[204:207], v[32:35], v[176:191]
    ds_read_b128 v[192:195], v8 offset:1216
    ds_read_b128 v[196:199], v8 offset:30400
    ds_read_b128 v[200:203], v9 offset:1216
    ds_read_b128 v[204:207], v9 offset:30400
    s_waitcnt lgkmcnt(7)
    v_mfma_f32_32x32x16_bf16 v[128:143], v[208:211], v[36:39], v[128:143]
    s_waitcnt lgkmcnt(6)
    v_mfma_f32_32x32x16_bf16 v[144:159], v[212:215], v[36:39], v[144:159]
    s_waitcnt lgkmcnt(5)
    v_mfma_f32_32x32x16_bf16 v[160:175], v[216:219], v[36:39], v[160:175]
    s_waitcnt lgkmcnt(4)
    v_mfma_f32_32x32x16_bf16 v[176:191], v[220:223], v[36:39], v[176:191]
    ds_read_b128 v[208:211], v8 offset:1248
    ds_read_b128 v[212:215], v8 offset:30432
    ds_read_b128 v[216:219], v9 offset:1248
    ds_read_b128 v[220:223], v9 offset:30432
    s_waitcnt lgkmcnt(7)
    v_mfma_f32_32x32x16_bf16 v[128:143], v[192:195], v[40:43], v[128:143]
    s_waitcnt lgkmcnt(6)
    v_mfma_f32_32x32x16_bf16 v[144:159], v[196:199], v[40:43], v[144:159]
    s_waitcnt lgkmcnt(5)
    v_mfma_f32_32x32x16_bf16 v[160:175], v[200:203], v[40:43], v[160:175]
    s_waitcnt lgkmcnt(4)
    v_mfma_f32_32x32x16_bf16 v[176:191], v[204:207], v[40:43], v[176:191]
    ds_read_b128 v[192:195], v8 offset:1280
    ds_read_b128 v[196:199], v8 offset:30464
    ds_read_b128 v[200:203], v9 offset:1280
    ds_read_b128 v[204:207], v9 offset:30464
    s_waitcnt lgkmcnt(7)
    v_mfma_f32_32x32x16_bf16 v[128:143], v[208:211], v[44:47], v[128:143]
    s_waitcnt lgkmcnt(6)
    v_mfma_f32_32x32x16_bf16 v[144:159], v[212:215], v[44:47], v[144:159]
    s_waitcnt lgkmcnt(5)
    v_mfma_f32_32x32x16_bf16 v[160:175], v[216:219], v[44:47], v[160:175]
    s_waitcnt lgkmcnt(4)
    v_mfma_f32_32x32x16_bf16 v[176:191], v[220:223], v[44:47], v[176:191]
    ds_read_b128 v[208:211], v8 offset:1312
    ds_read_b128 v[212:215], v8 offset:30496
    ds_read_b128 v[216:219], v9 offset:1312
    ds_read_b128 v[220:223], v9 offset:30496
    s_waitcnt lgkmcnt(7)
    v_mfma_f32_32x32x16_bf16 v[128:143], v[192:195], v[48:51], v[128:143]
    s_waitcnt lgkmcnt(6)
    v_mfma_f32_32x32x16_bf16 v[144:159], v[196:199], v[48:51], v[144:159]
    s_waitcnt lgkmcnt(5)
    v_mfma_f32_32x32x16_bf16 v[160:175], v[200:203], v[48:51], v[160:175]
    s_waitcnt lgkmcnt(4)
    v_mfma_f32_32x32x16_bf16 v[176:191], v[204:207], v[48:51], v[176:191]
    ds_read_b128 v[192:195], v8 offset:1344
    ds_read_b128 v[196:199], v8 offset:30528
    ds_read_b128 v[200:203], v9 offset:1344
    ds_read_b128 v[204:207], v9 offset:30528
    s_waitcnt lgkmcnt(7)
    v_mfma_f32_32x32x16_bf16 v[128:143], v[208:211], v[52:55], v[128:143]
    s_waitcnt lgkmcnt(6)
    v_mfma_f32_32x32x16_bf16 v[144:159], v[212:215], v[52:55], v[144:159]
    s_waitcnt lgkmcnt(5)
    v_mfma_f32_32x32x16_bf16 v[160:175], v[216:219], v[52:55], v[160:175]
    s_waitcnt lgkmcnt(4)
    v_mfma_f32_32x32x16_bf16 v[176:191], v[220:223], v[52:55], v[176:191]
    ds_read_b128 v[208:211], v8 offset:1376
    ds_read_b128 v[212:215], v8 offset:30560
    ds_read_b128 v[216:219], v9 offset:1376
    ds_read_b128 v[220:223], v9 offset:30560
    s_waitcnt lgkmcnt(7)
    v_mfma_f32_32x32x16_bf16 v[128:143], v[192:195], v[56:59], v[128:143]
    s_waitcnt lgkmcnt(6)
    v_mfma_f32_32x32x16_bf16 v[144:159], v[196:199], v[56:59], v[144:159]
    s_waitcnt lgkmcnt(5)
    v_mfma_f32_32x32x16_bf16 v[160:175], v[200:203], v[56:59], v[160:175]
    s_waitcnt lgkmcnt(4)
    v_mfma_f32_32x32x16_bf16 v[176:191], v[204:207], v[56:59], v[176:191]
    ds_read_b128 v[192:195], v8 offset:1408
    ds_read_b128 v[196:199], v8 offset:30592
    ds_read_b128 v[200:203], v9 offset:1408
    ds_read_b128 v[204:207], v9 offset:30592
    s_waitcnt lgkmcnt(7)
    v_mfma_f32_32x32x16_bf16 v[128:143], v[208:211], v[60:63], v[128:143]
    s_waitcnt lgkmcnt(6)
    v_mfma_f32_32x32x16_bf16 v[144:159], v[212:215], v[60:63], v[144:159]
    s_waitcnt lgkmcnt(5)
    v_mfma_f32_32x32x16_bf16 v[160:175], v[216:219], v[60:63], v[160:175]
    s_waitcnt lgkmcnt(4)
    v_mfma_f32_32x32x16_bf16 v[176:191], v[220:223], v[60:63], v[176:191]
    ds_read_b128 v[208:211], v8 offset:1440
    ds_read_b128 v[212:215], v8 offset:30624
    ds_read_b128 v[216:219], v9 offset:1440
    ds_read_b128 v[220:223], v9 offset:30624
    s_waitcnt lgkmcnt(7)
    v_mfma_f32_32x32x16_bf16 v[128:143], v[192:195], v[64:67], v[128:143]
    s_waitcnt lgkmcnt(6)
    v_mfma_f32_32x32x16_bf16 v[144:159], v[196:199], v[64:67], v[144:159]
    s_waitcnt lgkmcnt(5)
    v_mfma_f32_32x32x16_bf16 v[160:175], v[200:203], v[64:67], v[160:175]
    s_waitcnt lgkmcnt(4)
    v_mfma_f32_32x32x16_bf16 v[176:191], v[204:207], v[64:67], v[176:191]
    ds_read_b128 v[192:195], v8 offset:1472
    ds_read_b128 v[196:199], v8 offset:30656
    ds_read_b128 v[200:203], v9 offset:1472
    ds_read_b128 v[204:207], v9 offset:30656
    s_waitcnt lgkmcnt(7)
    v_mfma_f32_32x32x16_bf16 v[128:143], v[208:211], v[68:71], v[128:143]
    s_waitcnt lgkmcnt(6)
    v_mfma_f32_32x32x16_bf16 v[144:159], v[212:215], v[68:71], v[144:159]
    s_waitcnt lgkmcnt(5)
    v_mfma_f32_32x32x16_bf16 v[160:175], v[216:219], v[68:71], v[160:175]
    s_waitcnt lgkmcnt(4)
    v_mfma_f32_32x32x16_bf16 v[176:191], v[220:223], v[68:71], v[176:191]
    ds_read_b128 v[208:211], v8 offset:1504
    ds_read_b128 v[212:215], v8 offset:30688
    ds_read_b128 v[216:219], v9 offset:1504
    ds_read_b128 v[220:223], v9 offset:30688
    s_waitcnt lgkmcnt(7)
    v_mfma_f32_32x32x16_bf16 v[128:143], v[192:195], v[72:75], v[128:143]
    s_waitcnt lgkmcnt(6)
    v_mfma_f32_32x32x16_bf16 v[144:159], v[196:199], v[72:75], v[144:159]
    s_waitcnt lgkmcnt(5)
    v_mfma_f32_32x32x16_bf16 v[160:175], v[200:203], v[72:75], v[160:175]
    s_waitcnt lgkmcnt(4)
    v_mfma_f32_32x32x16_bf16 v[176:191], v[204:207], v[72:75], v[176:191]
    ds_read_b128 v[192:195], v8 offset:1536
    ds_read_b128 v[196:199], v8 offset:30720
    ds_read_b128 v[200:203], v9 offset:1536
    ds_read_b128 v[204:207], v9 offset:30720
    s_waitcnt lgkmcnt(7)
    v_mfma_f32_32x32x16_bf16 v[128:143], v[208:211], v[76:79], v[128:143]
    s_waitcnt lgkmcnt(6)
    v_mfma_f32_32x32x16_bf16 v[144:159], v[212:215], v[76:79], v[144:159]
    s_waitcnt lgkmcnt(5)
    v_mfma_f32_32x32x16_bf16 v[160:175], v[216:219], v[76:79], v[160:175]
    s_waitcnt lgkmcnt(4)
    v_mfma_f32_32x32x16_bf16 v[176:191], v[220:223], v[76:79], v[176:191]
    ds_read_b128 v[208:211], v8 offset:1568
    ds_read_b128 v[212:215], v8 offset:30752
    ds_read_b128 v[216:219], v9 offset:1568
    ds_read_b128 v[220:223], v9 offset:30752
    s_waitcnt lgkmcnt(7)
    v_mfma_f32_32x32x16_bf16 v[128:143], v[192:195], v[80:83], v[128:143]
    s_waitcnt lgkmcnt(6)
    v_mfma_f32_32x32x16_bf16 v[144:159], v[196:199], v[80:83], v[144:159]
    s_waitcnt lgkmcnt(5)
    v_mfma_f32_32x32x16_bf16 v[160:175], v[200:203], v[80:83], v[160:175]
    s_waitcnt lgkmcnt(4)
    v_mfma_f32_32x32x16_bf16 v[176:191], v[204:207], v[80:83], v[176:191]
    ds_read_b128 v[192:195], v8 offset:1600
    ds_read_b128 v[196:199], v8 offset:30784
    ds_read_b128 v[200:203], v9 offset:1600
    ds_read_b128 v[204:207], v9 offset:30784
    s_waitcnt lgkmcnt(7)
    v_mfma_f32_32x32x16_bf16 v[128:143], v[208:211], v[84:87], v[128:143]
    s_waitcnt lgkmcnt(6)
    v_mfma_f32_32x32x16_bf16 v[144:159], v[212:215], v[84:87], v[144:159]
    s_waitcnt lgkmcnt(5)
    v_mfma_f32_32x32x16_bf16 v[160:175], v[216:219], v[84:87], v[160:175]
    s_waitcnt lgkmcnt(4)
    v_mfma_f32_32x32x16_bf16 v[176:191], v[220:223], v[84:87], v[176:191]
    ds_read_b128 v[208:211], v8 offset:1632
    ds_read_b128 v[212:215], v8 offset:30816
    ds_read_b128 v[216:219], v9 offset:1632
    ds_read_b128 v[220:223], v9 offset:30816
    s_waitcnt lgkmcnt(7)
    v_mfma_f32_32x32x16_bf16 v[128:143], v[192:195], v[88:91], v[128:143]
    s_waitcnt lgkmcnt(6)
    v_mfma_f32_32x32x16_bf16 v[144:159], v[196:199], v[88:91], v[144:159]
    s_waitcnt lgkmcnt(5)
    v_mfma_f32_32x32x16_bf16 v[160:175], v[200:203], v[88:91], v[160:175]
    s_waitcnt lgkmcnt(4)
    v_mfma_f32_32x32x16_bf16 v[176:191], v[204:207], v[88:91], v[176:191]
    ds_read_b128 v[192:195], v8 offset:1664
    ds_read_b128 v[196:199], v8 offset:30848
    ds_read_b128 v[200:203], v9 offset:1664
    ds_read_b128 v[204:207], v9 offset:30848
    s_waitcnt lgkmcnt(7)
    v_mfma_f32_32x32x16_bf16 v[128:143], v[208:211], v[92:95], v[128:143]
    s_waitcnt lgkmcnt(6)
    v_mfma_f32_32x32x16_bf16 v[144:159], v[212:215], v[92:95], v[144:159]
    s_waitcnt lgkmcnt(5)
    v_mfma_f32_32x32x16_bf16 v[160:175], v[216:219], v[92:95], v[160:175]
    s_waitcnt lgkmcnt(4)
    v_mfma_f32_32x32x16_bf16 v[176:191], v[220:223], v[92:95], v[176:191]
    ds_read_b128 v[208:211], v8 offset:1696
    ds_read_b128 v[212:215], v8 offset:30880
    ds_read_b128 v[216:219], v9 offset:1696
    ds_read_b128 v[220:223], v9 offset:30880
    s_waitcnt lgkmcnt(7)
    v_mfma_f32_32x32x16_bf16 v[128:143], v[192:195], v[96:99], v[128:143]
    s_waitcnt lgkmcnt(6)
    v_mfma_f32_32x32x16_bf16 v[144:159], v[196:199], v[96:99], v[144:159]
    s_waitcnt lgkmcnt(5)
    v_mfma_f32_32x32x16_bf16 v[160:175], v[200:203], v[96:99], v[160:175]
    s_waitcnt lgkmcnt(4)
    v_mfma_f32_32x32x16_bf16 v[176:191], v[204:207], v[96:99], v[176:191]
    ds_read_b128 v[192:195], v8 offset:1728
    ds_read_b128 v[196:199], v8 offset:30912
    ds_read_b128 v[200:203], v9 offset:1728
    ds_read_b128 v[204:207], v9 offset:30912
    s_waitcnt lgkmcnt(7)
    v_mfma_f32_32x32x16_bf16 v[128:143], v[208:211], v[100:103], v[128:143]
    s_waitcnt lgkmcnt(6)
    v_mfma_f32_32x32x16_bf16 v[144:159], v[212:215], v[100:103], v[144:159]
    s_waitcnt lgkmcnt(5)
    v_mfma_f32_32x32x16_bf16 v[160:175], v[216:219], v[100:103], v[160:175]
    s_waitcnt lgkmcnt(4)
    v_mfma_f32_32x32x16_bf16 v[176:191], v[220:223], v[100:103], v[176:191]
    ds_read_b128 v[208:211], v8 offset:1760
    ds_read_b128 v[212:215], v8 offset:30944
    ds_read_b128 v[216:219], v9 offset:1760
    ds_read_b128 v[220:223], v9 offset:30944
    s_waitcnt lgkmcnt(7)
    v_mfma_f32_32x32x16_bf16 v[128:143], v[192:195], v[104:107], v[128:143]
    s_waitcnt lgkmcnt(6)
    v_mfma_f32_32x32x16_bf16 v[144:159], v[196:199], v[104:107], v[144:159]
    s_waitcnt lgkmcnt(5)
    v_mfma_f32_32x32x16_bf16 v[160:175], v[200:203], v[104:107], v[160:175]
    s_waitcnt lgkmcnt(4)
    v_mfma_f32_32x32x16_bf16 v[176:191], v[204:207], v[104:107], v[176:191]
    ds_read_b128 v[192:195], v8 offset:1792
    ds_read_b128 v[196:199], v8 offset:30976
    ds_read_b128 v[200:203], v9 offset:1792
    ds_read_b128 v[204:207], v9 offset:30976
    s_waitcnt lgkmcnt(7)
    v_mfma_f32_32x32x16_bf16 v[128:143], v[208:211], v[108:111], v[128:143]
    s_waitcnt lgkmcnt(6)
    v_mfma_f32_32x32x16_bf16 v[144:159], v[212:215], v[108:111], v[144:159]
    s_waitcnt lgkmcnt(5)
    v_mfma_f32_32x32x16_bf16 v[160:175], v[216:219], v[108:111], v[160:175]
    s_waitcnt lgkmcnt(4)
    v_mfma_f32_32x32x16_bf16 v[176:191], v[220:223], v[108:111], v[176:191]
    ds_read_b128 v[208:211], v8 offset:1824
    ds_read_b128 v[212:215], v8 offset:31008
    ds_read_b128 v[216:219], v9 offset:1824
    ds_read_b128 v[220:223], v9 offset:31008
    s_waitcnt lgkmcnt(7)
    v_mfma_f32_32x32x16_bf16 v[128:143], v[192:195], v[112:115], v[128:143]
    s_waitcnt lgkmcnt(6)
    v_mfma_f32_32x32x16_bf16 v[144:159], v[196:199], v[112:115], v[144:159]
    s_waitcnt lgkmcnt(5)
    v_mfma_f32_32x32x16_bf16 v[160:175], v[200:203], v[112:115], v[160:175]
    s_waitcnt lgkmcnt(4)
    v_mfma_f32_32x32x16_bf16 v[176:191], v[204:207], v[112:115], v[176:191]
    ds_read_b128 v[192:195], v8 offset:1856
    ds_read_b128 v[196:199], v8 offset:31040
    ds_read_b128 v[200:203], v9 offset:1856
    ds_read_b128 v[204:207], v9 offset:31040
    s_waitcnt lgkmcnt(7)
    v_mfma_f32_32x32x16_bf16 v[128:143], v[208:211], v[116:119], v[128:143]
    s_waitcnt lgkmcnt(6)
    v_mfma_f32_32x32x16_bf16 v[144:159], v[212:215], v[116:119], v[144:159]
    s_waitcnt lgkmcnt(5)
    v_mfma_f32_32x32x16_bf16 v[160:175], v[216:219], v[116:119], v[160:175]
    s_waitcnt lgkmcnt(4)
    v_mfma_f32_32x32x16_bf16 v[176:191], v[220:223], v[116:119], v[176:191]
    ds_read_b128 v[208:211], v8 offset:1888
    ds_read_b128 v[212:215], v8 offset:31072
    ds_read_b128 v[216:219], v9 offset:1888
    ds_read_b128 v[220:223], v9 offset:31072
    s_waitcnt lgkmcnt(7)
    v_mfma_f32_32x32x16_bf16 v[128:143], v[192:195], v[120:123], v[128:143]
    s_waitcnt lgkmcnt(6)
    v_mfma_f32_32x32x16_bf16 v[144:159], v[196:199], v[120:123], v[144:159]
    s_waitcnt lgkmcnt(5)
    v_mfma_f32_32x32x16_bf16 v[160:175], v[200:203], v[120:123], v[160:175]
    s_waitcnt lgkmcnt(4)
    v_mfma_f32_32x32x16_bf16 v[176:191], v[204:207], v[120:123], v[176:191]
    s_waitcnt lgkmcnt(3)
    v_mfma_f32_32x32x16_bf16 v[128:143], v[208:211], v[124:127], v[128:143]
    s_waitcnt lgkmcnt(2)
    v_mfma_f32_32x32x16_bf16 v[144:159], v[212:215], v[124:127], v[144:159]
    s_waitcnt lgkmcnt(1)
    v_mfma_f32_32x32x16_bf16 v[160:175], v[216:219], v[124:127], v[160:175]
    s_waitcnt lgkmcnt(0)
    v_mfma_f32_32x32x16_bf16 v[176:191], v[220:223], v[124:127], v[176:191]
    s_add_u32 s28, s4, 12582912
    s_addc_u32 s29, s5, 0
    s_mov_b32 s30, 2097152
    s_mov_b32 s31, 0x00020000
    s_sub_u32 s36, s33, 32
    s_lshl_b32 s36, s36, 17
    s_lshl_b32 s37, s34, 6
    s_add_u32 s36, s36, s37
    v_and_b32 v4, 31, v1
    v_lshlrev_b32 v4, 2, v4
    s_lshl_b32 s37, s33, 7
    buffer_load_dword v16, v4, s[24:27], s37 offen
    v_and_b32 v4, 31, v1
    v_cmp_eq_u32 vcc, 28, v4
    v_mov_b32 v17, 0x3f803f80
    v_lshrrev_b32 v5, 5, v1
    v_lshlrev_b32 v5, 4, v5
    ds_read_b128 v[20:23], v5 offset:0
    ds_read_b128 v[24:27], v5 offset:512
    s_waitcnt lgkmcnt(1)
    v_mul_f32 v128, v128, v20
    s_waitcnt vmcnt(0) lgkmcnt(0)
    v_fma_f32 v128, -v24, v16, v128
    v_mul_f32 v129, v129, v21
    v_fma_f32 v129, -v25, v16, v129
    v_mul_f32 v130, v130, v22
    v_fma_f32 v130, -v26, v16, v130
    v_mul_f32 v131, v131, v23
    v_fma_f32 v131, -v27, v16, v131
    v_cvt_pk_bf16_f32 v40, v128, v129
    v_cvt_pk_bf16_f32 v41, v130, v131
    ds_read_b128 v[28:31], v5 offset:32
    ds_read_b128 v[32:35], v5 offset:544
    s_waitcnt lgkmcnt(1)
    v_mul_f32 v132, v132, v28
    s_waitcnt lgkmcnt(0)
    v_fma_f32 v132, -v32, v16, v132
    v_mul_f32 v133, v133, v29
    v_fma_f32 v133, -v33, v16, v133
    v_mul_f32 v134, v134, v30
    v_fma_f32 v134, -v34, v16, v134
    v_mul_f32 v135, v135, v31
    v_fma_f32 v135, -v35, v16, v135
    v_cvt_pk_bf16_f32 v42, v132, v133
    v_cvt_pk_bf16_f32 v43, v134, v135
    v_cndmask_b32 v40, v40, v17, vcc
    v_cndmask_b32 v41, v41, v17, vcc
    v_cndmask_b32 v42, v42, v17, vcc
    v_cndmask_b32 v43, v43, v17, vcc
    buffer_store_dwordx4 v[40:43], v2, s[28:31], s36 offen offset:0
    ds_read_b128 v[20:23], v5 offset:64
    ds_read_b128 v[24:27], v5 offset:576
    s_waitcnt lgkmcnt(1)
    v_mul_f32 v136, v136, v20
    s_waitcnt lgkmcnt(0)
    v_fma_f32 v136, -v24, v16, v136
    v_mul_f32 v137, v137, v21
    v_fma_f32 v137, -v25, v16, v137
    v_mul_f32 v138, v138, v22
    v_fma_f32 v138, -v26, v16, v138
    v_mul_f32 v139, v139, v23
    v_fma_f32 v139, -v27, v16, v139
    v_cvt_pk_bf16_f32 v40, v136, v137
    v_cvt_pk_bf16_f32 v41, v138, v139
    ds_read_b128 v[28:31], v5 offset:96
    ds_read_b128 v[32:35], v5 offset:608
    s_waitcnt lgkmcnt(1)
    v_mul_f32 v140, v140, v28
    s_waitcnt lgkmcnt(0)
    v_fma_f32 v140, -v32, v16, v140
    v_mul_f32 v141, v141, v29
    v_fma_f32 v141, -v33, v16, v141
    v_mul_f32 v142, v142, v30
    v_fma_f32 v142, -v34, v16, v142
    v_mul_f32 v143, v143, v31
    v_fma_f32 v143, -v35, v16, v143
    v_cvt_pk_bf16_f32 v42, v140, v141
    v_cvt_pk_bf16_f32 v43, v142, v143
    v_cndmask_b32 v40, v40, v17, vcc
    v_cndmask_b32 v41, v41, v17, vcc
    v_cndmask_b32 v42, v42, v17, vcc
    v_cndmask_b32 v43, v43, v17, vcc
    buffer_store_dwordx4 v[40:43], v2, s[28:31], s36 offen offset:1024
    ds_read_b128 v[20:23], v5 offset:128
    ds_read_b128 v[24:27], v5 offset:640
    s_waitcnt lgkmcnt(1)
    v_mul_f32 v144, v144, v20
    s_waitcnt lgkmcnt(0)
    v_fma_f32 v144, -v24, v16, v144
    v_mul_f32 v145, v145, v21
    v_fma_f32 v145, -v25, v16, v145
    v_mul_f32 v146, v146, v22
    v_fma_f32 v146, -v26, v16, v146
    v_mul_f32 v147, v147, v23
    v_fma_f32 v147, -v27, v16, v147
    v_cvt_pk_bf16_f32 v40, v144, v145
    v_cvt_pk_bf16_f32 v41, v146, v147
    ds_read_b128 v[28:31], v5 offset:160
    ds_read_b128 v[32:35], v5 offset:672
    s_waitcnt lgkmcnt(1)
    v_mul_f32 v148, v148, v28
    s_waitcnt lgkmcnt(0)
    v_fma_f32 v148, -v32, v16, v148
    v_mul_f32 v149, v149, v29
    v_fma_f32 v149, -v33, v16, v149
    v_mul_f32 v150, v150, v30
    v_fma_f32 v150, -v34, v16, v150
    v_mul_f32 v151, v151, v31
    v_fma_f32 v151, -v35, v16, v151
    v_cvt_pk_bf16_f32 v42, v148, v149
    v_cvt_pk_bf16_f32 v43, v150, v151
    v_cndmask_b32 v40, v40, v17, vcc
    v_cndmask_b32 v41, v41, v17, vcc
    v_cndmask_b32 v42, v42, v17, vcc
    v_cndmask_b32 v43, v43, v17, vcc
    buffer_store_dwordx4 v[40:43], v2, s[28:31], s36 offen offset:2048
    ds_read_b128 v[20:23], v5 offset:192
    ds_read_b128 v[24:27], v5 offset:704
    s_waitcnt lgkmcnt(1)
    v_mul_f32 v152, v152, v20
    s_waitcnt lgkmcnt(0)
    v_fma_f32 v152, -v24, v16, v152
    v_mul_f32 v153, v153, v21
    v_fma_f32 v153, -v25, v16, v153
    v_mul_f32 v154, v154, v22
    v_fma_f32 v154, -v26, v16, v154
    v_mul_f32 v155, v155, v23
    v_fma_f32 v155, -v27, v16, v155
    v_cvt_pk_bf16_f32 v40, v152, v153
    v_cvt_pk_bf16_f32 v41, v154, v155
    ds_read_b128 v[28:31], v5 offset:224
    ds_read_b128 v[32:35], v5 offset:736
    s_waitcnt lgkmcnt(1)
    v_mul_f32 v156, v156, v28
    s_waitcnt lgkmcnt(0)
    v_fma_f32 v156, -v32, v16, v156
    v_mul_f32 v157, v157, v29
    v_fma_f32 v157, -v33, v16, v157
    v_mul_f32 v158, v158, v30
    v_fma_f32 v158, -v34, v16, v158
    v_mul_f32 v159, v159, v31
    v_fma_f32 v159, -v35, v16, v159
    v_cvt_pk_bf16_f32 v42, v156, v157
    v_cvt_pk_bf16_f32 v43, v158, v159
    v_cndmask_b32 v40, v40, v17, vcc
    v_cndmask_b32 v41, v41, v17, vcc
    v_cndmask_b32 v42, v42, v17, vcc
    v_cndmask_b32 v43, v43, v17, vcc
    buffer_store_dwordx4 v[40:43], v2, s[28:31], s36 offen offset:3072
    s_add_u32 s36, s36, 4096
    ds_read_b128 v[20:23], v5 offset:256
    ds_read_b128 v[24:27], v5 offset:768
    s_waitcnt lgkmcnt(1)
    v_mul_f32 v160, v160, v20
    s_waitcnt lgkmcnt(0)
    v_fma_f32 v160, -v24, v16, v160
    v_mul_f32 v161, v161, v21
    v_fma_f32 v161, -v25, v16, v161
    v_mul_f32 v162, v162, v22
    v_fma_f32 v162, -v26, v16, v162
    v_mul_f32 v163, v163, v23
    v_fma_f32 v163, -v27, v16, v163
    v_cvt_pk_bf16_f32 v40, v160, v161
    v_cvt_pk_bf16_f32 v41, v162, v163
    ds_read_b128 v[28:31], v5 offset:288
    ds_read_b128 v[32:35], v5 offset:800
    s_waitcnt lgkmcnt(1)
    v_mul_f32 v164, v164, v28
    s_waitcnt lgkmcnt(0)
    v_fma_f32 v164, -v32, v16, v164
    v_mul_f32 v165, v165, v29
    v_fma_f32 v165, -v33, v16, v165
    v_mul_f32 v166, v166, v30
    v_fma_f32 v166, -v34, v16, v166
    v_mul_f32 v167, v167, v31
    v_fma_f32 v167, -v35, v16, v167
    v_cvt_pk_bf16_f32 v42, v164, v165
    v_cvt_pk_bf16_f32 v43, v166, v167
    v_cndmask_b32 v40, v40, v17, vcc
    v_cndmask_b32 v41, v41, v17, vcc
    v_cndmask_b32 v42, v42, v17, vcc
    v_cndmask_b32 v43, v43, v17, vcc
    buffer_store_dwordx4 v[40:43], v2, s[28:31], s36 offen offset:0
    ds_read_b128 v[20:23], v5 offset:320
    ds_read_b128 v[24:27], v5 offset:832
    s_waitcnt lgkmcnt(1)
    v_mul_f32 v168, v168, v20
    s_waitcnt lgkmcnt(0)
    v_fma_f32 v168, -v24, v16, v168
    v_mul_f32 v169, v169, v21
    v_fma_f32 v169, -v25, v16, v169
    v_mul_f32 v170, v170, v22
    v_fma_f32 v170, -v26, v16, v170
    v_mul_f32 v171, v171, v23
    v_fma_f32 v171, -v27, v16, v171
    v_cvt_pk_bf16_f32 v40, v168, v169
    v_cvt_pk_bf16_f32 v41, v170, v171
    ds_read_b128 v[28:31], v5 offset:352
    ds_read_b128 v[32:35], v5 offset:864
    s_waitcnt lgkmcnt(1)
    v_mul_f32 v172, v172, v28
    s_waitcnt lgkmcnt(0)
    v_fma_f32 v172, -v32, v16, v172
    v_mul_f32 v173, v173, v29
    v_fma_f32 v173, -v33, v16, v173
    v_mul_f32 v174, v174, v30
    v_fma_f32 v174, -v34, v16, v174
    v_mul_f32 v175, v175, v31
    v_fma_f32 v175, -v35, v16, v175
    v_cvt_pk_bf16_f32 v42, v172, v173
    v_cvt_pk_bf16_f32 v43, v174, v175
    v_cndmask_b32 v40, v40, v17, vcc
    v_cndmask_b32 v41, v41, v17, vcc
    v_cndmask_b32 v42, v42, v17, vcc
    v_cndmask_b32 v43, v43, v17, vcc
    buffer_store_dwordx4 v[40:43], v2, s[28:31], s36 offen offset:1024
    ds_read_b128 v[20:23], v5 offset:384
    ds_read_b128 v[24:27], v5 offset:896
    s_waitcnt lgkmcnt(1)
    v_mul_f32 v176, v176, v20
    s_waitcnt lgkmcnt(0)
    v_fma_f32 v176, -v24, v16, v176
    v_mul_f32 v177, v177, v21
    v_fma_f32 v177, -v25, v16, v177
    v_mul_f32 v178, v178, v22
    v_fma_f32 v178, -v26, v16, v178
    v_mul_f32 v179, v179, v23
    v_fma_f32 v179, -v27, v16, v179
    v_cvt_pk_bf16_f32 v40, v176, v177
    v_cvt_pk_bf16_f32 v41, v178, v179
    ds_read_b128 v[28:31], v5 offset:416
    ds_read_b128 v[32:35], v5 offset:928
    s_waitcnt lgkmcnt(1)
    v_mul_f32 v180, v180, v28
    s_waitcnt lgkmcnt(0)
    v_fma_f32 v180, -v32, v16, v180
    v_mul_f32 v181, v181, v29
    v_fma_f32 v181, -v33, v16, v181
    v_mul_f32 v182, v182, v30
    v_fma_f32 v182, -v34, v16, v182
    v_mul_f32 v183, v183, v31
    v_fma_f32 v183, -v35, v16, v183
    v_cvt_pk_bf16_f32 v42, v180, v181
    v_cvt_pk_bf16_f32 v43, v182, v183
    v_cndmask_b32 v40, v40, v17, vcc
    v_cndmask_b32 v41, v41, v17, vcc
    v_cndmask_b32 v42, v42, v17, vcc
    v_cndmask_b32 v43, v43, v17, vcc
    buffer_store_dwordx4 v[40:43], v2, s[28:31], s36 offen offset:2048
    ds_read_b128 v[20:23], v5 offset:448
    ds_read_b128 v[24:27], v5 offset:960
    s_waitcnt lgkmcnt(1)
    v_mul_f32 v184, v184, v20
    s_waitcnt lgkmcnt(0)
    v_fma_f32 v184, -v24, v16, v184
    v_mul_f32 v185, v185, v21
    v_fma_f32 v185, -v25, v16, v185
    v_mul_f32 v186, v186, v22
    v_fma_f32 v186, -v26, v16, v186
    v_mul_f32 v187, v187, v23
    v_fma_f32 v187, -v27, v16, v187
    v_cvt_pk_bf16_f32 v40, v184, v185
    v_cvt_pk_bf16_f32 v41, v186, v187
    ds_read_b128 v[28:31], v5 offset:480
    ds_read_b128 v[32:35], v5 offset:992
    s_waitcnt lgkmcnt(1)
    v_mul_f32 v188, v188, v28
    s_waitcnt lgkmcnt(0)
    v_fma_f32 v188, -v32, v16, v188
    v_mul_f32 v189, v189, v29
    v_fma_f32 v189, -v33, v16, v189
    v_mul_f32 v190, v190, v30
    v_fma_f32 v190, -v34, v16, v190
    v_mul_f32 v191, v191, v31
    v_fma_f32 v191, -v35, v16, v191
    v_cvt_pk_bf16_f32 v42, v188, v189
    v_cvt_pk_bf16_f32 v43, v190, v191
    v_cndmask_b32 v40, v40, v17, vcc
    v_cndmask_b32 v41, v41, v17, vcc
    v_cndmask_b32 v42, v42, v17, vcc
    v_cndmask_b32 v43, v43, v17, vcc
    buffer_store_dwordx4 v[40:43], v2, s[28:31], s36 offen offset:3072
    s_endpgm
.section .rodata,"a"
.p2align 6
.amdhsa_kernel k1a_kernel
  .amdhsa_next_free_vgpr 256
  .amdhsa_next_free_sgpr 64
  .amdhsa_accum_offset 256
  .amdhsa_group_segment_fixed_size 0
  .amdhsa_kernarg_size 80
  .amdhsa_user_sgpr_count 2
  .amdhsa_user_sgpr_kernarg_segment_ptr 1
  .amdhsa_system_sgpr_workgroup_id_x 1
.end_amdhsa_kernel
.text
.globl k2a_kernel
.p2align 8
.type k2a_kernel,@function
k2a_kernel:
    s_cmp_ge_u32 s2, 512
    s_cbranch_scc0 k2a_kernel_go1
    s_endpgm
k2a_kernel_go1:
    s_load_dwordx2 s[4:5], s[0:1], 72
    s_waitcnt lgkmcnt(0)
    s_add_u32 s12, s4, 8388608
    s_addc_u32 s13, s5, 0
    s_mov_b32 s14, 2097152
    s_mov_b32 s15, 0x00020000
    s_add_u32 s16, s4, 10485760
    s_addc_u32 s17, s5, 0
    s_mov_b32 s18, 2097152
    s_mov_b32 s19, 0x00020000
    s_add_u32 s20, s4, 12582912
    s_addc_u32 s21, s5, 0
    s_mov_b32 s22, 2097152
    s_mov_b32 s23, 0x00020000
    s_add_u32 s24, s4, 14680064
    s_addc_u32 s25, s5, 0
    s_mov_b32 s26, 1835008
    s_mov_b32 s27, 0x00020000
    v_lshrrev_b32 v1, 6, v0
    s_nop 0
    v_readfirstlane_b32 s32, v1
    s_and_b32 s30, s2, 7
    s_lshl_b32 s30, s30, 1
    s_bfe_u32 s31, s2, 0x10003
    s_add_u32 s30, s30, s31
    s_lshr_b32 s31, s2, 4
    s_lshl_b32 s33, s30, 17
    v_and_b32 v1, 63, v0
    v_lshlrev_b32 v2, 4, v1
    v_lshlrev_b32 v3, 4, v1
    s_lshl_b32 s34, s31, 12
    s_add_u32 s34, s34, s33
    buffer_load_dwordx4 v[16:19], v2, s[12:15], s34 offen offset:0
    buffer_load_dwordx4 v[20:23], v2, s[12:15], s34 offen offset:1024
    buffer_load_dwordx4 v[24:27], v2, s[12:15], s34 offen offset:2048
    buffer_load_dwordx4 v[28:31], v2, s[12:15], s34 offen offset:3072
    s_lshl_b32 s35, s32, 15
    s_add_u32 s35, s35, s33
    s_lshl_b32 s36, s32, 15
    s_add_u32 s36, s36, s33
    s_mov_b32 s40, 0.2726437354213113
    s_mov_b32 s38, s35
    v_mov_b32 v144, -1e30
    v_mov_b32 v145, -1e30
    buffer_load_dwordx4 v[112:115], v2, s[16:19], s35 offen offset:0
    buffer_load_dwordx4 v[116:119], v2, s[16:19], s35 offen offset:1024
    s_add_u32 s35, s35, 2048
    buffer_load_dwordx4 v[120:123], v2, s[16:19], s35 offen offset:0
    buffer_load_dwordx4 v[124:127], v2, s[16:19], s35 offen offset:1024
    s_add_u32 s35, s35, 2048
    buffer_load_dwordx4 v[128:131], v2, s[16:19], s35 offen offset:0
    buffer_load_dwordx4 v[132:135], v2, s[16:19], s35 offen offset:1024
    s_add_u32 s35, s35, 2048
    buffer_load_dwordx4 v[136:139], v2, s[16:19], s35 offen offset:0
    buffer_load_dwordx4 v[140:143], v2, s[16:19], s35 offen offset:1024
    s_add_u32 s35, s35, 2048
    buffer_load_dwordx4 v[224:227], v2, s[16:19], s35 offen offset:0
    buffer_load_dwordx4 v[228:231], v2, s[16:19], s35 offen offset:1024
    s_add_u32 s35, s35, 2048
    buffer_load_dwordx4 v[232:235], v2, s[16:19], s35 offen offset:0
    buffer_load_dwordx4 v[236:239], v2, s[16:19], s35 offen offset:1024
    s_add_u32 s35, s35, 2048
    buffer_load_dwordx4 v[240:243], v2, s[16:19], s35 offen offset:0
    buffer_load_dwordx4 v[244:247], v2, s[16:19], s35 offen offset:1024
    s_add_u32 s35, s35, 2048
    buffer_load_dwordx4 v[248:251], v2, s[16:19], s35 offen offset:0
    buffer_load_dwordx4 v[252:255], v2, s[16:19], s35 offen offset:1024
    s_add_u32 s35, s35, 2048
    buffer_load_dwordx4 v[192:195], v2, s[16:19], s35 offen offset:0
    buffer_load_dwordx4 v[196:199], v2, s[16:19], s35 offen offset:1024
    s_add_u32 s35, s35, 2048
    buffer_load_dwordx4 v[200:203], v2, s[16:19], s35 offen offset:0
    buffer_load_dwordx4 v[204:207], v2, s[16:19], s35 offen offset:1024
    s_add_u32 s35, s35, 2048
    buffer_load_dwordx4 v[208:211], v2, s[16:19], s35 offen offset:0
    buffer_load_dwordx4 v[212:215], v2, s[16:19], s35 offen offset:1024
    s_add_u32 s35, s35, 2048
    buffer_load_dwordx4 v[216:219], v2, s[16:19], s35 offen offset:0
    buffer_load_dwordx4 v[220:223], v2, s[16:19], s35 offen offset:1024
    s_add_u32 s35, s35, 2048
    buffer_load_dwordx4 v[32:35], v2, s[16:19], s35 offen offset:0
    buffer_load_dwordx4 v[36:39], v2, s[16:19], s35 offen offset:1024
    s_add_u32 s35, s35, 2048
    buffer_load_dwordx4 v[40:43], v2, s[16:19], s35 offen offset:0
    buffer_load_dwordx4 v[44:47], v2, s[16:19], s35 offen offset:1024
    s_add_u32 s35, s35, 2048
    buffer_load_dwordx4 v[48:51], v2, s[16:19], s35 offen offset:0
    buffer_load_dwordx4 v[52:55], v2, s[16:19], s35 offen offset:1024
    s_add_u32 s35, s35, 2048
    buffer_load_dwordx4 v[56:59], v2, s[16:19], s35 offen offset:0
    buffer_load_dwordx4 v[60:63], v2, s[16:19], s35 offen offset:1024
    s_add_u32 s35, s35, 2048
    s_waitcnt vmcnt(31)
    v_mfma_f32_32x32x16_bf16 v[64:79], v[112:115], v[16:19], 0
    v_mfma_f32_32x32x16_bf16 v[80:95], v[112:115], v[24:27], 0
    s_waitcnt vmcnt(30)
    v_mfma_f32_32x32x16_bf16 v[64:79], v[116:119], v[20:23], v[64:79]
    v_mfma_f32_32x32x16_bf16 v[80:95], v[116:119], v[28:31], v[80:95]
    s_waitcnt vmcnt(29)
    v_mfma_f32_32x32x16_bf16 v[160:175], v[120:123], v[16:19], 0
    s_nop 8
    v_max3_f32 v144, v144, v64, v65
    v_max3_f32 v144, v144, v66, v67
    v_max3_f32 v144, v144, v68, v69
    v_max3_f32 v144, v144, v70, v71
    v_mfma_f32_32x32x16_bf16 v[176:191], v[120:123], v[24:27], 0
    v_max3_f32 v144, v144, v72, v73
    v_max3_f32 v144, v144, v74, v75
    v_max3_f32 v144, v144, v76, v77
    v_max3_f32 v144, v144, v78, v79
    s_waitcnt vmcnt(28)
    v_mfma_f32_32x32x16_bf16 v[160:175], v[124:127], v[20:23], v[160:175]
    v_max3_f32 v145, v145, v80, v81
    v_max3_f32 v145, v145, v82, v83
    v_max3_f32 v145, v145, v84, v85
    v_max3_f32 v145, v145, v86, v87
    v_mfma_f32_32x32x16_bf16 v[176:191], v[124:127], v[28:31], v[176:191]
    v_max3_f32 v145, v145, v88, v89
    v_max3_f32 v145, v145, v90, v91
    v_max3_f32 v145, v145, v92, v93
    v_max3_f32 v145, v145, v94, v95
    s_waitcnt vmcnt(27)
    v_mfma_f32_32x32x16_bf16 v[64:79], v[128:131], v[16:19], 0
    s_nop 0
    v_max3_f32 v144, v144, v160, v161
    v_max3_f32 v144, v144, v162, v163
    v_max3_f32 v144, v144, v164, v165
    v_max3_f32 v144, v144, v166, v167
    v_mfma_f32_32x32x16_bf16 v[80:95], v[128:131], v[24:27], 0
    v_max3_f32 v144, v144, v168, v169
    v_max3_f32 v144, v144, v170, v171
    v_max3_f32 v144, v144, v172, v173
    v_max3_f32 v144, v144, v174, v175
    s_waitcnt vmcnt(26)
    v_mfma_f32_32x32x16_bf16 v[64:79], v[132:135], v[20:23], v[64:79]
    v_max3_f32 v145, v145, v176, v177
    v_max3_f32 v145, v145, v178, v179
    v_max3_f32 v145, v145, v180, v181
    v_max3_f32 v145, v145, v182, v183
    v_mfma_f32_32x32x16_bf16 v[80:95], v[132:135], v[28:31], v[80:95]
    v_max3_f32 v145, v145, v184, v185
    v_max3_f32 v145, v145, v186, v187
    v_max3_f32 v145, v145, v188, v189
    v_max3_f32 v145, v145, v190, v191
    s_waitcnt vmcnt(25)
    v_mfma_f32_32x32x16_bf16 v[160:175], v[136:139], v[16:19], 0
    s_nop 0
    v_max3_f32 v144, v144, v64, v65
    v_max3_f32 v144, v144, v66, v67
    v_max3_f32 v144, v144, v68, v69
    v_max3_f32 v144, v144, v70, v71
    v_mfma_f32_32x32x16_bf16 v[176:191], v[136:139], v[24:27], 0
    v_max3_f32 v144, v144, v72, v73
    v_max3_f32 v144, v144, v74, v75
    v_max3_f32 v144, v144, v76, v77
    v_max3_f32 v144, v144, v78, v79
    s_waitcnt vmcnt(24)
    v_mfma_f32_32x32x16_bf16 v[160:175], v[140:143], v[20:23], v[160:175]
    v_max3_f32 v145, v145, v80, v81
    v_max3_f32 v145, v145, v82, v83
    v_max3_f32 v145, v145, v84, v85
    v_max3_f32 v145, v145, v86, v87
    v_mfma_f32_32x32x16_bf16 v[176:191], v[140:143], v[28:31], v[176:191]
    v_max3_f32 v145, v145, v88, v89
    v_max3_f32 v145, v145, v90, v91
    v_max3_f32 v145, v145, v92, v93
    v_max3_f32 v145, v145, v94, v95
    s_waitcnt vmcnt(23)
    v_mfma_f32_32x32x16_bf16 v[64:79], v[224:227], v[16:19], 0
    s_nop 0
    v_max3_f32 v144, v144, v160, v161
    v_max3_f32 v144, v144, v162, v163
    v_max3_f32 v144, v144, v164, v165
    v_max3_f32 v144, v144, v166, v167
    v_mfma_f32_32x32x16_bf16 v[80:95], v[224:227], v[24:27], 0
    v_max3_f32 v144, v144, v168, v169
    v_max3_f32 v144, v144, v170, v171
    v_max3_f32 v144, v144, v172, v173
    v_max3_f32 v144, v144, v174, v175
    s_waitcnt vmcnt(22)
    v_mfma_f32_32x32x16_bf16 v[64:79], v[228:231], v[20:23], v[64:79]
    v_max3_f32 v145, v145, v176, v177
    v_max3_f32 v145, v145, v178, v179
    v_max3_f32 v145, v145, v180, v181
    v_max3_f32 v145, v145, v182, v183
    v_mfma_f32_32x32x16_bf16 v[80:95], v[228:231], v[28:31], v[80:95]
    v_max3_f32 v145, v145, v184, v185
    v_max3_f32 v145, v145, v186, v187
    v_max3_f32 v145, v145, v188, v189
    v_max3_f32 v145, v145, v190, v191
    s_waitcnt vmcnt(21)
    v_mfma_f32_32x32x16_bf16 v[160:175], v[232:235], v[16:19], 0
    s_nop 0
    v_max3_f32 v144, v144, v64, v65
    v_max3_f32 v144, v144, v66, v67
    v_max3_f32 v144, v144, v68, v69
    v_max3_f32 v144, v144, v70, v71
    v_mfma_f32_32x32x16_bf16 v[176:191], v[232:235], v[24:27], 0
    v_max3_f32 v144, v144, v72, v73
    v_max3_f32 v144, v144, v74, v75
    v_max3_f32 v144, v144, v76, v77
    v_max3_f32 v144, v144, v78, v79
    s_waitcnt vmcnt(20)
    v_mfma_f32_32x32x16_bf16 v[160:175], v[236:239], v[20:23], v[160:175]
    v_max3_f32 v145, v145, v80, v81
    v_max3_f32 v145, v145, v82, v83
    v_max3_f32 v145, v145, v84, v85
    v_max3_f32 v145, v145, v86, v87
    v_mfma_f32_32x32x16_bf16 v[176:191], v[236:239], v[28:31], v[176:191]
    v_max3_f32 v145, v145, v88, v89
    v_max3_f32 v145, v145, v90, v91
    v_max3_f32 v145, v145, v92, v93
    v_max3_f32 v145, v145, v94, v95
    s_waitcnt vmcnt(19)
    v_mfma_f32_32x32x16_bf16 v[64:79], v[240:243], v[16:19], 0
    s_nop 0
    v_max3_f32 v144, v144, v160, v161
    v_max3_f32 v144, v144, v162, v163
    v_max3_f32 v144, v144, v164, v165
    v_max3_f32 v144, v144, v166, v167
    v_mfma_f32_32x32x16_bf16 v[80:95], v[240:243], v[24:27], 0
    v_max3_f32 v144, v144, v168, v169
    v_max3_f32 v144, v144, v170, v171
    v_max3_f32 v144, v144, v172, v173
    v_max3_f32 v144, v144, v174, v175
    s_waitcnt vmcnt(18)
    v_mfma_f32_32x32x16_bf16 v[64:79], v[244:247], v[20:23], v[64:79]
    v_max3_f32 v145, v145, v176, v177
    v_max3_f32 v145, v145, v178, v179
    v_max3_f32 v145, v145, v180, v181
    v_max3_f32 v145, v145, v182, v183
    v_mfma_f32_32x32x16_bf16 v[80:95], v[244:247], v[28:31], v[80:95]
    v_max3_f32 v145, v145, v184, v185
    v_max3_f32 v145, v145, v186, v187
    v_max3_f32 v145, v145, v188, v189
    v_max3_f32 v145, v145, v190, v191
    s_waitcnt vmcnt(17)
    v_mfma_f32_32x32x16_bf16 v[160:175], v[248:251], v[16:19], 0
    s_nop 0
    v_max3_f32 v144, v144, v64, v65
    v_max3_f32 v144, v144, v66, v67
    v_max3_f32 v144, v144, v68, v69
    v_max3_f32 v144, v144, v70, v71
    v_mfma_f32_32x32x16_bf16 v[176:191], v[248:251], v[24:27], 0
    v_max3_f32 v144, v144, v72, v73
    v_max3_f32 v144, v144, v74, v75
    v_max3_f32 v144, v144, v76, v77
    v_max3_f32 v144, v144, v78, v79
    s_waitcnt vmcnt(16)
    v_mfma_f32_32x32x16_bf16 v[160:175], v[252:255], v[20:23], v[160:175]
    v_max3_f32 v145, v145, v80, v81
    v_max3_f32 v145, v145, v82, v83
    v_max3_f32 v145, v145, v84, v85
    v_max3_f32 v145, v145, v86, v87
    v_mfma_f32_32x32x16_bf16 v[176:191], v[252:255], v[28:31], v[176:191]
    v_max3_f32 v145, v145, v88, v89
    v_max3_f32 v145, v145, v90, v91
    v_max3_f32 v145, v145, v92, v93
    v_max3_f32 v145, v145, v94, v95
    s_waitcnt vmcnt(15)
    v_mfma_f32_32x32x16_bf16 v[64:79], v[192:195], v[16:19], 0
    s_nop 0
    v_max3_f32 v144, v144, v160, v161
    v_max3_f32 v144, v144, v162, v163
    v_max3_f32 v144, v144, v164, v165
    v_max3_f32 v144, v144, v166, v167
    v_mfma_f32_32x32x16_bf16 v[80:95], v[192:195], v[24:27], 0
    v_max3_f32 v144, v144, v168, v169
    v_max3_f32 v144, v144, v170, v171
    v_max3_f32 v144, v144, v172, v173
    v_max3_f32 v144, v144, v174, v175
    s_waitcnt vmcnt(14)
    v_mfma_f32_32x32x16_bf16 v[64:79], v[196:199], v[20:23], v[64:79]
    v_max3_f32 v145, v145, v176, v177
    v_max3_f32 v145, v145, v178, v179
    v_max3_f32 v145, v145, v180, v181
    v_max3_f32 v145, v145, v182, v183
    v_mfma_f32_32x32x16_bf16 v[80:95], v[196:199], v[28:31], v[80:95]
    v_max3_f32 v145, v145, v184, v185
    v_max3_f32 v145, v145, v186, v187
    v_max3_f32 v145, v145, v188, v189
    v_max3_f32 v145, v145, v190, v191
    s_waitcnt vmcnt(13)
    v_mfma_f32_32x32x16_bf16 v[160:175], v[200:203], v[16:19], 0
    s_nop 0
    v_max3_f32 v144, v144, v64, v65
    v_max3_f32 v144, v144, v66, v67
    v_max3_f32 v144, v144, v68, v69
    v_max3_f32 v144, v144, v70, v71
    v_mfma_f32_32x32x16_bf16 v[176:191], v[200:203], v[24:27], 0
    v_max3_f32 v144, v144, v72, v73
    v_max3_f32 v144, v144, v74, v75
    v_max3_f32 v144, v144, v76, v77
    v_max3_f32 v144, v144, v78, v79
    s_waitcnt vmcnt(12)
    v_mfma_f32_32x32x16_bf16 v[160:175], v[204:207], v[20:23], v[160:175]
    v_max3_f32 v145, v145, v80, v81
    v_max3_f32 v145, v145, v82, v83
    v_max3_f32 v145, v145, v84, v85
    v_max3_f32 v145, v145, v86, v87
    v_mfma_f32_32x32x16_bf16 v[176:191], v[204:207], v[28:31], v[176:191]
    v_max3_f32 v145, v145, v88, v89
    v_max3_f32 v145, v145, v90, v91
    v_max3_f32 v145, v145, v92, v93
    v_max3_f32 v145, v145, v94, v95
    s_waitcnt vmcnt(11)
    v_mfma_f32_32x32x16_bf16 v[64:79], v[208:211], v[16:19], 0
    s_nop 0
    v_max3_f32 v144, v144, v160, v161
    v_max3_f32 v144, v144, v162, v163
    v_max3_f32 v144, v144, v164, v165
    v_max3_f32 v144, v144, v166, v167
    v_mfma_f32_32x32x16_bf16 v[80:95], v[208:211], v[24:27], 0
    v_max3_f32 v144, v144, v168, v169
    v_max3_f32 v144, v144, v170, v171
    v_max3_f32 v144, v144, v172, v173
    v_max3_f32 v144, v144, v174, v175
    s_waitcnt vmcnt(10)
    v_mfma_f32_32x32x16_bf16 v[64:79], v[212:215], v[20:23], v[64:79]
    v_max3_f32 v145, v145, v176, v177
    v_max3_f32 v145, v145, v178, v179
    v_max3_f32 v145, v145, v180, v181
    v_max3_f32 v145, v145, v182, v183
    v_mfma_f32_32x32x16_bf16 v[80:95], v[212:215], v[28:31], v[80:95]
    v_max3_f32 v145, v145, v184, v185
    v_max3_f32 v145, v145, v186, v187
    v_max3_f32 v145, v145, v188, v189
    v_max3_f32 v145, v145, v190, v191
    s_waitcnt vmcnt(9)
    v_mfma_f32_32x32x16_bf16 v[160:175], v[216:219], v[16:19], 0
    s_nop 0
    v_max3_f32 v144, v144, v64, v65
    v_max3_f32 v144, v144, v66, v67
    v_max3_f32 v144, v144, v68, v69
    v_max3_f32 v144, v144, v70, v71
    v_mfma_f32_32x32x16_bf16 v[176:191], v[216:219], v[24:27], 0
    v_max3_f32 v144, v144, v72, v73
    v_max3_f32 v144, v144, v74, v75
    v_max3_f32 v144, v144, v76, v77
    v_max3_f32 v144, v144, v78, v79
    s_waitcnt vmcnt(8)
    v_mfma_f32_32x32x16_bf16 v[160:175], v[220:223], v[20:23], v[160:175]
    v_max3_f32 v145, v145, v80, v81
    v_max3_f32 v145, v145, v82, v83
    v_max3_f32 v145, v145, v84, v85
    v_max3_f32 v145, v145, v86, v87
    v_mfma_f32_32x32x16_bf16 v[176:191], v[220:223], v[28:31], v[176:191]
    v_max3_f32 v145, v145, v88, v89
    v_max3_f32 v145, v145, v90, v91
    v_max3_f32 v145, v145, v92, v93
    v_max3_f32 v145, v145, v94, v95
    s_waitcnt vmcnt(7)
    v_mfma_f32_32x32x16_bf16 v[64:79], v[32:35], v[16:19], 0
    s_nop 0
    v_max3_f32 v144, v144, v160, v161
    v_max3_f32 v144, v144, v162, v163
    v_max3_f32 v144, v144, v164, v165
    v_max3_f32 v144, v144, v166, v167
    v_mfma_f32_32x32x16_bf16 v[80:95], v[32:35], v[24:27], 0
    v_max3_f32 v144, v144, v168, v169
    v_max3_f32 v144, v144, v170, v171
    v_max3_f32 v144, v144, v172, v173
    v_max3_f32 v144, v144, v174, v175
    s_waitcnt vmcnt(6)
    v_mfma_f32_32x32x16_bf16 v[64:79], v[36:39], v[20:23], v[64:79]
    v_max3_f32 v145, v145, v176, v177
    v_max3_f32 v145, v145, v178, v179
    v_max3_f32 v145, v145, v180, v181
    v_max3_f32 v145, v145, v182, v183
    v_mfma_f32_32x32x16_bf16 v[80:95], v[36:39], v[28:31], v[80:95]
    v_max3_f32 v145, v145, v184, v185
    v_max3_f32 v145, v145, v186, v187
    v_max3_f32 v145, v145, v188, v189
    v_max3_f32 v145, v145, v190, v191
    s_waitcnt vmcnt(5)
    v_mfma_f32_32x32x16_bf16 v[160:175], v[40:43], v[16:19], 0
    s_nop 0
    v_max3_f32 v144, v144, v64, v65
    v_max3_f32 v144, v144, v66, v67
    v_max3_f32 v144, v144, v68, v69
    v_max3_f32 v144, v144, v70, v71
    v_mfma_f32_32x32x16_bf16 v[176:191], v[40:43], v[24:27], 0
    v_max3_f32 v144, v144, v72, v73
    v_max3_f32 v144, v144, v74, v75
    v_max3_f32 v144, v144, v76, v77
    v_max3_f32 v144, v144, v78, v79
    s_waitcnt vmcnt(4)
    v_mfma_f32_32x32x16_bf16 v[160:175], v[44:47], v[20:23], v[160:175]
    v_max3_f32 v145, v145, v80, v81
    v_max3_f32 v145, v145, v82, v83
    v_max3_f32 v145, v145, v84, v85
    v_max3_f32 v145, v145, v86, v87
    v_mfma_f32_32x32x16_bf16 v[176:191], v[44:47], v[28:31], v[176:191]
    v_max3_f32 v145, v145, v88, v89
    v_max3_f32 v145, v145, v90, v91
    v_max3_f32 v145, v145, v92, v93
    v_max3_f32 v145, v145, v94, v95
    s_waitcnt vmcnt(3)
    v_mfma_f32_32x32x16_bf16 v[64:79], v[48:51], v[16:19], 0
    s_nop 0
    v_max3_f32 v144, v144, v160, v161
    v_max3_f32 v144, v144, v162, v163
    v_max3_f32 v144, v144, v164, v165
    v_max3_f32 v144, v144, v166, v167
    v_mfma_f32_32x32x16_bf16 v[80:95], v[48:51], v[24:27], 0
    v_max3_f32 v144, v144, v168, v169
    v_max3_f32 v144, v144, v170, v171
    v_max3_f32 v144, v144, v172, v173
    v_max3_f32 v144, v144, v174, v175
    s_waitcnt vmcnt(2)
    v_mfma_f32_32x32x16_bf16 v[64:79], v[52:55], v[20:23], v[64:79]
    v_max3_f32 v145, v145, v176, v177
    v_max3_f32 v145, v145, v178, v179
    v_max3_f32 v145, v145, v180, v181
    v_max3_f32 v145, v145, v182, v183
    v_mfma_f32_32x32x16_bf16 v[80:95], v[52:55], v[28:31], v[80:95]
    v_max3_f32 v145, v145, v184, v185
    v_max3_f32 v145, v145, v186, v187
    v_max3_f32 v145, v145, v188, v189
    v_max3_f32 v145, v145, v190, v191
    s_waitcnt vmcnt(1)
    v_mfma_f32_32x32x16_bf16 v[160:175], v[56:59], v[16:19], 0
    s_nop 0
    v_max3_f32 v144, v144, v64, v65
    v_max3_f32 v144, v144, v66, v67
    v_max3_f32 v144, v144, v68, v69
    v_max3_f32 v144, v144, v70, v71
    v_mfma_f32_32x32x16_bf16 v[176:191], v[56:59], v[24:27], 0
    v_max3_f32 v144, v144, v72, v73
    v_max3_f32 v144, v144, v74, v75
    v_max3_f32 v144, v144, v76, v77
    v_max3_f32 v144, v144, v78, v79
    s_waitcnt vmcnt(0)
    v_mfma_f32_32x32x16_bf16 v[160:175], v[60:63], v[20:23], v[160:175]
    v_max3_f32 v145, v145, v80, v81
    v_max3_f32 v145, v145, v82, v83
    v_max3_f32 v145, v145, v84, v85
    v_max3_f32 v145, v145, v86, v87
    v_mfma_f32_32x32x16_bf16 v[176:191], v[60:63], v[28:31], v[176:191]
    v_max3_f32 v145, v145, v88, v89
    v_max3_f32 v145, v145, v90, v91
    v_max3_f32 v145, v145, v92, v93
    v_max3_f32 v145, v145, v94, v95
    s_nop 2
    v_max3_f32 v144, v144, v160, v161
    v_max3_f32 v144, v144, v162, v163
    v_max3_f32 v144, v144, v164, v165
    v_max3_f32 v144, v144, v166, v167
    v_max3_f32 v144, v144, v168, v169
    v_max3_f32 v144, v144, v170, v171
    v_max3_f32 v144, v144, v172, v173
    v_max3_f32 v144, v144, v174, v175
    v_max3_f32 v145, v145, v176, v177
    v_max3_f32 v145, v145, v178, v179
    v_max3_f32 v145, v145, v180, v181
    v_max3_f32 v145, v145, v182, v183
    v_max3_f32 v145, v145, v184, v185
    v_max3_f32 v145, v145, v186, v187
    v_max3_f32 v145, v145, v188, v189
    v_max3_f32 v145, v145, v190, v191
    v_mov_b32 v32, 0
    v_mov_b32 v33, 0
    v_mov_b32 v34, 0
    v_mov_b32 v35, 0
    v_mov_b32 v36, 0
    v_mov_b32 v37, 0
    v_mov_b32 v38, 0
    v_mov_b32 v39, 0
    v_mov_b32 v40, 0
    v_mov_b32 v41, 0
    v_mov_b32 v42, 0
    v_mov_b32 v43, 0
    v_mov_b32 v44, 0
    v_mov_b32 v45, 0
    v_mov_b32 v46, 0
    v_mov_b32 v47, 0
    v_mov_b32 v48, 0
    v_mov_b32 v49, 0
    v_mov_b32 v50, 0
    v_mov_b32 v51, 0
    v_mov_b32 v52, 0
    v_mov_b32 v53, 0
    v_mov_b32 v54, 0
    v_mov_b32 v55, 0
    v_mov_b32 v56, 0
    v_mov_b32 v57, 0
    v_mov_b32 v58, 0
    v_mov_b32 v59, 0
    v_mov_b32 v60, 0
    v_mov_b32 v61, 0
    v_mov_b32 v62, 0
    v_mov_b32 v63, 0
    s_mov_b32 s35, s38
    buffer_load_dwordx4 v[112:115], v2, s[16:19], s35 offen offset:0
    buffer_load_dwordx4 v[116:119], v2, s[16:19], s35 offen offset:1024
    s_add_u32 s35, s35, 2048
    buffer_load_dwordx4 v[224:227], v3, s[20:23], s36 offen offset:0
    buffer_load_dwordx4 v[228:231], v3, s[20:23], s36 offen offset:1024
    s_add_u32 s36, s36, 2048
    buffer_load_dwordx4 v[120:123], v2, s[16:19], s35 offen offset:0
    buffer_load_dwordx4 v[124:127], v2, s[16:19], s35 offen offset:1024
    s_add_u32 s35, s35, 2048
    buffer_load_dwordx4 v[232:235], v3, s[20:23], s36 offen offset:0
    buffer_load_dwordx4 v[236:239], v3, s[20:23], s36 offen offset:1024
    s_add_u32 s36, s36, 2048
    buffer_load_dwordx4 v[128:131], v2, s[16:19], s35 offen offset:0
    buffer_load_dwordx4 v[132:135], v2, s[16:19], s35 offen offset:1024
    s_add_u32 s35, s35, 2048
    buffer_load_dwordx4 v[240:243], v3, s[20:23], s36 offen offset:0
    buffer_load_dwordx4 v[244:247], v3, s[20:23], s36 offen offset:1024
    s_add_u32 s36, s36, 2048
    buffer_load_dwordx4 v[136:139], v2, s[16:19], s35 offen offset:0
    buffer_load_dwordx4 v[140:143], v2, s[16:19], s35 offen offset:1024
    s_add_u32 s35, s35, 2048
    v_mov_b32 v146, v144
    s_nop 1
    v_permlane32_swap_b32 v144, v146
    v_max_f32 v144, v144, v146
    v_sub_f32 v192, 0, v144
    v_sub_f32 v193, 0, v144
    v_sub_f32 v194, 0, v144
    v_sub_f32 v195, 0, v144
    v_sub_f32 v196, 0, v144
    v_sub_f32 v197, 0, v144
    v_sub_f32 v198, 0, v144
    v_sub_f32 v199, 0, v144
    v_sub_f32 v200, 0, v144
    v_sub_f32 v201, 0, v144
    v_sub_f32 v202, 0, v144
    v_sub_f32 v203, 0, v144
    v_sub_f32 v204, 0, v144
    v_sub_f32 v205, 0, v144
    v_sub_f32 v206, 0, v144
    v_sub_f32 v207, 0, v144
    v_mov_b32 v146, v145
    s_nop 1
    v_permlane32_swap_b32 v145, v146
    v_max_f32 v145, v145, v146
    v_sub_f32 v208, 0, v145
    v_sub_f32 v209, 0, v145
    v_sub_f32 v210, 0, v145
    v_sub_f32 v211, 0, v145
    v_sub_f32 v212, 0, v145
    v_sub_f32 v213, 0, v145
    v_sub_f32 v214, 0, v145
    v_sub_f32 v215, 0, v145
    v_sub_f32 v216, 0, v145
    v_sub_f32 v217, 0, v145
    v_sub_f32 v218, 0, v145
    v_sub_f32 v219, 0, v145
    v_sub_f32 v220, 0, v145
    v_sub_f32 v221, 0, v145
    v_sub_f32 v222, 0, v145
    v_sub_f32 v223, 0, v145
    s_waitcnt vmcnt(13)
    v_mfma_f32_32x32x16_bf16 v[64:79], v[112:115], v[16:19], v[192:207]
    v_mfma_f32_32x32x16_bf16 v[80:95], v[112:115], v[24:27], v[208:223]
    s_waitcnt vmcnt(12)
    v_mfma_f32_32x32x16_bf16 v[64:79], v[116:119], v[20:23], v[64:79]
    v_mfma_f32_32x32x16_bf16 v[80:95], v[116:119], v[28:31], v[80:95]
    s_mov_b32 s37, 0
    s_nop 10
k2a_kernel_loop2:
    buffer_load_dwordx4 v[248:251], v3, s[20:23], s36 offen offset:0
    buffer_load_dwordx4 v[252:255], v3, s[20:23], s36 offen offset:1024
    s_add_u32 s36, s36, 2048
    s_waitcnt vmcnt(11)
    v_mfma_f32_32x32x16_bf16 v[160:175], v[120:123], v[16:19], v[192:207]
    v_exp_f32 v64, v64
    v_exp_f32 v65, v65
    v_exp_f32 v66, v66
    v_exp_f32 v67, v67
    v_mfma_f32_32x32x16_bf16 v[176:191], v[120:123], v[24:27], v[208:223]
    v_exp_f32 v68, v68
    v_exp_f32 v69, v69
    v_exp_f32 v70, v70
    v_exp_f32 v71, v71
    s_waitcnt vmcnt(10)
    v_mfma_f32_32x32x16_bf16 v[160:175], v[124:127], v[20:23], v[160:175]
    v_exp_f32 v72, v72
    v_exp_f32 v73, v73
    v_exp_f32 v74, v74
    v_exp_f32 v75, v75
    v_mfma_f32_32x32x16_bf16 v[176:191], v[124:127], v[28:31], v[176:191]
    v_exp_f32 v76, v76
    v_exp_f32 v77, v77
    v_exp_f32 v78, v78
    v_exp_f32 v79, v79
    buffer_load_dwordx4 v[112:115], v2, s[16:19], s35 offen offset:0
    buffer_load_dwordx4 v[116:119], v2, s[16:19], s35 offen offset:1024
    s_add_u32 s35, s35, 2048
    v_cvt_pk_bf16_f32 v96, v64, v65
    v_cvt_pk_bf16_f32 v97, v66, v67
    v_cvt_pk_bf16_f32 v98, v68, v69
    v_cvt_pk_bf16_f32 v99, v70, v71
    v_cvt_pk_bf16_f32 v100, v72, v73
    v_cvt_pk_bf16_f32 v101, v74, v75
    v_cvt_pk_bf16_f32 v102, v76, v77
    v_cvt_pk_bf16_f32 v103, v78, v79
    v_mfma_f32_32x32x16_bf16 v[32:47], v[224:227], v[96:99], v[32:47]
    v_exp_f32 v80, v80
    v_exp_f32 v81, v81
    v_exp_f32 v82, v82
    v_exp_f32 v83, v83
    v_mfma_f32_32x32x16_bf16 v[32:47], v[228:231], v[100:103], v[32:47]
    v_exp_f32 v84, v84
    v_exp_f32 v85, v85
    v_exp_f32 v86, v86
    v_exp_f32 v87, v87
    v_exp_f32 v88, v88
    v_exp_f32 v89, v89
    v_exp_f32 v90, v90
    v_exp_f32 v91, v91
    v_exp_f32 v92, v92
    v_exp_f32 v93, v93
    v_exp_f32 v94, v94
    v_exp_f32 v95, v95
    v_cvt_pk_bf16_f32 v104, v80, v81
    v_cvt_pk_bf16_f32 v105, v82, v83
    v_cvt_pk_bf16_f32 v106, v84, v85
    v_cvt_pk_bf16_f32 v107, v86, v87
    v_cvt_pk_bf16_f32 v108, v88, v89
    v_cvt_pk_bf16_f32 v109, v90, v91
    v_cvt_pk_bf16_f32 v110, v92, v93
    v_cvt_pk_bf16_f32 v111, v94, v95
    v_mfma_f32_32x32x16_bf16 v[48:63], v[224:227], v[104:107], v[48:63]
    s_nop 0
    v_mfma_f32_32x32x16_bf16 v[48:63], v[228:231], v[108:111], v[48:63]
    buffer_load_dwordx4 v[224:227], v3, s[20:23], s36 offen offset:0
    buffer_load_dwordx4 v[228:231], v3, s[20:23], s36 offen offset:1024
    s_add_u32 s36, s36, 2048
    s_waitcnt vmcnt(11)
    v_mfma_f32_32x32x16_bf16 v[64:79], v[128:131], v[16:19], v[192:207]
    v_exp_f32 v160, v160
    v_exp_f32 v161, v161
    v_exp_f32 v162, v162
    v_exp_f32 v163, v163
    v_mfma_f32_32x32x16_bf16 v[80:95], v[128:131], v[24:27], v[208:223]
    v_exp_f32 v164, v164
    v_exp_f32 v165, v165
    v_exp_f32 v166, v166
    v_exp_f32 v167, v167
    s_waitcnt vmcnt(10)
    v_mfma_f32_32x32x16_bf16 v[64:79], v[132:135], v[20:23], v[64:79]
    v_exp_f32 v168, v168
    v_exp_f32 v169, v169
    v_exp_f32 v170, v170
    v_exp_f32 v171, v171
    v_mfma_f32_32x32x16_bf16 v[80:95], v[132:135], v[28:31], v[80:95]
    v_exp_f32 v172, v172
    v_exp_f32 v173, v173
    v_exp_f32 v174, v174
    v_exp_f32 v175, v175
    buffer_load_dwordx4 v[120:123], v2, s[16:19], s35 offen offset:0
    buffer_load_dwordx4 v[124:127], v2, s[16:19], s35 offen offset:1024
    s_add_u32 s35, s35, 2048
    v_cvt_pk_bf16_f32 v96, v160, v161
    v_cvt_pk_bf16_f32 v97, v162, v163
    v_cvt_pk_bf16_f32 v98, v164, v165
    v_cvt_pk_bf16_f32 v99, v166, v167
    v_cvt_pk_bf16_f32 v100, v168, v169
    v_cvt_pk_bf16_f32 v101, v170, v171
    v_cvt_pk_bf16_f32 v102, v172, v173
    v_cvt_pk_bf16_f32 v103, v174, v175
    v_mfma_f32_32x32x16_bf16 v[32:47], v[232:235], v[96:99], v[32:47]
    v_exp_f32 v176, v176
    v_exp_f32 v177, v177
    v_exp_f32 v178, v178
    v_exp_f32 v179, v179
    v_mfma_f32_32x32x16_bf16 v[32:47], v[236:239], v[100:103], v[32:47]
    v_exp_f32 v180, v180
    v_exp_f32 v181, v181
    v_exp_f32 v182, v182
    v_exp_f32 v183, v183
    v_exp_f32 v184, v184
    v_exp_f32 v185, v185
    v_exp_f32 v186, v186
    v_exp_f32 v187, v187
    v_exp_f32 v188, v188
    v_exp_f32 v189, v189
    v_exp_f32 v190, v190
    v_exp_f32 v191, v191
    v_cvt_pk_bf16_f32 v104, v176, v177
    v_cvt_pk_bf16_f32 v105, v178, v179
    v_cvt_pk_bf16_f32 v106, v180, v181
    v_cvt_pk_bf16_f32 v107, v182, v183
    v_cvt_pk_bf16_f32 v108, v184, v185
    v_cvt_pk_bf16_f32 v109, v186, v187
    v_cvt_pk_bf16_f32 v110, v188, v189
    v_cvt_pk_bf16_f32 v111, v190, v191
    v_mfma_f32_32x32x16_bf16 v[48:63], v[232:235], v[104:107], v[48:63]
    s_nop 0
    v_mfma_f32_32x32x16_bf16 v[48:63], v[236:239], v[108:111], v[48:63]
    buffer_load_dwordx4 v[232:235], v3, s[20:23], s36 offen offset:0
    buffer_load_dwordx4 v[236:239], v3, s[20:23], s36 offen offset:1024
    s_add_u32 s36, s36, 2048
    s_waitcnt vmcnt(11)
    v_mfma_f32_32x32x16_bf16 v[160:175], v[136:139], v[16:19], v[192:207]
    v_exp_f32 v64, v64
    v_exp_f32 v65, v65
    v_exp_f32 v66, v66
    v_exp_f32 v67, v67
    v_mfma_f32_32x32x16_bf16 v[176:191], v[136:139], v[24:27], v[208:223]
    v_exp_f32 v68, v68
    v_exp_f32 v69, v69
    v_exp_f32 v70, v70
    v_exp_f32 v71, v71
    s_waitcnt vmcnt(10)
    v_mfma_f32_32x32x16_bf16 v[160:175], v[140:143], v[20:23], v[160:175]
    v_exp_f32 v72, v72
    v_exp_f32 v73, v73
    v_exp_f32 v74, v74
    v_exp_f32 v75, v75
    v_mfma_f32_32x32x16_bf16 v[176:191], v[140:143], v[28:31], v[176:191]
    v_exp_f32 v76, v76
    v_exp_f32 v77, v77
    v_exp_f32 v78, v78
    v_exp_f32 v79, v79
    buffer_load_dwordx4 v[128:131], v2, s[16:19], s35 offen offset:0
    buffer_load_dwordx4 v[132:135], v2, s[16:19], s35 offen offset:1024
    s_add_u32 s35, s35, 2048
    v_cvt_pk_bf16_f32 v96, v64, v65
    v_cvt_pk_bf16_f32 v97, v66, v67
    v_cvt_pk_bf16_f32 v98, v68, v69
    v_cvt_pk_bf16_f32 v99, v70, v71
    v_cvt_pk_bf16_f32 v100, v72, v73
    v_cvt_pk_bf16_f32 v101, v74, v75
    v_cvt_pk_bf16_f32 v102, v76, v77
    v_cvt_pk_bf16_f32 v103, v78, v79
    v_mfma_f32_32x32x16_bf16 v[32:47], v[240:243], v[96:99], v[32:47]
    v_exp_f32 v80, v80
    v_exp_f32 v81, v81
    v_exp_f32 v82, v82
    v_exp_f32 v83, v83
    v_mfma_f32_32x32x16_bf16 v[32:47], v[244:247], v[100:103], v[32:47]
    v_exp_f32 v84, v84
    v_exp_f32 v85, v85
    v_exp_f32 v86, v86
    v_exp_f32 v87, v87
    v_exp_f32 v88, v88
    v_exp_f32 v89, v89
    v_exp_f32 v90, v90
    v_exp_f32 v91, v91
    v_exp_f32 v92, v92
    v_exp_f32 v93, v93
    v_exp_f32 v94, v94
    v_exp_f32 v95, v95
    v_cvt_pk_bf16_f32 v104, v80, v81
    v_cvt_pk_bf16_f32 v105, v82, v83
    v_cvt_pk_bf16_f32 v106, v84, v85
    v_cvt_pk_bf16_f32 v107, v86, v87
    v_cvt_pk_bf16_f32 v108, v88, v89
    v_cvt_pk_bf16_f32 v109, v90, v91
    v_cvt_pk_bf16_f32 v110, v92, v93
    v_cvt_pk_bf16_f32 v111, v94, v95
    v_mfma_f32_32x32x16_bf16 v[48:63], v[240:243], v[104:107], v[48:63]
    s_nop 0
    v_mfma_f32_32x32x16_bf16 v[48:63], v[244:247], v[108:111], v[48:63]
    buffer_load_dwordx4 v[240:243], v3, s[20:23], s36 offen offset:0
    buffer_load_dwordx4 v[244:247], v3, s[20:23], s36 offen offset:1024
    s_add_u32 s36, s36, 2048
    s_waitcnt vmcnt(11)
    v_mfma_f32_32x32x16_bf16 v[64:79], v[112:115], v[16:19], v[192:207]
    v_exp_f32 v160, v160
    v_exp_f32 v161, v161
    v_exp_f32 v162, v162
    v_exp_f32 v163, v163
    v_mfma_f32_32x32x16_bf16 v[80:95], v[112:115], v[24:27], v[208:223]
    v_exp_f32 v164, v164
    v_exp_f32 v165, v165
    v_exp_f32 v166, v166
    v_exp_f32 v167, v167
    s_waitcnt vmcnt(10)
    v_mfma_f32_32x32x16_bf16 v[64:79], v[116:119], v[20:23], v[64:79]
    v_exp_f32 v168, v168
    v_exp_f32 v169, v169
    v_exp_f32 v170, v170
    v_exp_f32 v171, v171
    v_mfma_f32_32x32x16_bf16 v[80:95], v[116:119], v[28:31], v[80:95]
    v_exp_f32 v172, v172
    v_exp_f32 v173, v173
    v_exp_f32 v174, v174
    v_exp_f32 v175, v175
    buffer_load_dwordx4 v[136:139], v2, s[16:19], s35 offen offset:0
    buffer_load_dwordx4 v[140:143], v2, s[16:19], s35 offen offset:1024
    s_add_u32 s35, s35, 2048
    v_cvt_pk_bf16_f32 v96, v160, v161
    v_cvt_pk_bf16_f32 v97, v162, v163
    v_cvt_pk_bf16_f32 v98, v164, v165
    v_cvt_pk_bf16_f32 v99, v166, v167
    v_cvt_pk_bf16_f32 v100, v168, v169
    v_cvt_pk_bf16_f32 v101, v170, v171
    v_cvt_pk_bf16_f32 v102, v172, v173
    v_cvt_pk_bf16_f32 v103, v174, v175
    v_mfma_f32_32x32x16_bf16 v[32:47], v[248:251], v[96:99], v[32:47]
    v_exp_f32 v176, v176
    v_exp_f32 v177, v177
    v_exp_f32 v178, v178
    v_exp_f32 v179, v179
    v_mfma_f32_32x32x16_bf16 v[32:47], v[252:255], v[100:103], v[32:47]
    v_exp_f32 v180, v180
    v_exp_f32 v181, v181
    v_exp_f32 v182, v182
    v_exp_f32 v183, v183
    v_exp_f32 v184, v184
    v_exp_f32 v185, v185
    v_exp_f32 v186, v186
    v_exp_f32 v187, v187
    v_exp_f32 v188, v188
    v_exp_f32 v189, v189
    v_exp_f32 v190, v190
    v_exp_f32 v191, v191
    v_cvt_pk_bf16_f32 v104, v176, v177
    v_cvt_pk_bf16_f32 v105, v178, v179
    v_cvt_pk_bf16_f32 v106, v180, v181
    v_cvt_pk_bf16_f32 v107, v182, v183
    v_cvt_pk_bf16_f32 v108, v184, v185
    v_cvt_pk_bf16_f32 v109, v186, v187
    v_cvt_pk_bf16_f32 v110, v188, v189
    v_cvt_pk_bf16_f32 v111, v190, v191
    v_mfma_f32_32x32x16_bf16 v[48:63], v[248:251], v[104:107], v[48:63]
    s_nop 0
    v_mfma_f32_32x32x16_bf16 v[48:63], v[252:255], v[108:111], v[48:63]
    s_add_u32 s37, s37, 1
    s_cmp_lt_u32 s37, 4
    s_nop 9
    s_cbranch_scc1 k2a_kernel_loop2
    s_waitcnt vmcnt(0) lgkmcnt(0)
    v_and_b32 v4, 31, v1
    v_lshlrev_b32 v4, 2, v4
    s_lshl_b32 s38, s32, 8
    v_add_u32 v5, s38, v4
    ds_write_b32 v5, v144
    ds_write_b32 v5, v145 offset:128
    s_waitcnt lgkmcnt(0)
    s_barrier
    ds_read_b32 v146, v4 offset:0
    ds_read_b32 v150, v4 offset:128
    ds_read_b32 v147, v4 offset:256
    ds_read_b32 v151, v4 offset:384
    ds_read_b32 v148, v4 offset:512
    ds_read_b32 v152, v4 offset:640
    ds_read_b32 v149, v4 offset:768
    ds_read_b32 v153, v4 offset:896
    s_waitcnt lgkmcnt(3)
    v_max3_f32 v146, v146, v147, v148
    s_waitcnt lgkmcnt(1)
    v_max_f32 v146, v146, v149
    v_max3_f32 v150, v150, v151, v152
    s_waitcnt lgkmcnt(0)
    v_max_f32 v150, v150, v153
    v_sub_f32 v146, v144, v146
    v_sub_f32 v150, v145, v150
    v_exp_f32 v146, v146
    v_exp_f32 v150, v150
    v_mul_f32 v32, v32, v146
    v_mul_f32 v48, v48, v150
    v_mul_f32 v33, v33, v146
    v_mul_f32 v49, v49, v150
    v_mul_f32 v34, v34, v146
    v_mul_f32 v50, v50, v150
    v_mul_f32 v35, v35, v146
    v_mul_f32 v51, v51, v150
    v_mul_f32 v36, v36, v146
    v_mul_f32 v52, v52, v150
    v_mul_f32 v37, v37, v146
    v_mul_f32 v53, v53, v150
    v_mul_f32 v38, v38, v146
    v_mul_f32 v54, v54, v150
    v_mul_f32 v39, v39, v146
    v_mul_f32 v55, v55, v150
    v_mul_f32 v40, v40, v146
    v_mul_f32 v56, v56, v150
    v_mul_f32 v41, v41, v146
    v_mul_f32 v57, v57, v150
    v_mul_f32 v42, v42, v146
    v_mul_f32 v58, v58, v150
    v_mul_f32 v43, v43, v146
    v_mul_f32 v59, v59, v150
    v_mul_f32 v44, v44, v146
    v_mul_f32 v60, v60, v150
    v_mul_f32 v45, v45, v146
    v_mul_f32 v61, v61, v150
    v_mul_f32 v46, v46, v146
    v_mul_f32 v62, v62, v150
    v_mul_f32 v47, v47, v146
    v_mul_f32 v63, v63, v150
    s_lshl_b32 s38, s32, 13
    v_add_u32 v5, s38, v3
    ds_write_b128 v5, v[32:35] offset:1024
    ds_write_b128 v5, v[36:39] offset:2048
    ds_write_b128 v5, v[40:43] offset:3072
    ds_write_b128 v5, v[44:47] offset:4096
    ds_write_b128 v5, v[48:51] offset:5120
    ds_write_b128 v5, v[52:55] offset:6144
    ds_write_b128 v5, v[56:59] offset:7168
    ds_write_b128 v5, v[60:63] offset:8192
    s_waitcnt lgkmcnt(0)
    s_barrier
    s_and_b32 s38, s32, 1
    s_lshr_b32 s39, s32, 1
    s_lshl_b32 s41, s38, 12
    s_lshl_b32 s42, s39, 11
    s_add_u32 s41, s41, s42
    v_add_u32 v5, s41, v3
    ds_read_b128 v[64:67], v5 offset:1024
    ds_read_b128 v[68:71], v5 offset:2048
    ds_read_b128 v[72:75], v5 offset:9216
    ds_read_b128 v[76:79], v5 offset:10240
    ds_read_b128 v[80:83], v5 offset:17408
    ds_read_b128 v[84:87], v5 offset:18432
    ds_read_b128 v[88:91], v5 offset:25600
    ds_read_b128 v[92:95], v5 offset:26624
    v_and_b32 v6, 31, v1
    v_lshlrev_b32 v6, 4, v6
    s_lshl_b32 s41, s38, 12
    v_add_u32 v6, s41, v6
    ds_read_b32 v100, v6 offset:4608
    ds_read_b32 v101, v6 offset:12800
    ds_read_b32 v102, v6 offset:20992
    ds_read_b32 v103, v6 offset:29184
    s_waitcnt lgkmcnt(9)
    v_add_f32 v64, v64, v72
    s_waitcnt lgkmcnt(5)
    v_add_f32 v80, v80, v88
    v_add_f32 v64, v64, v80
    v_add_f32 v65, v65, v73
    v_add_f32 v81, v81, v89
    v_add_f32 v65, v65, v81
    v_add_f32 v66, v66, v74
    v_add_f32 v82, v82, v90
    v_add_f32 v66, v66, v82
    v_add_f32 v67, v67, v75
    v_add_f32 v83, v83, v91
    v_add_f32 v67, v67, v83
    v_add_f32 v68, v68, v76
    s_waitcnt lgkmcnt(4)
    v_add_f32 v84, v84, v92
    v_add_f32 v68, v68, v84
    v_add_f32 v69, v69, v77
    v_add_f32 v85, v85, v93
    v_add_f32 v69, v69, v85
    v_add_f32 v70, v70, v78
    v_add_f32 v86, v86, v94
    v_add_f32 v70, v70, v86
    v_add_f32 v71, v71, v79
    v_add_f32 v87, v87, v95
    v_add_f32 v71, v71, v87
    s_waitcnt lgkmcnt(2)
    v_add_f32 v100, v100, v101
    s_waitcnt lgkmcnt(0)
    v_add_f32 v102, v102, v103
    v_add_f32 v100, v100, v102
    v_rcp_f32 v100, v100
    s_nop 0
    v_mul_f32 v64, v64, v100
    v_mul_f32 v65, v65, v100
    v_mul_f32 v66, v66, v100
    v_mul_f32 v67, v67, v100
    v_mul_f32 v68, v68, v100
    v_mul_f32 v69, v69, v100
    v_mul_f32 v70, v70, v100
    v_mul_f32 v71, v71, v100
    s_lshl_b32 s41, s31, 1
    s_add_u32 s41, s41, s38
    s_mul_i32 s41, s41, 28672
    s_mul_i32 s42, s30, 28
    s_lshl_b32 s43, s39, 4
    s_add_u32 s42, s42, s43
    v_lshrrev_b32 v7, 5, v1
    v_lshlrev_b32 v7, 2, v7
    v_and_b32 v8, 31, v1
    v_add_u32 v9, 0, v7
    v_add_u32 v9, s42, v9
    v_lshrrev_b32 v10, 4, v9
    v_lshlrev_b32 v10, 10, v10
    v_bfe_u32 v11, v9, 3, 1
    v_lshl_add_u32 v11, v11, 5, v8
    v_lshl_add_u32 v10, v11, 4, v10
    v_and_b32 v11, 7, v9
    v_lshl_add_u32 v10, v11, 1, v10
    v_cvt_pk_bf16_f32 v12, v64, v65
    v_cvt_pk_bf16_f32 v13, v66, v67
    s_mul_i32 s43, s30, 28
    v_subrev_u32 v14, s43, v9
    v_cmp_gt_u32 vcc, 28, v14
    s_and_saveexec_b64 s[44:45], vcc
    buffer_store_dwordx2 v[12:13], v10, s[24:27], s41 offen
    s_mov_b64 exec, s[44:45]
    v_add_u32 v9, 8, v7
    v_add_u32 v9, s42, v9
    v_lshrrev_b32 v10, 4, v9
    v_lshlrev_b32 v10, 10, v10
    v_bfe_u32 v11, v9, 3, 1
    v_lshl_add_u32 v11, v11, 5, v8
    v_lshl_add_u32 v10, v11, 4, v10
    v_and_b32 v11, 7, v9
    v_lshl_add_u32 v10, v11, 1, v10
    v_cvt_pk_bf16_f32 v12, v68, v69
    v_cvt_pk_bf16_f32 v13, v70, v71
    s_mul_i32 s43, s30, 28
    v_subrev_u32 v14, s43, v9
    v_cmp_gt_u32 vcc, 28, v14
    s_and_saveexec_b64 s[44:45], vcc
    buffer_store_dwordx2 v[12:13], v10, s[24:27], s41 offen
    s_mov_b64 exec, s[44:45]
    s_endpgm
.section .rodata,"a"
.p2align 6
.amdhsa_kernel k2a_kernel
  .amdhsa_next_free_vgpr 256
  .amdhsa_next_free_sgpr 64
  .amdhsa_accum_offset 256
  .amdhsa_group_segment_fixed_size 0
  .amdhsa_kernarg_size 80
  .amdhsa_user_sgpr_count 2
  .amdhsa_user_sgpr_kernarg_segment_ptr 1
  .amdhsa_system_sgpr_workgroup_id_x 1
.end_amdhsa_kernel
.text
.globl k3a_kernel
.p2align 8
.type k3a_kernel,@function
k3a_kernel:
    s_cmp_ge_u32 s2, 224
    s_cbranch_scc0 k3a_kernel_go1
    s_endpgm
k3a_kernel_go1:
    s_load_dwordx2 s[4:5], s[0:1], 72
    s_load_dwordx2 s[6:7], s[0:1], 0
    s_waitcnt lgkmcnt(0)
    s_add_u32 s12, s4, 14680064
    s_addc_u32 s13, s5, 0
    s_mov_b32 s14, 1835008
    s_mov_b32 s15, 0x00020000
    s_add_u32 s16, s4, 1441792
    s_addc_u32 s17, s5, 0
    s_mov_b32 s18, 401408
    s_mov_b32 s19, 0x00020000
    s_mov_b32 s20, s6
    s_mov_b32 s21, s7
    s_mov_b32 s22, 1835008
    s_mov_b32 s23, 0x00020000
    s_add_u32 s24, s4, 16777216
    s_addc_u32 s25, s5, 0
    s_mov_b32 s26, 1835008
    s_mov_b32 s27, 0x00020000
    s_add_u32 s28, s4, 31719424
    s_addc_u32 s29, s5, 0
    s_mov_b32 s30, 229376
    s_mov_b32 s31, 0x00020000
    v_lshrrev_b32 v1, 6, v0
    s_nop 0
    v_readfirstlane_b32 s32, v1
    s_and_b32 s33, s2, 7
    s_lshl_b32 s33, s33, 2
    s_bfe_u32 s34, s2, 0x20003
    s_add_u32 s33, s33, s34
    s_lshr_b32 s34, s2, 5
    v_and_b32 v1, 63, v0
    v_lshlrev_b32 v2, 4, v1
    s_lshr_b32 s35, s32, 1
    s_and_b32 s36, s32, 1
    s_lshl_b32 s37, s33, 6
    s_lshl_b32 s38, s35, 5
    s_add_u32 s37, s37, s38
    v_and_b32 v3, 31, v1
    v_add_u32 v3, s37, v3
    v_mul_u32_u24 v4, 896, v3
    v_lshrrev_b32 v5, 5, v1
    v_lshl_add_u32 v4, v5, 3, v4
    s_lshl_b32 s38, s34, 7
    s_lshl_b32 s39, s36, 6
    s_add_u32 s38, s38, s39
    buffer_load_dwordx2 v[8:9], v4, s[20:23], s38 offen offset:0
    buffer_load_dwordx2 v[10:11], v4, s[20:23], s38 offen offset:16
    buffer_load_dwordx2 v[12:13], v4, s[20:23], s38 offen offset:32
    buffer_load_dwordx2 v[14:15], v4, s[20:23], s38 offen offset:48
    s_mul_i32 s40, s32, 7168
    s_mul_i32 s41, s33, 57344
    s_add_u32 s41, s41, s40
    s_add_u32 s42, s41, 28672
    s_mul_i32 s43, s34, 57344
    s_add_u32 s43, s43, s40
    s_add_u32 s44, s43, 28672
    buffer_load_dwordx4 v[80:83], v2, s[12:15], s41 offen offset:0
    buffer_load_dwordx4 v[84:87], v2, s[12:15], s42 offen offset:0
    buffer_load_dwordx4 v[88:91], v2, s[16:19], s43 offen offset:0
    buffer_load_dwordx4 v[92:95], v2, s[16:19], s44 offen offset:0
    buffer_load_dwordx4 v[96:99], v2, s[12:15], s41 offen offset:1024
    buffer_load_dwordx4 v[100:103], v2, s[12:15], s42 offen offset:1024
    buffer_load_dwordx4 v[104:107], v2, s[16:19], s43 offen offset:1024
    buffer_load_dwordx4 v[108:111], v2, s[16:19], s44 offen offset:1024
    buffer_load_dwordx4 v[112:115], v2, s[12:15], s41 offen offset:2048
    buffer_load_dwordx4 v[116:119], v2, s[12:15], s42 offen offset:2048
    buffer_load_dwordx4 v[120:123], v2, s[16:19], s43 offen offset:2048
    buffer_load_dwordx4 v[124:127], v2, s[16:19], s44 offen offset:2048
    buffer_load_dwordx4 v[128:131], v2, s[12:15], s41 offen offset:3072
    buffer_load_dwordx4 v[132:135], v2, s[12:15], s42 offen offset:3072
    buffer_load_dwordx4 v[136:139], v2, s[16:19], s43 offen offset:3072
    buffer_load_dwordx4 v[140:143], v2, s[16:19], s44 offen offset:3072
    s_add_u32 s41, s41, 4096
    s_add_u32 s42, s42, 4096
    s_add_u32 s43, s43, 4096
    s_add_u32 s44, s44, 4096
    buffer_load_dwordx4 v[144:147], v2, s[12:15], s41 offen offset:0
    buffer_load_dwordx4 v[148:151], v2, s[12:15], s42 offen offset:0
    buffer_load_dwordx4 v[152:155], v2, s[16:19], s43 offen offset:0
    buffer_load_dwordx4 v[156:159], v2, s[16:19], s44 offen offset:0
    buffer_load_dwordx4 v[160:163], v2, s[12:15], s41 offen offset:1024
    buffer_load_dwordx4 v[164:167], v2, s[12:15], s42 offen offset:1024
    buffer_load_dwordx4 v[168:171], v2, s[16:19], s43 offen offset:1024
    buffer_load_dwordx4 v[172:175], v2, s[16:19], s44 offen offset:1024
    buffer_load_dwordx4 v[176:179], v2, s[12:15], s41 offen offset:2048
    buffer_load_dwordx4 v[180:183], v2, s[12:15], s42 offen offset:2048
    buffer_load_dwordx4 v[184:187], v2, s[16:19], s43 offen offset:2048
    buffer_load_dwordx4 v[188:191], v2, s[16:19], s44 offen offset:2048
    s_add_u32 s41, s41, 3072
    s_add_u32 s42, s42, 3072
    s_add_u32 s43, s43, 3072
    s_add_u32 s44, s44, 3072
    s_waitcnt vmcnt(25)
    v_mfma_f32_32x32x16_bf16 v[16:31], v[88:91], v[80:83], 0
    s_waitcnt vmcnt(24)
    v_mfma_f32_32x32x16_bf16 v[32:47], v[92:95], v[80:83], 0
    v_mfma_f32_32x32x16_bf16 v[48:63], v[88:91], v[84:87], 0
    v_mfma_f32_32x32x16_bf16 v[64:79], v[92:95], v[84:87], 0
    s_waitcnt vmcnt(21)
    v_mfma_f32_32x32x16_bf16 v[16:31], v[104:107], v[96:99], v[16:31]
    s_waitcnt vmcnt(20)
    v_mfma_f32_32x32x16_bf16 v[32:47], v[108:111], v[96:99], v[32:47]
    v_mfma_f32_32x32x16_bf16 v[48:63], v[104:107], v[100:103], v[48:63]
    v_mfma_f32_32x32x16_bf16 v[64:79], v[108:111], v[100:103], v[64:79]
    s_waitcnt vmcnt(17)
    v_mfma_f32_32x32x16_bf16 v[16:31], v[120:123], v[112:115], v[16:31]
    s_waitcnt vmcnt(16)
    v_mfma_f32_32x32x16_bf16 v[32:47], v[124:127], v[112:115], v[32:47]
    v_mfma_f32_32x32x16_bf16 v[48:63], v[120:123], v[116:119], v[48:63]
    v_mfma_f32_32x32x16_bf16 v[64:79], v[124:127], v[116:119], v[64:79]
    s_waitcnt vmcnt(13)
    v_mfma_f32_32x32x16_bf16 v[16:31], v[136:139], v[128:131], v[16:31]
    s_waitcnt vmcnt(12)
    v_mfma_f32_32x32x16_bf16 v[32:47], v[140:143], v[128:131], v[32:47]
    v_mfma_f32_32x32x16_bf16 v[48:63], v[136:139], v[132:135], v[48:63]
    v_mfma_f32_32x32x16_bf16 v[64:79], v[140:143], v[132:135], v[64:79]
    s_waitcnt vmcnt(9)
    v_mfma_f32_32x32x16_bf16 v[16:31], v[152:155], v[144:147], v[16:31]
    s_waitcnt vmcnt(8)
    v_mfma_f32_32x32x16_bf16 v[32:47], v[156:159], v[144:147], v[32:47]
    v_mfma_f32_32x32x16_bf16 v[48:63], v[152:155], v[148:151], v[48:63]
    v_mfma_f32_32x32x16_bf16 v[64:79], v[156:159], v[148:151], v[64:79]
    s_waitcnt vmcnt(5)
    v_mfma_f32_32x32x16_bf16 v[16:31], v[168:171], v[160:163], v[16:31]
    s_waitcnt vmcnt(4)
    v_mfma_f32_32x32x16_bf16 v[32:47], v[172:175], v[160:163], v[32:47]
    v_mfma_f32_32x32x16_bf16 v[48:63], v[168:171], v[164:167], v[48:63]
    v_mfma_f32_32x32x16_bf16 v[64:79], v[172:175], v[164:167], v[64:79]
    s_waitcnt vmcnt(1)
    v_mfma_f32_32x32x16_bf16 v[16:31], v[184:187], v[176:179], v[16:31]
    s_waitcnt vmcnt(0)
    v_mfma_f32_32x32x16_bf16 v[32:47], v[188:191], v[176:179], v[32:47]
    v_mfma_f32_32x32x16_bf16 v[48:63], v[184:187], v[180:183], v[48:63]
    v_mfma_f32_32x32x16_bf16 v[64:79], v[188:191], v[180:183], v[64:79]
    s_lshl_b32 s40, s32, 14
    v_add_u32 v5, s40, v2
    s_nop 5
    ds_write_b128 v5, v[16:19] offset:0
    ds_write_b128 v5, v[20:23] offset:1024
    ds_write_b128 v5, v[24:27] offset:2048
    ds_write_b128 v5, v[28:31] offset:3072
    ds_write_b128 v5, v[32:35] offset:4096
    ds_write_b128 v5, v[36:39] offset:5120
    ds_write_b128 v5, v[40:43] offset:6144
    ds_write_b128 v5, v[44:47] offset:7168
    ds_write_b128 v5, v[48:51] offset:8192
    ds_write_b128 v5, v[52:55] offset:9216
    ds_write_b128 v5, v[56:59] offset:10240
    ds_write_b128 v5, v[60:63] offset:11264
    ds_write_b128 v5, v[64:67] offset:12288
    ds_write_b128 v5, v[68:71] offset:13312
    ds_write_b128 v5, v[72:75] offset:14336
    ds_write_b128 v5, v[76:79] offset:15360
    s_waitcnt lgkmcnt(0)
    s_barrier
    s_lshl_b32 s40, s32, 12
    v_add_u32 v5, s40, v2
    ds_read_b128 v[80:83], v5 offset:0
    ds_read_b128 v[84:87], v5 offset:1024
    ds_read_b128 v[88:91], v5 offset:2048
    ds_read_b128 v[92:95], v5 offset:3072
    ds_read_b128 v[96:99], v5 offset:16384
    ds_read_b128 v[100:103], v5 offset:17408
    ds_read_b128 v[104:107], v5 offset:18432
    ds_read_b128 v[108:111], v5 offset:19456
    ds_read_b128 v[112:115], v5 offset:32768
    ds_read_b128 v[116:119], v5 offset:33792
    ds_read_b128 v[120:123], v5 offset:34816
    ds_read_b128 v[124:127], v5 offset:35840
    ds_read_b128 v[128:131], v5 offset:49152
    ds_read_b128 v[132:135], v5 offset:50176
    ds_read_b128 v[136:139], v5 offset:51200
    ds_read_b128 v[140:143], v5 offset:52224
    s_waitcnt lgkmcnt(11)
    v_add_f32 v80, v80, v96
    s_waitcnt lgkmcnt(3)
    v_add_f32 v112, v112, v128
    v_add_f32 v80, v80, v112
    v_add_f32 v81, v81, v97
    v_add_f32 v113, v113, v129
    v_add_f32 v81, v81, v113
    v_add_f32 v82, v82, v98
    v_add_f32 v114, v114, v130
    v_add_f32 v82, v82, v114
    v_add_f32 v83, v83, v99
    v_add_f32 v115, v115, v131
    v_add_f32 v83, v83, v115
    v_add_f32 v84, v84, v100
    s_waitcnt lgkmcnt(2)
    v_add_f32 v116, v116, v132
    v_add_f32 v84, v84, v116
    v_add_f32 v85, v85, v101
    v_add_f32 v117, v117, v133
    v_add_f32 v85, v85, v117
    v_add_f32 v86, v86, v102
    v_add_f32 v118, v118, v134
    v_add_f32 v86, v86, v118
    v_add_f32 v87, v87, v103
    v_add_f32 v119, v119, v135
    v_add_f32 v87, v87, v119
    v_add_f32 v88, v88, v104
    s_waitcnt lgkmcnt(1)
    v_add_f32 v120, v120, v136
    v_add_f32 v88, v88, v120
    v_add_f32 v89, v89, v105
    v_add_f32 v121, v121, v137
    v_add_f32 v89, v89, v121
    v_add_f32 v90, v90, v106
    v_add_f32 v122, v122, v138
    v_add_f32 v90, v90, v122
    v_add_f32 v91, v91, v107
    v_add_f32 v123, v123, v139
    v_add_f32 v91, v91, v123
    v_add_f32 v92, v92, v108
    s_waitcnt lgkmcnt(0)
    v_add_f32 v124, v124, v140
    v_add_f32 v92, v92, v124
    v_add_f32 v93, v93, v109
    v_add_f32 v125, v125, v141
    v_add_f32 v93, v93, v125
    v_add_f32 v94, v94, v110
    v_add_f32 v126, v126, v142
    v_add_f32 v94, v94, v126
    v_add_f32 v95, v95, v111
    v_add_f32 v127, v127, v143
    v_add_f32 v95, v95, v127
    v_mov_b32 v6, 0
    v_mov_b32 v7, 0
    v_mov_b32 v20, 0xffff0000
    v_lshlrev_b32 v16, 16, v8
    v_and_b32 v17, v20, v8
    v_add_f32 v80, v80, v16
    v_add_f32 v81, v81, v17
    v_cvt_pk_bf16_f32 v18, v80, v81
    v_lshlrev_b32 v16, 16, v18
    v_and_b32 v17, v20, v18
    v_add_f32 v6, v6, v16
    v_fma_f32 v7, v16, v16, v7
    v_add_f32 v6, v6, v17
    v_fma_f32 v7, v17, v17, v7
    v_lshlrev_b32 v16, 16, v9
    v_and_b32 v17, v20, v9
    v_add_f32 v82, v82, v16
    v_add_f32 v83, v83, v17
    v_cvt_pk_bf16_f32 v19, v82, v83
    v_lshlrev_b32 v16, 16, v19
    v_and_b32 v17, v20, v19
    v_add_f32 v6, v6, v16
    v_fma_f32 v7, v16, v16, v7
    v_add_f32 v6, v6, v17
    v_fma_f32 v7, v17, v17, v7
    buffer_store_dwordx2 v[18:19], v4, s[24:27], s38 offen offset:0
    v_lshlrev_b32 v16, 16, v10
    v_and_b32 v17, v20, v10
    v_add_f32 v84, v84, v16
    v_add_f32 v85, v85, v17
    v_cvt_pk_bf16_f32 v18, v84, v85
    v_lshlrev_b32 v16, 16, v18
    v_and_b32 v17, v20, v18
    v_add_f32 v6, v6, v16
    v_fma_f32 v7, v16, v16, v7
    v_add_f32 v6, v6, v17
    v_fma_f32 v7, v17, v17, v7
    v_lshlrev_b32 v16, 16, v11
    v_and_b32 v17, v20, v11
    v_add_f32 v86, v86, v16
    v_add_f32 v87, v87, v17
    v_cvt_pk_bf16_f32 v19, v86, v87
    v_lshlrev_b32 v16, 16, v19
    v_and_b32 v17, v20, v19
    v_add_f32 v6, v6, v16
    v_fma_f32 v7, v16, v16, v7
    v_add_f32 v6, v6, v17
    v_fma_f32 v7, v17, v17, v7
    buffer_store_dwordx2 v[18:19], v4, s[24:27], s38 offen offset:16
    v_lshlrev_b32 v16, 16, v12
    v_and_b32 v17, v20, v12
    v_add_f32 v88, v88, v16
    v_add_f32 v89, v89, v17
    v_cvt_pk_bf16_f32 v18, v88, v89
    v_lshlrev_b32 v16, 16, v18
    v_and_b32 v17, v20, v18
    v_add_f32 v6, v6, v16
    v_fma_f32 v7, v16, v16, v7
    v_add_f32 v6, v6, v17
    v_fma_f32 v7, v17, v17, v7
    v_lshlrev_b32 v16, 16, v13
    v_and_b32 v17, v20, v13
    v_add_f32 v90, v90, v16
    v_add_f32 v91, v91, v17
    v_cvt_pk_bf16_f32 v19, v90, v91
    v_lshlrev_b32 v16, 16, v19
    v_and_b32 v17, v20, v19
    v_add_f32 v6, v6, v16
    v_fma_f32 v7, v16, v16, v7
    v_add_f32 v6, v6, v17
    v_fma_f32 v7, v17, v17, v7
    buffer_store_dwordx2 v[18:19], v4, s[24:27], s38 offen offset:32
    v_lshlrev_b32 v16, 16, v14
    v_and_b32 v17, v20, v14
    v_add_f32 v92, v92, v16
    v_add_f32 v93, v93, v17
    v_cvt_pk_bf16_f32 v18, v92, v93
    v_lshlrev_b32 v16, 16, v18
    v_and_b32 v17, v20, v18
    v_add_f32 v6, v6, v16
    v_fma_f32 v7, v16, v16, v7
    v_add_f32 v6, v6, v17
    v_fma_f32 v7, v17, v17, v7
    v_lshlrev_b32 v16, 16, v15
    v_and_b32 v17, v20, v15
    v_add_f32 v94, v94, v16
    v_add_f32 v95, v95, v17
    v_cvt_pk_bf16_f32 v19, v94, v95
    v_lshlrev_b32 v16, 16, v19
    v_and_b32 v17, v20, v19
    v_add_f32 v6, v6, v16
    v_fma_f32 v7, v16, v16, v7
    v_add_f32 v6, v6, v17
    v_fma_f32 v7, v17, v17, v7
    buffer_store_dwordx2 v[18:19], v4, s[24:27], s38 offen offset:48
    v_mov_b32 v16, v6
    v_mov_b32 v17, v7
    s_nop 0
    v_permlane32_swap_b32 v6, v16
    v_permlane32_swap_b32 v7, v17
    v_add_f32 v6, v6, v16
    v_add_f32 v7, v7, v17
    v_mul_u32_u24 v5, 112, v3
    s_lshl_b32 s40, s34, 4
    s_lshl_b32 s41, s36, 3
    s_add_u32 s40, s40, s41
    v_cmp_gt_u32 vcc, 32, v1
    s_and_saveexec_b64 s[44:45], vcc
    buffer_store_dwordx2 v[6:7], v5, s[28:31], s40 offen
    s_endpgm
.section .rodata,"a"
.p2align 6
.amdhsa_kernel k3a_kernel
  .amdhsa_next_free_vgpr 208
  .amdhsa_next_free_sgpr 64
  .amdhsa_accum_offset 208
  .amdhsa_group_segment_fixed_size 0
  .amdhsa_kernarg_size 80
  .amdhsa_user_sgpr_count 2
  .amdhsa_user_sgpr_kernarg_segment_ptr 1
  .amdhsa_system_sgpr_workgroup_id_x 1
.end_amdhsa_kernel
.text
.globl k4a_kernel
.p2align 8
.type k4a_kernel,@function
k4a_kernel:
    s_cmp_ge_u32 s2, 224
    s_cbranch_scc0 k4a_kernel_go1
    s_endpgm
k4a_kernel_go1:
    s_load_dwordx2 s[4:5], s[0:1], 72
    s_waitcnt lgkmcnt(0)
    s_add_u32 s12, s4, 16777216
    s_addc_u32 s13, s5, 0
    s_mov_b32 s14, 1835008
    s_mov_b32 s15, 0x00020000
    s_add_u32 s16, s4, 2097152
    s_addc_u32 s17, s5, 0
    s_mov_b32 s18, 1605632
    s_mov_b32 s19, 0x00020000
    s_add_u32 s20, s4, 31719424
    s_addc_u32 s21, s5, 0
    s_mov_b32 s22, 229376
    s_mov_b32 s23, 0x00020000
    s_add_u32 s24, s4, 8134656
    s_addc_u32 s25, s5, 0
    s_mov_b32 s26, 7168
    s_mov_b32 s27, 0x00020000
    s_add_u32 s56, s4, 23068672
    s_addc_u32 s57, s5, 0
    s_mov_b32 s58, 7340032
    s_mov_b32 s59, 0x00020000
    s_add_u32 s48, s4, 4194304
    s_addc_u32 s49, s5, 0
    s_mov_b32 s50, 1605632
    s_mov_b32 s51, 0x00020000
    s_add_u32 s52, s4, 8142848
    s_addc_u32 s53, s5, 0
    s_mov_b32 s54, 7168
    s_mov_b32 s55, 0x00020000
    v_lshrrev_b32 v1, 6, v0
    s_nop 0
    v_readfirstlane_b32 s32, v1
    s_lshr_b32 s30, s2, 4
    s_and_b32 s31, s2, 15
    s_lshl_b32 s34, s31, 7
    s_lshl_b32 s33, s30, 2
    s_add_u32 s33, s33, s32
    s_mul_i32 s35, s33, 28672
    v_and_b32 v1, 63, v0
    v_lshlrev_b32 v2, 4, v1
    buffer_load_dwordx4 v[16:19], v2, s[16:19], s35 offen offset:0
    buffer_load_dwordx4 v[20:23], v2, s[48:51], s35 offen offset:0
    buffer_load_dwordx4 v[24:27], v2, s[16:19], s35 offen offset:1024
    buffer_load_dwordx4 v[28:31], v2, s[48:51], s35 offen offset:1024
    buffer_load_dwordx4 v[32:35], v2, s[16:19], s35 offen offset:2048
    buffer_load_dwordx4 v[36:39], v2, s[48:51], s35 offen offset:2048
    buffer_load_dwordx4 v[40:43], v2, s[16:19], s35 offen offset:3072
    buffer_load_dwordx4 v[44:47], v2, s[48:51], s35 offen offset:3072
    s_add_u32 s35, s35, 4096
    v_lshlrev_b32 v3, 4, v0
    s_mul_i32 s40, s34, 896
    s_add_u32 s41, s40, 0
    buffer_load_dwordx4 v[112:115], v3, s[12:15], s41 offen
    s_add_u32 s41, s40, 4096
    buffer_load_dwordx4 v[116:119], v3, s[12:15], s41 offen
    s_add_u32 s41, s40, 8192
    buffer_load_dwordx4 v[120:123], v3, s[12:15], s41 offen
    s_add_u32 s41, s40, 12288
    buffer_load_dwordx4 v[124:127], v3, s[12:15], s41 offen
    s_add_u32 s41, s40, 16384
    buffer_load_dwordx4 v[128:131], v3, s[12:15], s41 offen
    s_add_u32 s41, s40, 20480
    buffer_load_dwordx4 v[132:135], v3, s[12:15], s41 offen
    s_add_u32 s41, s40, 24576
    buffer_load_dwordx4 v[136:139], v3, s[12:15], s41 offen
    s_add_u32 s41, s40, 28672
    buffer_load_dwordx4 v[140:143], v3, s[12:15], s41 offen
    s_add_u32 s41, s40, 32768
    buffer_load_dwordx4 v[144:147], v3, s[12:15], s41 offen
    s_add_u32 s41, s40, 36864
    buffer_load_dwordx4 v[148:151], v3, s[12:15], s41 offen
    s_add_u32 s41, s40, 40960
    buffer_load_dwordx4 v[152:155], v3, s[12:15], s41 offen
    s_add_u32 s41, s40, 45056
    buffer_load_dwordx4 v[156:159], v3, s[12:15], s41 offen
    s_add_u32 s41, s40, 49152
    buffer_load_dwordx4 v[160:163], v3, s[12:15], s41 offen
    s_add_u32 s41, s40, 53248
    buffer_load_dwordx4 v[164:167], v3, s[12:15], s41 offen
    s_add_u32 s41, s40, 57344
    buffer_load_dwordx4 v[168:171], v3, s[12:15], s41 offen
    s_add_u32 s41, s40, 61440
    buffer_load_dwordx4 v[172:175], v3, s[12:15], s41 offen
    s_add_u32 s41, s40, 65536
    buffer_load_dwordx4 v[176:179], v3, s[12:15], s41 offen
    s_add_u32 s41, s40, 69632
    buffer_load_dwordx4 v[180:183], v3, s[12:15], s41 offen
    s_add_u32 s41, s40, 73728
    buffer_load_dwordx4 v[184:187], v3, s[12:15], s41 offen
    s_add_u32 s41, s40, 77824
    buffer_load_dwordx4 v[188:191], v3, s[12:15], s41 offen
    s_add_u32 s41, s40, 81920
    buffer_load_dwordx4 v[192:195], v3, s[12:15], s41 offen
    s_add_u32 s41, s40, 86016
    buffer_load_dwordx4 v[196:199], v3, s[12:15], s41 offen
    s_add_u32 s41, s40, 90112
    buffer_load_dwordx4 v[200:203], v3, s[12:15], s41 offen
    s_add_u32 s41, s40, 94208
    buffer_load_dwordx4 v[204:207], v3, s[12:15], s41 offen
    s_add_u32 s41, s40, 98304
    buffer_load_dwordx4 v[208:211], v3, s[12:15], s41 offen
    s_add_u32 s41, s40, 102400
    buffer_load_dwordx4 v[212:215], v3, s[12:15], s41 offen
    s_add_u32 s41, s40, 106496
    buffer_load_dwordx4 v[216:219], v3, s[12:15], s41 offen
    s_add_u32 s41, s40, 110592
    buffer_load_dwordx4 v[220:223], v3, s[12:15], s41 offen
    v_add_u32 v4, 0, v0
    v_mul_u32_u24 v5, 9363, v4
    v_lshrrev_b32 v5, 19, v5
    v_add_lshl_u32 v4, v4, v5, 4
    s_waitcnt vmcnt(27)
    ds_write_b128 v4, v[112:115] offset:1024
    v_add_u32 v4, 256, v0
    v_mul_u32_u24 v5, 9363, v4
    v_lshrrev_b32 v5, 19, v5
    v_add_lshl_u32 v4, v4, v5, 4
    s_waitcnt vmcnt(26)
    ds_write_b128 v4, v[116:119] offset:1024
    v_add_u32 v4, 512, v0
    v_mul_u32_u24 v5, 9363, v4
    v_lshrrev_b32 v5, 19, v5
    v_add_lshl_u32 v4, v4, v5, 4
    s_waitcnt vmcnt(25)
    ds_write_b128 v4, v[120:123] offset:1024
    v_add_u32 v4, 768, v0
    v_mul_u32_u24 v5, 9363, v4
    v_lshrrev_b32 v5, 19, v5
    v_add_lshl_u32 v4, v4, v5, 4
    s_waitcnt vmcnt(24)
    ds_write_b128 v4, v[124:127] offset:1024
    v_add_u32 v4, 1024, v0
    v_mul_u32_u24 v5, 9363, v4
    v_lshrrev_b32 v5, 19, v5
    v_add_lshl_u32 v4, v4, v5, 4
    s_waitcnt vmcnt(23)
    ds_write_b128 v4, v[128:131] offset:1024
    v_add_u32 v4, 1280, v0
    v_mul_u32_u24 v5, 9363, v4
    v_lshrrev_b32 v5, 19, v5
    v_add_lshl_u32 v4, v4, v5, 4
    s_waitcnt vmcnt(22)
    ds_write_b128 v4, v[132:135] offset:1024
    v_add_u32 v4, 1536, v0
    v_mul_u32_u24 v5, 9363, v4
    v_lshrrev_b32 v5, 19, v5
    v_add_lshl_u32 v4, v4, v5, 4
    s_waitcnt vmcnt(21)
    ds_write_b128 v4, v[136:139] offset:1024
    s_waitcnt lgkmcnt(0)
    v_add_u32 v7, s34, v0
    v_and_b32 v7, 2047, v7
    v_mul_u32_u24 v7, 112, v7
    buffer_load_dwordx4 v[112:115], v7, s[20:23], 0 offen offset:0
    buffer_load_dwordx4 v[116:119], v7, s[20:23], 0 offen offset:16
    buffer_load_dwordx4 v[120:123], v7, s[20:23], 0 offen offset:32
    buffer_load_dwordx4 v[124:127], v7, s[20:23], 0 offen offset:48
    buffer_load_dwordx4 v[128:131], v7, s[20:23], 0 offen offset:64
    buffer_load_dwordx4 v[132:135], v7, s[20:23], 0 offen offset:80
    buffer_load_dwordx4 v[136:139], v7, s[20:23], 0 offen offset:96
    v_add_u32 v4, 1792, v0
    v_mul_u32_u24 v5, 9363, v4
    v_lshrrev_b32 v5, 19, v5
    v_add_lshl_u32 v4, v4, v5, 4
    s_waitcnt vmcnt(27)
    ds_write_b128 v4, v[140:143] offset:1024
    v_add_u32 v4, 2048, v0
    v_mul_u32_u24 v5, 9363, v4
    v_lshrrev_b32 v5, 19, v5
    v_add_lshl_u32 v4, v4, v5, 4
    s_waitcnt vmcnt(26)
    ds_write_b128 v4, v[144:147] offset:1024
    v_add_u32 v4, 2304, v0
    v_mul_u32_u24 v5, 9363, v4
    v_lshrrev_b32 v5, 19, v5
    v_add_lshl_u32 v4, v4, v5, 4
    s_waitcnt vmcnt(25)
    ds_write_b128 v4, v[148:151] offset:1024
    v_add_u32 v4, 2560, v0
    v_mul_u32_u24 v5, 9363, v4
    v_lshrrev_b32 v5, 19, v5
    v_add_lshl_u32 v4, v4, v5, 4
    s_waitcnt vmcnt(24)
    ds_write_b128 v4, v[152:155] offset:1024
    v_add_u32 v4, 2816, v0
    v_mul_u32_u24 v5, 9363, v4
    v_lshrrev_b32 v5, 19, v5
    v_add_lshl_u32 v4, v4, v5, 4
    s_waitcnt vmcnt(23)
    ds_write_b128 v4, v[156:159] offset:1024
    v_add_u32 v4, 3072, v0
    v_mul_u32_u24 v5, 9363, v4
    v_lshrrev_b32 v5, 19, v5
    v_add_lshl_u32 v4, v4, v5, 4
    s_waitcnt vmcnt(22)
    ds_write_b128 v4, v[160:163] offset:1024
    v_add_u32 v4, 3328, v0
    v_mul_u32_u24 v5, 9363, v4
    v_lshrrev_b32 v5, 19, v5
    v_add_lshl_u32 v4, v4, v5, 4
    s_waitcnt vmcnt(21)
    ds_write_b128 v4, v[164:167] offset:1024
    v_add_u32 v4, 3584, v0
    v_mul_u32_u24 v5, 9363, v4
    v_lshrrev_b32 v5, 19, v5
    v_add_lshl_u32 v4, v4, v5, 4
    s_waitcnt vmcnt(20)
    ds_write_b128 v4, v[168:171] offset:1024
    v_add_u32 v4, 3840, v0
    v_mul_u32_u24 v5, 9363, v4
    v_lshrrev_b32 v5, 19, v5
    v_add_lshl_u32 v4, v4, v5, 4
    s_waitcnt vmcnt(19)
    ds_write_b128 v4, v[172:175] offset:1024
    v_add_u32 v4, 4096, v0
    v_mul_u32_u24 v5, 9363, v4
    v_lshrrev_b32 v5, 19, v5
    v_add_lshl_u32 v4, v4, v5, 4
    s_waitcnt vmcnt(18)
    ds_write_b128 v4, v[176:179] offset:1024
    v_add_u32 v4, 4352, v0
    v_mul_u32_u24 v5, 9363, v4
    v_lshrrev_b32 v5, 19, v5
    v_add_lshl_u32 v4, v4, v5, 4
    s_waitcnt vmcnt(17)
    ds_write_b128 v4, v[180:183] offset:1024
    v_add_u32 v4, 4608, v0
    v_mul_u32_u24 v5, 9363, v4
    v_lshrrev_b32 v5, 19, v5
    v_add_lshl_u32 v4, v4, v5, 4
    s_waitcnt vmcnt(16)
    ds_write_b128 v4, v[184:187] offset:1024
    v_add_u32 v4, 4864, v0
    v_mul_u32_u24 v5, 9363, v4
    v_lshrrev_b32 v5, 19, v5
    v_add_lshl_u32 v4, v4, v5, 4
    s_waitcnt vmcnt(15)
    ds_write_b128 v4, v[188:191] offset:1024
    v_add_u32 v4, 5120, v0
    v_mul_u32_u24 v5, 9363, v4
    v_lshrrev_b32 v5, 19, v5
    v_add_lshl_u32 v4, v4, v5, 4
    s_waitcnt vmcnt(14)
    ds_write_b128 v4, v[192:195] offset:1024
    v_add_u32 v4, 5376, v0
    v_mul_u32_u24 v5, 9363, v4
    v_lshrrev_b32 v5, 19, v5
    v_add_lshl_u32 v4, v4, v5, 4
    s_waitcnt vmcnt(13)
    ds_write_b128 v4, v[196:199] offset:1024
    v_add_u32 v4, 5632, v0
    v_mul_u32_u24 v5, 9363, v4
    v_lshrrev_b32 v5, 19, v5
    v_add_lshl_u32 v4, v4, v5, 4
    s_waitcnt vmcnt(12)
    ds_write_b128 v4, v[200:203] offset:1024
    v_add_u32 v4, 5888, v0
    v_mul_u32_u24 v5, 9363, v4
    v_lshrrev_b32 v5, 19, v5
    v_add_lshl_u32 v4, v4, v5, 4
    s_waitcnt vmcnt(11)
    ds_write_b128 v4, v[204:207] offset:1024
    v_add_u32 v4, 6144, v0
    v_mul_u32_u24 v5, 9363, v4
    v_lshrrev_b32 v5, 19, v5
    v_add_lshl_u32 v4, v4, v5, 4
    s_waitcnt vmcnt(10)
    ds_write_b128 v4, v[208:211] offset:1024
    v_add_u32 v4, 6400, v0
    v_mul_u32_u24 v5, 9363, v4
    v_lshrrev_b32 v5, 19, v5
    v_add_lshl_u32 v4, v4, v5, 4
    s_waitcnt vmcnt(9)
    ds_write_b128 v4, v[212:215] offset:1024
    v_add_u32 v4, 6656, v0
    v_mul_u32_u24 v5, 9363, v4
    v_lshrrev_b32 v5, 19, v5
    v_add_lshl_u32 v4, v4, v5, 4
    s_waitcnt vmcnt(8)
    ds_write_b128 v4, v[216:219] offset:1024
    v_add_u32 v4, 6912, v0
    v_mul_u32_u24 v5, 9363, v4
    v_lshrrev_b32 v5, 19, v5
    v_add_lshl_u32 v4, v4, v5, 4
    s_waitcnt vmcnt(7)
    ds_write_b128 v4, v[220:223] offset:1024
    v_cmp_gt_u32 vcc, 128, v0
    s_and_saveexec_b64 s[42:43], vcc
    s_cbranch_execz k4a_kernel_st2
    v_mov_b32 v5, 0
    v_mov_b32 v6, 0
    s_waitcnt vmcnt(6)
    v_add_f32 v5, v5, v112
    v_add_f32 v6, v6, v113
    v_add_f32 v5, v5, v114
    v_add_f32 v6, v6, v115
    s_waitcnt vmcnt(5)
    v_add_f32 v5, v5, v116
    v_add_f32 v6, v6, v117
    v_add_f32 v5, v5, v118
    v_add_f32 v6, v6, v119
    s_waitcnt vmcnt(4)
    v_add_f32 v5, v5, v120
    v_add_f32 v6, v6, v121
    v_add_f32 v5, v5, v122
    v_add_f32 v6, v6, v123
    s_waitcnt vmcnt(3)
    v_add_f32 v5, v5, v124
    v_add_f32 v6, v6, v125
    v_add_f32 v5, v5, v126
    v_add_f32 v6, v6, v127
    s_waitcnt vmcnt(2)
    v_add_f32 v5, v5, v128
    v_add_f32 v6, v6, v129
    v_add_f32 v5, v5, v130
    v_add_f32 v6, v6, v131
    s_waitcnt vmcnt(1)
    v_add_f32 v5, v5, v132
    v_add_f32 v6, v6, v133
    v_add_f32 v5, v5, v134
    v_add_f32 v6, v6, v135
    s_waitcnt vmcnt(0)
    v_add_f32 v5, v5, v136
    v_add_f32 v6, v6, v137
    v_add_f32 v5, v5, v138
    v_add_f32 v6, v6, v139
    v_mul_f32 v5, 0.002232142857142857, v5
    v_mul_f32 v6, 0.002232142857142857, v6
    v_fma_f32 v6, -v5, v5, v6
    v_max_f32 v6, 0, v6
    v_add_f32 v6, 1e-05, v6
    v_rsq_f32 v6, v6
    s_nop 0
    v_mul_f32 v5, v5, v6
    v_lshlrev_b32 v4, 2, v0
    ds_write_b32 v4, v6 offset:0
    ds_write_b32 v4, v5 offset:512
k4a_kernel_st2:
    s_waitcnt vmcnt(0)
    s_mov_b64 exec, s[42:43]
    s_waitcnt lgkmcnt(0)
    s_barrier
    v_and_b32 v3, 31, v1
    v_mul_u32_u24 v3, 912, v3
    v_lshrrev_b32 v4, 5, v1
    v_lshl_add_u32 v8, v4, 4, v3
    v_add_u32 v9, 58368, v8
    ds_read_b128 v[80:83], v8 offset:1024
    ds_read_b128 v[84:87], v8 offset:30208
    ds_read_b128 v[88:91], v9 offset:1024
    ds_read_b128 v[92:95], v9 offset:30208
    buffer_load_dwordx4 v[48:51], v2, s[16:19], s35 offen offset:0
    buffer_load_dwordx4 v[52:55], v2, s[48:51], s35 offen offset:0
    buffer_load_dwordx4 v[56:59], v2, s[16:19], s35 offen offset:1024
    buffer_load_dwordx4 v[60:63], v2, s[48:51], s35 offen offset:1024
    buffer_load_dwordx4 v[64:67], v2, s[16:19], s35 offen offset:2048
    buffer_load_dwordx4 v[68:71], v2, s[48:51], s35 offen offset:2048
    buffer_load_dwordx4 v[72:75], v2, s[16:19], s35 offen offset:3072
    buffer_load_dwordx4 v[76:79], v2, s[48:51], s35 offen offset:3072
    s_add_u32 s35, s35, 4096
    ds_read_b128 v[96:99], v8 offset:1056
    ds_read_b128 v[100:103], v8 offset:30240
    ds_read_b128 v[104:107], v9 offset:1056
    ds_read_b128 v[108:111], v9 offset:30240
    s_waitcnt lgkmcnt(7)
    v_mfma_f32_32x32x16_bf16 v[112:127], v[16:19], v[80:83], 0
    v_mfma_f32_32x32x16_bf16 v[176:191], v[20:23], v[80:83], 0
    s_waitcnt lgkmcnt(6)
    v_mfma_f32_32x32x16_bf16 v[128:143], v[16:19], v[84:87], 0
    v_mfma_f32_32x32x16_bf16 v[192:207], v[20:23], v[84:87], 0
    s_waitcnt lgkmcnt(5)
    v_mfma_f32_32x32x16_bf16 v[144:159], v[16:19], v[88:91], 0
    v_mfma_f32_32x32x16_bf16 v[208:223], v[20:23], v[88:91], 0
    s_waitcnt lgkmcnt(4)
    v_mfma_f32_32x32x16_bf16 v[160:175], v[16:19], v[92:95], 0
    v_mfma_f32_32x32x16_bf16 v[224:239], v[20:23], v[92:95], 0
    ds_read_b128 v[80:83], v8 offset:1088
    ds_read_b128 v[84:87], v8 offset:30272
    ds_read_b128 v[88:91], v9 offset:1088
    ds_read_b128 v[92:95], v9 offset:30272
    s_waitcnt lgkmcnt(7)
    v_mfma_f32_32x32x16_bf16 v[112:127], v[24:27], v[96:99], v[112:127]
    v_mfma_f32_32x32x16_bf16 v[176:191], v[28:31], v[96:99], v[176:191]
    s_waitcnt lgkmcnt(6)
    v_mfma_f32_32x32x16_bf16 v[128:143], v[24:27], v[100:103], v[128:143]
    v_mfma_f32_32x32x16_bf16 v[192:207], v[28:31], v[100:103], v[192:207]
    s_waitcnt lgkmcnt(5)
    v_mfma_f32_32x32x16_bf16 v[144:159], v[24:27], v[104:107], v[144:159]
    v_mfma_f32_32x32x16_bf16 v[208:223], v[28:31], v[104:107], v[208:223]
    s_waitcnt lgkmcnt(4)
    v_mfma_f32_32x32x16_bf16 v[160:175], v[24:27], v[108:111], v[160:175]
    v_mfma_f32_32x32x16_bf16 v[224:239], v[28:31], v[108:111], v[224:239]
    ds_read_b128 v[96:99], v8 offset:1120
    ds_read_b128 v[100:103], v8 offset:30304
    ds_read_b128 v[104:107], v9 offset:1120
    ds_read_b128 v[108:111], v9 offset:30304
    s_waitcnt lgkmcnt(7)
    v_mfma_f32_32x32x16_bf16 v[112:127], v[32:35], v[80:83], v[112:127]
    v_mfma_f32_32x32x16_bf16 v[176:191], v[36:39], v[80:83], v[176:191]
    s_waitcnt lgkmcnt(6)
    v_mfma_f32_32x32x16_bf16 v[128:143], v[32:35], v[84:87], v[128:143]
    v_mfma_f32_32x32x16_bf16 v[192:207], v[36:39], v[84:87], v[192:207]
    s_waitcnt lgkmcnt(5)
    v_mfma_f32_32x32x16_bf16 v[144:159], v[32:35], v[88:91], v[144:159]
    v_mfma_f32_32x32x16_bf16 v[208:223], v[36:39], v[88:91], v[208:223]
    s_waitcnt lgkmcnt(4)
    v_mfma_f32_32x32x16_bf16 v[160:175], v[32:35], v[92:95], v[160:175]
    v_mfma_f32_32x32x16_bf16 v[224:239], v[36:39], v[92:95], v[224:239]
    ds_read_b128 v[80:83], v8 offset:1152
    ds_read_b128 v[84:87], v8 offset:30336
    ds_read_b128 v[88:91], v9 offset:1152
    ds_read_b128 v[92:95], v9 offset:30336
    s_waitcnt lgkmcnt(7)
    v_mfma_f32_32x32x16_bf16 v[112:127], v[40:43], v[96:99], v[112:127]
    v_mfma_f32_32x32x16_bf16 v[176:191], v[44:47], v[96:99], v[176:191]
    s_waitcnt lgkmcnt(6)
    v_mfma_f32_32x32x16_bf16 v[128:143], v[40:43], v[100:103], v[128:143]
    v_mfma_f32_32x32x16_bf16 v[192:207], v[44:47], v[100:103], v[192:207]
    s_waitcnt lgkmcnt(5)
    v_mfma_f32_32x32x16_bf16 v[144:159], v[40:43], v[104:107], v[144:159]
    v_mfma_f32_32x32x16_bf16 v[208:223], v[44:47], v[104:107], v[208:223]
    s_waitcnt lgkmcnt(4)
    v_mfma_f32_32x32x16_bf16 v[160:175], v[40:43], v[108:111], v[160:175]
    v_mfma_f32_32x32x16_bf16 v[224:239], v[44:47], v[108:111], v[224:239]
    buffer_load_dwordx4 v[16:19], v2, s[16:19], s35 offen offset:0
    buffer_load_dwordx4 v[20:23], v2, s[48:51], s35 offen offset:0
    buffer_load_dwordx4 v[24:27], v2, s[16:19], s35 offen offset:1024
    buffer_load_dwordx4 v[28:31], v2, s[48:51], s35 offen offset:1024
    buffer_load_dwordx4 v[32:35], v2, s[16:19], s35 offen offset:2048
    buffer_load_dwordx4 v[36:39], v2, s[48:51], s35 offen offset:2048
    buffer_load_dwordx4 v[40:43], v2, s[16:19], s35 offen offset:3072
    buffer_load_dwordx4 v[44:47], v2, s[48:51], s35 offen offset:3072
    s_add_u32 s35, s35, 4096
    ds_read_b128 v[96:99], v8 offset:1184
    ds_read_b128 v[100:103], v8 offset:30368
    ds_read_b128 v[104:107], v9 offset:1184
    ds_read_b128 v[108:111], v9 offset:30368
    s_waitcnt vmcnt(15) lgkmcnt(7)
    v_mfma_f32_32x32x16_bf16 v[112:127], v[48:51], v[80:83], v[112:127]
    s_waitcnt vmcnt(14)
    v_mfma_f32_32x32x16_bf16 v[176:191], v[52:55], v[80:83], v[176:191]
    s_waitcnt lgkmcnt(6)
    v_mfma_f32_32x32x16_bf16 v[128:143], v[48:51], v[84:87], v[128:143]
    v_mfma_f32_32x32x16_bf16 v[192:207], v[52:55], v[84:87], v[192:207]
    s_waitcnt lgkmcnt(5)
    v_mfma_f32_32x32x16_bf16 v[144:159], v[48:51], v[88:91], v[144:159]
    v_mfma_f32_32x32x16_bf16 v[208:223], v[52:55], v[88:91], v[208:223]
    s_waitcnt lgkmcnt(4)
    v_mfma_f32_32x32x16_bf16 v[160:175], v[48:51], v[92:95], v[160:175]
    v_mfma_f32_32x32x16_bf16 v[224:239], v[52:55], v[92:95], v[224:239]
    ds_read_b128 v[80:83], v8 offset:1216
    ds_read_b128 v[84:87], v8 offset:30400
    ds_read_b128 v[88:91], v9 offset:1216
    ds_read_b128 v[92:95], v9 offset:30400
    s_waitcnt vmcnt(13) lgkmcnt(7)
    v_mfma_f32_32x32x16_bf16 v[112:127], v[56:59], v[96:99], v[112:127]
    s_waitcnt vmcnt(12)
    v_mfma_f32_32x32x16_bf16 v[176:191], v[60:63], v[96:99], v[176:191]
    s_waitcnt lgkmcnt(6)
    v_mfma_f32_32x32x16_bf16 v[128:143], v[56:59], v[100:103], v[128:143]
    v_mfma_f32_32x32x16_bf16 v[192:207], v[60:63], v[100:103], v[192:207]
    s_waitcnt lgkmcnt(5)
    v_mfma_f32_32x32x16_bf16 v[144:159], v[56:59], v[104:107], v[144:159]
    v_mfma_f32_32x32x16_bf16 v[208:223], v[60:63], v[104:107], v[208:223]
    s_waitcnt lgkmcnt(4)
    v_mfma_f32_32x32x16_bf16 v[160:175], v[56:59], v[108:111], v[160:175]
    v_mfma_f32_32x32x16_bf16 v[224:239], v[60:63], v[108:111], v[224:239]
    ds_read_b128 v[96:99], v8 offset:1248
    ds_read_b128 v[100:103], v8 offset:30432
    ds_read_b128 v[104:107], v9 offset:1248
    ds_read_b128 v[108:111], v9 offset:30432
    s_waitcnt vmcnt(11) lgkmcnt(7)
    v_mfma_f32_32x32x16_bf16 v[112:127], v[64:67], v[80:83], v[112:127]
    s_waitcnt vmcnt(10)
    v_mfma_f32_32x32x16_bf16 v[176:191], v[68:71], v[80:83], v[176:191]
    s_waitcnt lgkmcnt(6)
    v_mfma_f32_32x32x16_bf16 v[128:143], v[64:67], v[84:87], v[128:143]
    v_mfma_f32_32x32x16_bf16 v[192:207], v[68:71], v[84:87], v[192:207]
    s_waitcnt lgkmcnt(5)
    v_mfma_f32_32x32x16_bf16 v[144:159], v[64:67], v[88:91], v[144:159]
    v_mfma_f32_32x32x16_bf16 v[208:223], v[68:71], v[88:91], v[208:223]
    s_waitcnt lgkmcnt(4)
    v_mfma_f32_32x32x16_bf16 v[160:175], v[64:67], v[92:95], v[160:175]
    v_mfma_f32_32x32x16_bf16 v[224:239], v[68:71], v[92:95], v[224:239]
    ds_read_b128 v[80:83], v8 offset:1280
    ds_read_b128 v[84:87], v8 offset:30464
    ds_read_b128 v[88:91], v9 offset:1280
    ds_read_b128 v[92:95], v9 offset:30464
    s_waitcnt vmcnt(9) lgkmcnt(7)
    v_mfma_f32_32x32x16_bf16 v[112:127], v[72:75], v[96:99], v[112:127]
    s_waitcnt vmcnt(8)
    v_mfma_f32_32x32x16_bf16 v[176:191], v[76:79], v[96:99], v[176:191]
    s_waitcnt lgkmcnt(6)
    v_mfma_f32_32x32x16_bf16 v[128:143], v[72:75], v[100:103], v[128:143]
    v_mfma_f32_32x32x16_bf16 v[192:207], v[76:79], v[100:103], v[192:207]
    s_waitcnt lgkmcnt(5)
    v_mfma_f32_32x32x16_bf16 v[144:159], v[72:75], v[104:107], v[144:159]
    v_mfma_f32_32x32x16_bf16 v[208:223], v[76:79], v[104:107], v[208:223]
    s_waitcnt lgkmcnt(4)
    v_mfma_f32_32x32x16_bf16 v[160:175], v[72:75], v[108:111], v[160:175]
    v_mfma_f32_32x32x16_bf16 v[224:239], v[76:79], v[108:111], v[224:239]
    buffer_load_dwordx4 v[48:51], v2, s[16:19], s35 offen offset:0
    buffer_load_dwordx4 v[52:55], v2, s[48:51], s35 offen offset:0
    buffer_load_dwordx4 v[56:59], v2, s[16:19], s35 offen offset:1024
    buffer_load_dwordx4 v[60:63], v2, s[48:51], s35 offen offset:1024
    buffer_load_dwordx4 v[64:67], v2, s[16:19], s35 offen offset:2048
    buffer_load_dwordx4 v[68:71], v2, s[48:51], s35 offen offset:2048
    buffer_load_dwordx4 v[72:75], v2, s[16:19], s35 offen offset:3072
    buffer_load_dwordx4 v[76:79], v2, s[48:51], s35 offen offset:3072
    s_add_u32 s35, s35, 4096
    ds_read_b128 v[96:99], v8 offset:1312
    ds_read_b128 v[100:103], v8 offset:30496
    ds_read_b128 v[104:107], v9 offset:1312
    ds_read_b128 v[108:111], v9 offset:30496
    s_waitcnt vmcnt(15) lgkmcnt(7)
    v_mfma_f32_32x32x16_bf16 v[112:127], v[16:19], v[80:83], v[112:127]
    s_waitcnt vmcnt(14)
    v_mfma_f32_32x32x16_bf16 v[176:191], v[20:23], v[80:83], v[176:191]
    s_waitcnt lgkmcnt(6)
    v_mfma_f32_32x32x16_bf16 v[128:143], v[16:19], v[84:87], v[128:143]
    v_mfma_f32_32x32x16_bf16 v[192:207], v[20:23], v[84:87], v[192:207]
    s_waitcnt lgkmcnt(5)
    v_mfma_f32_32x32x16_bf16 v[144:159], v[16:19], v[88:91], v[144:159]
    v_mfma_f32_32x32x16_bf16 v[208:223], v[20:23], v[88:91], v[208:223]
    s_waitcnt lgkmcnt(4)
    v_mfma_f32_32x32x16_bf16 v[160:175], v[16:19], v[92:95], v[160:175]
    v_mfma_f32_32x32x16_bf16 v[224:239], v[20:23], v[92:95], v[224:239]
    ds_read_b128 v[80:83], v8 offset:1344
    ds_read_b128 v[84:87], v8 offset:30528
    ds_read_b128 v[88:91], v9 offset:1344
    ds_read_b128 v[92:95], v9 offset:30528
    s_waitcnt vmcnt(13) lgkmcnt(7)
    v_mfma_f32_32x32x16_bf16 v[112:127], v[24:27], v[96:99], v[112:127]
    s_waitcnt vmcnt(12)
    v_mfma_f32_32x32x16_bf16 v[176:191], v[28:31], v[96:99], v[176:191]
    s_waitcnt lgkmcnt(6)
    v_mfma_f32_32x32x16_bf16 v[128:143], v[24:27], v[100:103], v[128:143]
    v_mfma_f32_32x32x16_bf16 v[192:207], v[28:31], v[100:103], v[192:207]
    s_waitcnt lgkmcnt(5)
    v_mfma_f32_32x32x16_bf16 v[144:159], v[24:27], v[104:107], v[144:159]
    v_mfma_f32_32x32x16_bf16 v[208:223], v[28:31], v[104:107], v[208:223]
    s_waitcnt lgkmcnt(4)
    v_mfma_f32_32x32x16_bf16 v[160:175], v[24:27], v[108:111], v[160:175]
    v_mfma_f32_32x32x16_bf16 v[224:239], v[28:31], v[108:111], v[224:239]
    ds_read_b128 v[96:99], v8 offset:1376
    ds_read_b128 v[100:103], v8 offset:30560
    ds_read_b128 v[104:107], v9 offset:1376
    ds_read_b128 v[108:111], v9 offset:30560
    s_waitcnt vmcnt(11) lgkmcnt(7)
    v_mfma_f32_32x32x16_bf16 v[112:127], v[32:35], v[80:83], v[112:127]
    s_waitcnt vmcnt(10)
    v_mfma_f32_32x32x16_bf16 v[176:191], v[36:39], v[80:83], v[176:191]
    s_waitcnt lgkmcnt(6)
    v_mfma_f32_32x32x16_bf16 v[128:143], v[32:35], v[84:87], v[128:143]
    v_mfma_f32_32x32x16_bf16 v[192:207], v[36:39], v[84:87], v[192:207]
    s_waitcnt lgkmcnt(5)
    v_mfma_f32_32x32x16_bf16 v[144:159], v[32:35], v[88:91], v[144:159]
    v_mfma_f32_32x32x16_bf16 v[208:223], v[36:39], v[88:91], v[208:223]
    s_waitcnt lgkmcnt(4)
    v_mfma_f32_32x32x16_bf16 v[160:175], v[32:35], v[92:95], v[160:175]
    v_mfma_f32_32x32x16_bf16 v[224:239], v[36:39], v[92:95], v[224:239]
    ds_read_b128 v[80:83], v8 offset:1408
    ds_read_b128 v[84:87], v8 offset:30592
    ds_read_b128 v[88:91], v9 offset:1408
    ds_read_b128 v[92:95], v9 offset:30592
    s_waitcnt vmcnt(9) lgkmcnt(7)
    v_mfma_f32_32x32x16_bf16 v[112:127], v[40:43], v[96:99], v[112:127]
    s_waitcnt vmcnt(8)
    v_mfma_f32_32x32x16_bf16 v[176:191], v[44:47], v[96:99], v[176:191]
    s_waitcnt lgkmcnt(6)
    v_mfma_f32_32x32x16_bf16 v[128:143], v[40:43], v[100:103], v[128:143]
    v_mfma_f32_32x32x16_bf16 v[192:207], v[44:47], v[100:103], v[192:207]
    s_waitcnt lgkmcnt(5)
    v_mfma_f32_32x32x16_bf16 v[144:159], v[40:43], v[104:107], v[144:159]
    v_mfma_f32_32x32x16_bf16 v[208:223], v[44:47], v[104:107], v[208:223]
    s_waitcnt lgkmcnt(4)
    v_mfma_f32_32x32x16_bf16 v[160:175], v[40:43], v[108:111], v[160:175]
    v_mfma_f32_32x32x16_bf16 v[224:239], v[44:47], v[108:111], v[224:239]
    buffer_load_dwordx4 v[16:19], v2, s[16:19], s35 offen offset:0
    buffer_load_dwordx4 v[20:23], v2, s[48:51], s35 offen offset:0
    buffer_load_dwordx4 v[24:27], v2, s[16:19], s35 offen offset:1024
    buffer_load_dwordx4 v[28:31], v2, s[48:51], s35 offen offset:1024
    buffer_load_dwordx4 v[32:35], v2, s[16:19], s35 offen offset:2048
    buffer_load_dwordx4 v[36:39], v2, s[48:51], s35 offen offset:2048
    buffer_load_dwordx4 v[40:43], v2, s[16:19], s35 offen offset:3072
    buffer_load_dwordx4 v[44:47], v2, s[48:51], s35 offen offset:3072
    s_add_u32 s35, s35, 4096
    ds_read_b128 v[96:99], v8 offset:1440
    ds_read_b128 v[100:103], v8 offset:30624
    ds_read_b128 v[104:107], v9 offset:1440
    ds_read_b128 v[108:111], v9 offset:30624
    s_waitcnt vmcnt(15) lgkmcnt(7)
    v_mfma_f32_32x32x16_bf16 v[112:127], v[48:51], v[80:83], v[112:127]
    s_waitcnt vmcnt(14)
    v_mfma_f32_32x32x16_bf16 v[176:191], v[52:55], v[80:83], v[176:191]
    s_waitcnt lgkmcnt(6)
    v_mfma_f32_32x32x16_bf16 v[128:143], v[48:51], v[84:87], v[128:143]
    v_mfma_f32_32x32x16_bf16 v[192:207], v[52:55], v[84:87], v[192:207]
    s_waitcnt lgkmcnt(5)
    v_mfma_f32_32x32x16_bf16 v[144:159], v[48:51], v[88:91], v[144:159]
    v_mfma_f32_32x32x16_bf16 v[208:223], v[52:55], v[88:91], v[208:223]
    s_waitcnt lgkmcnt(4)
    v_mfma_f32_32x32x16_bf16 v[160:175], v[48:51], v[92:95], v[160:175]
    v_mfma_f32_32x32x16_bf16 v[224:239], v[52:55], v[92:95], v[224:239]
    ds_read_b128 v[80:83], v8 offset:1472
    ds_read_b128 v[84:87], v8 offset:30656
    ds_read_b128 v[88:91], v9 offset:1472
    ds_read_b128 v[92:95], v9 offset:30656
    s_waitcnt vmcnt(13) lgkmcnt(7)
    v_mfma_f32_32x32x16_bf16 v[112:127], v[56:59], v[96:99], v[112:127]
    s_waitcnt vmcnt(12)
    v_mfma_f32_32x32x16_bf16 v[176:191], v[60:63], v[96:99], v[176:191]
    s_waitcnt lgkmcnt(6)
    v_mfma_f32_32x32x16_bf16 v[128:143], v[56:59], v[100:103], v[128:143]
    v_mfma_f32_32x32x16_bf16 v[192:207], v[60:63], v[100:103], v[192:207]
    s_waitcnt lgkmcnt(5)
    v_mfma_f32_32x32x16_bf16 v[144:159], v[56:59], v[104:107], v[144:159]
    v_mfma_f32_32x32x16_bf16 v[208:223], v[60:63], v[104:107], v[208:223]
    s_waitcnt lgkmcnt(4)
    v_mfma_f32_32x32x16_bf16 v[160:175], v[56:59], v[108:111], v[160:175]
    v_mfma_f32_32x32x16_bf16 v[224:239], v[60:63], v[108:111], v[224:239]
    ds_read_b128 v[96:99], v8 offset:1504
    ds_read_b128 v[100:103], v8 offset:30688
    ds_read_b128 v[104:107], v9 offset:1504
    ds_read_b128 v[108:111], v9 offset:30688
    s_waitcnt vmcnt(11) lgkmcnt(7)
    v_mfma_f32_32x32x16_bf16 v[112:127], v[64:67], v[80:83], v[112:127]
    s_waitcnt vmcnt(10)
    v_mfma_f32_32x32x16_bf16 v[176:191], v[68:71], v[80:83], v[176:191]
    s_waitcnt lgkmcnt(6)
    v_mfma_f32_32x32x16_bf16 v[128:143], v[64:67], v[84:87], v[128:143]
    v_mfma_f32_32x32x16_bf16 v[192:207], v[68:71], v[84:87], v[192:207]
    s_waitcnt lgkmcnt(5)
    v_mfma_f32_32x32x16_bf16 v[144:159], v[64:67], v[88:91], v[144:159]
    v_mfma_f32_32x32x16_bf16 v[208:223], v[68:71], v[88:91], v[208:223]
    s_waitcnt lgkmcnt(4)
    v_mfma_f32_32x32x16_bf16 v[160:175], v[64:67], v[92:95], v[160:175]
    v_mfma_f32_32x32x16_bf16 v[224:239], v[68:71], v[92:95], v[224:239]
    ds_read_b128 v[80:83], v8 offset:1536
    ds_read_b128 v[84:87], v8 offset:30720
    ds_read_b128 v[88:91], v9 offset:1536
    ds_read_b128 v[92:95], v9 offset:30720
    s_waitcnt vmcnt(9) lgkmcnt(7)
    v_mfma_f32_32x32x16_bf16 v[112:127], v[72:75], v[96:99], v[112:127]
    s_waitcnt vmcnt(8)
    v_mfma_f32_32x32x16_bf16 v[176:191], v[76:79], v[96:99], v[176:191]
    s_waitcnt lgkmcnt(6)
    v_mfma_f32_32x32x16_bf16 v[128:143], v[72:75], v[100:103], v[128:143]
    v_mfma_f32_32x32x16_bf16 v[192:207], v[76:79], v[100:103], v[192:207]
    s_waitcnt lgkmcnt(5)
    v_mfma_f32_32x32x16_bf16 v[144:159], v[72:75], v[104:107], v[144:159]
    v_mfma_f32_32x32x16_bf16 v[208:223], v[76:79], v[104:107], v[208:223]
    s_waitcnt lgkmcnt(4)
    v_mfma_f32_32x32x16_bf16 v[160:175], v[72:75], v[108:111], v[160:175]
    v_mfma_f32_32x32x16_bf16 v[224:239], v[76:79], v[108:111], v[224:239]
    buffer_load_dwordx4 v[48:51], v2, s[16:19], s35 offen offset:0
    buffer_load_dwordx4 v[52:55], v2, s[48:51], s35 offen offset:0
    buffer_load_dwordx4 v[56:59], v2, s[16:19], s35 offen offset:1024
    buffer_load_dwordx4 v[60:63], v2, s[48:51], s35 offen offset:1024
    buffer_load_dwordx4 v[64:67], v2, s[16:19], s35 offen offset:2048
    buffer_load_dwordx4 v[68:71], v2, s[48:51], s35 offen offset:2048
    buffer_load_dwordx4 v[72:75], v2, s[16:19], s35 offen offset:3072
    buffer_load_dwordx4 v[76:79], v2, s[48:51], s35 offen offset:3072
    s_add_u32 s35, s35, 4096
    ds_read_b128 v[96:99], v8 offset:1568
    ds_read_b128 v[100:103], v8 offset:30752
    ds_read_b128 v[104:107], v9 offset:1568
    ds_read_b128 v[108:111], v9 offset:30752
    s_waitcnt vmcnt(15) lgkmcnt(7)
    v_mfma_f32_32x32x16_bf16 v[112:127], v[16:19], v[80:83], v[112:127]
    s_waitcnt vmcnt(14)
    v_mfma_f32_32x32x16_bf16 v[176:191], v[20:23], v[80:83], v[176:191]
    s_waitcnt lgkmcnt(6)
    v_mfma_f32_32x32x16_bf16 v[128:143], v[16:19], v[84:87], v[128:143]
    v_mfma_f32_32x32x16_bf16 v[192:207], v[20:23], v[84:87], v[192:207]
    s_waitcnt lgkmcnt(5)
    v_mfma_f32_32x32x16_bf16 v[144:159], v[16:19], v[88:91], v[144:159]
    v_mfma_f32_32x32x16_bf16 v[208:223], v[20:23], v[88:91], v[208:223]
    s_waitcnt lgkmcnt(4)
    v_mfma_f32_32x32x16_bf16 v[160:175], v[16:19], v[92:95], v[160:175]
    v_mfma_f32_32x32x16_bf16 v[224:239], v[20:23], v[92:95], v[224:239]
    ds_read_b128 v[80:83], v8 offset:1600
    ds_read_b128 v[84:87], v8 offset:30784
    ds_read_b128 v[88:91], v9 offset:1600
    ds_read_b128 v[92:95], v9 offset:30784
    s_waitcnt vmcnt(13) lgkmcnt(7)
    v_mfma_f32_32x32x16_bf16 v[112:127], v[24:27], v[96:99], v[112:127]
    s_waitcnt vmcnt(12)
    v_mfma_f32_32x32x16_bf16 v[176:191], v[28:31], v[96:99], v[176:191]
    s_waitcnt lgkmcnt(6)
    v_mfma_f32_32x32x16_bf16 v[128:143], v[24:27], v[100:103], v[128:143]
    v_mfma_f32_32x32x16_bf16 v[192:207], v[28:31], v[100:103], v[192:207]
    s_waitcnt lgkmcnt(5)
    v_mfma_f32_32x32x16_bf16 v[144:159], v[24:27], v[104:107], v[144:159]
    v_mfma_f32_32x32x16_bf16 v[208:223], v[28:31], v[104:107], v[208:223]
    s_waitcnt lgkmcnt(4)
    v_mfma_f32_32x32x16_bf16 v[160:175], v[24:27], v[108:111], v[160:175]
    v_mfma_f32_32x32x16_bf16 v[224:239], v[28:31], v[108:111], v[224:239]
    ds_read_b128 v[96:99], v8 offset:1632
    ds_read_b128 v[100:103], v8 offset:30816
    ds_read_b128 v[104:107], v9 offset:1632
    ds_read_b128 v[108:111], v9 offset:30816
    s_waitcnt vmcnt(11) lgkmcnt(7)
    v_mfma_f32_32x32x16_bf16 v[112:127], v[32:35], v[80:83], v[112:127]
    s_waitcnt vmcnt(10)
    v_mfma_f32_32x32x16_bf16 v[176:191], v[36:39], v[80:83], v[176:191]
    s_waitcnt lgkmcnt(6)
    v_mfma_f32_32x32x16_bf16 v[128:143], v[32:35], v[84:87], v[128:143]
    v_mfma_f32_32x32x16_bf16 v[192:207], v[36:39], v[84:87], v[192:207]
    s_waitcnt lgkmcnt(5)
    v_mfma_f32_32x32x16_bf16 v[144:159], v[32:35], v[88:91], v[144:159]
    v_mfma_f32_32x32x16_bf16 v[208:223], v[36:39], v[88:91], v[208:223]
    s_waitcnt lgkmcnt(4)
    v_mfma_f32_32x32x16_bf16 v[160:175], v[32:35], v[92:95], v[160:175]
    v_mfma_f32_32x32x16_bf16 v[224:239], v[36:39], v[92:95], v[224:239]
    ds_read_b128 v[80:83], v8 offset:1664
    ds_read_b128 v[84:87], v8 offset:30848
    ds_read_b128 v[88:91], v9 offset:1664
    ds_read_b128 v[92:95], v9 offset:30848
    s_waitcnt vmcnt(9) lgkmcnt(7)
    v_mfma_f32_32x32x16_bf16 v[112:127], v[40:43], v[96:99], v[112:127]
    s_waitcnt vmcnt(8)
    v_mfma_f32_32x32x16_bf16 v[176:191], v[44:47], v[96:99], v[176:191]
    s_waitcnt lgkmcnt(6)
    v_mfma_f32_32x32x16_bf16 v[128:143], v[40:43], v[100:103], v[128:143]
    v_mfma_f32_32x32x16_bf16 v[192:207], v[44:47], v[100:103], v[192:207]
    s_waitcnt lgkmcnt(5)
    v_mfma_f32_32x32x16_bf16 v[144:159], v[40:43], v[104:107], v[144:159]
    v_mfma_f32_32x32x16_bf16 v[208:223], v[44:47], v[104:107], v[208:223]
    s_waitcnt lgkmcnt(4)
    v_mfma_f32_32x32x16_bf16 v[160:175], v[40:43], v[108:111], v[160:175]
    v_mfma_f32_32x32x16_bf16 v[224:239], v[44:47], v[108:111], v[224:239]
    buffer_load_dwordx4 v[16:19], v2, s[16:19], s35 offen offset:0
    buffer_load_dwordx4 v[20:23], v2, s[48:51], s35 offen offset:0
    buffer_load_dwordx4 v[24:27], v2, s[16:19], s35 offen offset:1024
    buffer_load_dwordx4 v[28:31], v2, s[48:51], s35 offen offset:1024
    buffer_load_dwordx4 v[32:35], v2, s[16:19], s35 offen offset:2048
    buffer_load_dwordx4 v[36:39], v2, s[48:51], s35 offen offset:2048
    buffer_load_dwordx4 v[40:43], v2, s[16:19], s35 offen offset:3072
    buffer_load_dwordx4 v[44:47], v2, s[48:51], s35 offen offset:3072
    s_add_u32 s35, s35, 4096
    ds_read_b128 v[96:99], v8 offset:1696
    ds_read_b128 v[100:103], v8 offset:30880
    ds_read_b128 v[104:107], v9 offset:1696
    ds_read_b128 v[108:111], v9 offset:30880
    s_waitcnt vmcnt(15) lgkmcnt(7)
    v_mfma_f32_32x32x16_bf16 v[112:127], v[48:51], v[80:83], v[112:127]
    s_waitcnt vmcnt(14)
    v_mfma_f32_32x32x16_bf16 v[176:191], v[52:55], v[80:83], v[176:191]
    s_waitcnt lgkmcnt(6)
    v_mfma_f32_32x32x16_bf16 v[128:143], v[48:51], v[84:87], v[128:143]
    v_mfma_f32_32x32x16_bf16 v[192:207], v[52:55], v[84:87], v[192:207]
    s_waitcnt lgkmcnt(5)
    v_mfma_f32_32x32x16_bf16 v[144:159], v[48:51], v[88:91], v[144:159]
    v_mfma_f32_32x32x16_bf16 v[208:223], v[52:55], v[88:91], v[208:223]
    s_waitcnt lgkmcnt(4)
    v_mfma_f32_32x32x16_bf16 v[160:175], v[48:51], v[92:95], v[160:175]
    v_mfma_f32_32x32x16_bf16 v[224:239], v[52:55], v[92:95], v[224:239]
    ds_read_b128 v[80:83], v8 offset:1728
    ds_read_b128 v[84:87], v8 offset:30912
    ds_read_b128 v[88:91], v9 offset:1728
    ds_read_b128 v[92:95], v9 offset:30912
    s_waitcnt vmcnt(13) lgkmcnt(7)
    v_mfma_f32_32x32x16_bf16 v[112:127], v[56:59], v[96:99], v[112:127]
    s_waitcnt vmcnt(12)
    v_mfma_f32_32x32x16_bf16 v[176:191], v[60:63], v[96:99], v[176:191]
    s_waitcnt lgkmcnt(6)
    v_mfma_f32_32x32x16_bf16 v[128:143], v[56:59], v[100:103], v[128:143]
    v_mfma_f32_32x32x16_bf16 v[192:207], v[60:63], v[100:103], v[192:207]
    s_waitcnt lgkmcnt(5)
    v_mfma_f32_32x32x16_bf16 v[144:159], v[56:59], v[104:107], v[144:159]
    v_mfma_f32_32x32x16_bf16 v[208:223], v[60:63], v[104:107], v[208:223]
    s_waitcnt lgkmcnt(4)
    v_mfma_f32_32x32x16_bf16 v[160:175], v[56:59], v[108:111], v[160:175]
    v_mfma_f32_32x32x16_bf16 v[224:239], v[60:63], v[108:111], v[224:239]
    ds_read_b128 v[96:99], v8 offset:1760
    ds_read_b128 v[100:103], v8 offset:30944
    ds_read_b128 v[104:107], v9 offset:1760
    ds_read_b128 v[108:111], v9 offset:30944
    s_waitcnt vmcnt(11) lgkmcnt(7)
    v_mfma_f32_32x32x16_bf16 v[112:127], v[64:67], v[80:83], v[112:127]
    s_waitcnt vmcnt(10)
    v_mfma_f32_32x32x16_bf16 v[176:191], v[68:71], v[80:83], v[176:191]
    s_waitcnt lgkmcnt(6)
    v_mfma_f32_32x32x16_bf16 v[128:143], v[64:67], v[84:87], v[128:143]
    v_mfma_f32_32x32x16_bf16 v[192:207], v[68:71], v[84:87], v[192:207]
    s_waitcnt lgkmcnt(5)
    v_mfma_f32_32x32x16_bf16 v[144:159], v[64:67], v[88:91], v[144:159]
    v_mfma_f32_32x32x16_bf16 v[208:223], v[68:71], v[88:91], v[208:223]
    s_waitcnt lgkmcnt(4)
    v_mfma_f32_32x32x16_bf16 v[160:175], v[64:67], v[92:95], v[160:175]
    v_mfma_f32_32x32x16_bf16 v[224:239], v[68:71], v[92:95], v[224:239]
    ds_read_b128 v[80:83], v8 offset:1792
    ds_read_b128 v[84:87], v8 offset:30976
    ds_read_b128 v[88:91], v9 offset:1792
    ds_read_b128 v[92:95], v9 offset:30976
    s_waitcnt vmcnt(9) lgkmcnt(7)
    v_mfma_f32_32x32x16_bf16 v[112:127], v[72:75], v[96:99], v[112:127]
    s_waitcnt vmcnt(8)
    v_mfma_f32_32x32x16_bf16 v[176:191], v[76:79], v[96:99], v[176:191]
    s_waitcnt lgkmcnt(6)
    v_mfma_f32_32x32x16_bf16 v[128:143], v[72:75], v[100:103], v[128:143]
    v_mfma_f32_32x32x16_bf16 v[192:207], v[76:79], v[100:103], v[192:207]
    s_waitcnt lgkmcnt(5)
    v_mfma_f32_32x32x16_bf16 v[144:159], v[72:75], v[104:107], v[144:159]
    v_mfma_f32_32x32x16_bf16 v[208:223], v[76:79], v[104:107], v[208:223]
    s_waitcnt lgkmcnt(4)
    v_mfma_f32_32x32x16_bf16 v[160:175], v[72:75], v[108:111], v[160:175]
    v_mfma_f32_32x32x16_bf16 v[224:239], v[76:79], v[108:111], v[224:239]
    ds_read_b128 v[96:99], v8 offset:1824
    ds_read_b128 v[100:103], v8 offset:31008
    ds_read_b128 v[104:107], v9 offset:1824
    ds_read_b128 v[108:111], v9 offset:31008
    s_waitcnt vmcnt(7) lgkmcnt(7)
    v_mfma_f32_32x32x16_bf16 v[112:127], v[16:19], v[80:83], v[112:127]
    s_waitcnt vmcnt(6)
    v_mfma_f32_32x32x16_bf16 v[176:191], v[20:23], v[80:83], v[176:191]
    s_waitcnt lgkmcnt(6)
    v_mfma_f32_32x32x16_bf16 v[128:143], v[16:19], v[84:87], v[128:143]
    v_mfma_f32_32x32x16_bf16 v[192:207], v[20:23], v[84:87], v[192:207]
    s_waitcnt lgkmcnt(5)
    v_mfma_f32_32x32x16_bf16 v[144:159], v[16:19], v[88:91], v[144:159]
    v_mfma_f32_32x32x16_bf16 v[208:223], v[20:23], v[88:91], v[208:223]
    s_waitcnt lgkmcnt(4)
    v_mfma_f32_32x32x16_bf16 v[160:175], v[16:19], v[92:95], v[160:175]
    v_mfma_f32_32x32x16_bf16 v[224:239], v[20:23], v[92:95], v[224:239]
    ds_read_b128 v[80:83], v8 offset:1856
    ds_read_b128 v[84:87], v8 offset:31040
    ds_read_b128 v[88:91], v9 offset:1856
    ds_read_b128 v[92:95], v9 offset:31040
    s_waitcnt vmcnt(5) lgkmcnt(7)
    v_mfma_f32_32x32x16_bf16 v[112:127], v[24:27], v[96:99], v[112:127]
    s_waitcnt vmcnt(4)
    v_mfma_f32_32x32x16_bf16 v[176:191], v[28:31], v[96:99], v[176:191]
    s_waitcnt lgkmcnt(6)
    v_mfma_f32_32x32x16_bf16 v[128:143], v[24:27], v[100:103], v[128:143]
    v_mfma_f32_32x32x16_bf16 v[192:207], v[28:31], v[100:103], v[192:207]
    s_waitcnt lgkmcnt(5)
    v_mfma_f32_32x32x16_bf16 v[144:159], v[24:27], v[104:107], v[144:159]
    v_mfma_f32_32x32x16_bf16 v[208:223], v[28:31], v[104:107], v[208:223]
    s_waitcnt lgkmcnt(4)
    v_mfma_f32_32x32x16_bf16 v[160:175], v[24:27], v[108:111], v[160:175]
    v_mfma_f32_32x32x16_bf16 v[224:239], v[28:31], v[108:111], v[224:239]
    ds_read_b128 v[96:99], v8 offset:1888
    ds_read_b128 v[100:103], v8 offset:31072
    ds_read_b128 v[104:107], v9 offset:1888
    ds_read_b128 v[108:111], v9 offset:31072
    s_waitcnt vmcnt(3) lgkmcnt(7)
    v_mfma_f32_32x32x16_bf16 v[112:127], v[32:35], v[80:83], v[112:127]
    s_waitcnt vmcnt(2)
    v_mfma_f32_32x32x16_bf16 v[176:191], v[36:39], v[80:83], v[176:191]
    s_waitcnt lgkmcnt(6)
    v_mfma_f32_32x32x16_bf16 v[128:143], v[32:35], v[84:87], v[128:143]
    v_mfma_f32_32x32x16_bf16 v[192:207], v[36:39], v[84:87], v[192:207]
    s_waitcnt lgkmcnt(5)
    v_mfma_f32_32x32x16_bf16 v[144:159], v[32:35], v[88:91], v[144:159]
    v_mfma_f32_32x32x16_bf16 v[208:223], v[36:39], v[88:91], v[208:223]
    s_waitcnt lgkmcnt(4)
    v_mfma_f32_32x32x16_bf16 v[160:175], v[32:35], v[92:95], v[160:175]
    v_mfma_f32_32x32x16_bf16 v[224:239], v[36:39], v[92:95], v[224:239]
    s_waitcnt vmcnt(1) lgkmcnt(3)
    v_mfma_f32_32x32x16_bf16 v[112:127], v[40:43], v[96:99], v[112:127]
    s_waitcnt vmcnt(0)
    v_mfma_f32_32x32x16_bf16 v[176:191], v[44:47], v[96:99], v[176:191]
    s_waitcnt lgkmcnt(2)
    v_mfma_f32_32x32x16_bf16 v[128:143], v[40:43], v[100:103], v[128:143]
    v_mfma_f32_32x32x16_bf16 v[192:207], v[44:47], v[100:103], v[192:207]
    s_waitcnt lgkmcnt(1)
    v_mfma_f32_32x32x16_bf16 v[144:159], v[40:43], v[104:107], v[144:159]
    v_mfma_f32_32x32x16_bf16 v[208:223], v[44:47], v[104:107], v[208:223]
    s_waitcnt lgkmcnt(0)
    v_mfma_f32_32x32x16_bf16 v[160:175], v[40:43], v[108:111], v[160:175]
    v_mfma_f32_32x32x16_bf16 v[224:239], v[44:47], v[108:111], v[224:239]
    v_lshrrev_b32 v4, 5, v1
    v_lshlrev_b32 v4, 4, v4
    s_lshl_b32 s37, s33, 7
    buffer_load_dwordx4 v[16:19], v4, s[24:27], s37 offen offset:0
    buffer_load_dwordx4 v[32:35], v4, s[52:55], s37 offen offset:0
    buffer_load_dwordx4 v[20:23], v4, s[24:27], s37 offen offset:32
    buffer_load_dwordx4 v[36:39], v4, s[52:55], s37 offen offset:32
    buffer_load_dwordx4 v[24:27], v4, s[24:27], s37 offen offset:64
    buffer_load_dwordx4 v[40:43], v4, s[52:55], s37 offen offset:64
    buffer_load_dwordx4 v[28:31], v4, s[24:27], s37 offen offset:96
    buffer_load_dwordx4 v[44:47], v4, s[52:55], s37 offen offset:96
    v_and_b32 v5, 31, v1
    v_lshlrev_b32 v5, 2, v5
    ds_read_b32 v48, v5 offset:0
    ds_read_b32 v52, v5 offset:512
    ds_read_b32 v49, v5 offset:128
    ds_read_b32 v53, v5 offset:640
    ds_read_b32 v50, v5 offset:256
    ds_read_b32 v54, v5 offset:768
    ds_read_b32 v51, v5 offset:384
    ds_read_b32 v55, v5 offset:896
    v_and_b32 v5, 31, v1
    v_lshlrev_b32 v5, 4, v5
    v_lshrrev_b32 v6, 5, v1
    v_lshl_add_u32 v5, v6, 3, v5
    s_lshl_b32 s36, s31, 2
    s_mul_i32 s36, s36, 114688
    s_lshl_b32 s37, s33, 11
    s_add_u32 s36, s36, s37
    s_waitcnt lgkmcnt(7)
    v_mul_f32 v112, v112, v48
    s_waitcnt vmcnt(7) lgkmcnt(6)
    v_fma_f32 v112, -v52, v16, v112
    v_mul_f32 v112, -1.4426950408889634, v112
    v_exp_f32 v112, v112
    v_mul_f32 v176, v176, v48
    s_waitcnt vmcnt(6)
    v_fma_f32 v176, -v52, v32, v176
    v_add_f32 v112, 1.0, v112
    v_rcp_f32 v112, v112
    s_nop 0
    v_mul_f32 v176, v176, v112
    v_mul_f32 v113, v113, v48
    v_fma_f32 v113, -v52, v17, v113
    v_mul_f32 v113, -1.4426950408889634, v113
    v_exp_f32 v113, v113
    v_mul_f32 v177, v177, v48
    v_fma_f32 v177, -v52, v33, v177
    v_add_f32 v113, 1.0, v113
    v_rcp_f32 v113, v113
    s_nop 0
    v_mul_f32 v177, v177, v113
    v_mul_f32 v114, v114, v48
    v_fma_f32 v114, -v52, v18, v114
    v_mul_f32 v114, -1.4426950408889634, v114
    v_exp_f32 v114, v114
    v_mul_f32 v178, v178, v48
    v_fma_f32 v178, -v52, v34, v178
    v_add_f32 v114, 1.0, v114
    v_rcp_f32 v114, v114
    s_nop 0
    v_mul_f32 v178, v178, v114
    v_mul_f32 v115, v115, v48
    v_fma_f32 v115, -v52, v19, v115
    v_mul_f32 v115, -1.4426950408889634, v115
    v_exp_f32 v115, v115
    v_mul_f32 v179, v179, v48
    v_fma_f32 v179, -v52, v35, v179
    v_add_f32 v115, 1.0, v115
    v_rcp_f32 v115, v115
    s_nop 0
    v_mul_f32 v179, v179, v115
    v_cvt_pk_bf16_f32 v56, v176, v177
    v_cvt_pk_bf16_f32 v57, v178, v179
    buffer_store_dwordx2 v[56:57], v5, s[56:59], s36 offen offset:0
    v_mul_f32 v116, v116, v48
    s_waitcnt vmcnt(6)
    v_fma_f32 v116, -v52, v20, v116
    v_mul_f32 v116, -1.4426950408889634, v116
    v_exp_f32 v116, v116
    v_mul_f32 v180, v180, v48
    s_waitcnt vmcnt(5)
    v_fma_f32 v180, -v52, v36, v180
    v_add_f32 v116, 1.0, v116
    v_rcp_f32 v116, v116
    s_nop 0
    v_mul_f32 v180, v180, v116
    v_mul_f32 v117, v117, v48
    v_fma_f32 v117, -v52, v21, v117
    v_mul_f32 v117, -1.4426950408889634, v117
    v_exp_f32 v117, v117
    v_mul_f32 v181, v181, v48
    v_fma_f32 v181, -v52, v37, v181
    v_add_f32 v117, 1.0, v117
    v_rcp_f32 v117, v117
    s_nop 0
    v_mul_f32 v181, v181, v117
    v_mul_f32 v118, v118, v48
    v_fma_f32 v118, -v52, v22, v118
    v_mul_f32 v118, -1.4426950408889634, v118
    v_exp_f32 v118, v118
    v_mul_f32 v182, v182, v48
    v_fma_f32 v182, -v52, v38, v182
    v_add_f32 v118, 1.0, v118
    v_rcp_f32 v118, v118
    s_nop 0
    v_mul_f32 v182, v182, v118
    v_mul_f32 v119, v119, v48
    v_fma_f32 v119, -v52, v23, v119
    v_mul_f32 v119, -1.4426950408889634, v119
    v_exp_f32 v119, v119
    v_mul_f32 v183, v183, v48
    v_fma_f32 v183, -v52, v39, v183
    v_add_f32 v119, 1.0, v119
    v_rcp_f32 v119, v119
    s_nop 0
    v_mul_f32 v183, v183, v119
    v_cvt_pk_bf16_f32 v56, v180, v181
    v_cvt_pk_bf16_f32 v57, v182, v183
    buffer_store_dwordx2 v[56:57], v5, s[56:59], s36 offen offset:512
    v_mul_f32 v120, v120, v48
    s_waitcnt vmcnt(5)
    v_fma_f32 v120, -v52, v24, v120
    v_mul_f32 v120, -1.4426950408889634, v120
    v_exp_f32 v120, v120
    v_mul_f32 v184, v184, v48
    s_waitcnt vmcnt(4)
    v_fma_f32 v184, -v52, v40, v184
    v_add_f32 v120, 1.0, v120
    v_rcp_f32 v120, v120
    s_nop 0
    v_mul_f32 v184, v184, v120
    v_mul_f32 v121, v121, v48
    v_fma_f32 v121, -v52, v25, v121
    v_mul_f32 v121, -1.4426950408889634, v121
    v_exp_f32 v121, v121
    v_mul_f32 v185, v185, v48
    v_fma_f32 v185, -v52, v41, v185
    v_add_f32 v121, 1.0, v121
    v_rcp_f32 v121, v121
    s_nop 0
    v_mul_f32 v185, v185, v121
    v_mul_f32 v122, v122, v48
    v_fma_f32 v122, -v52, v26, v122
    v_mul_f32 v122, -1.4426950408889634, v122
    v_exp_f32 v122, v122
    v_mul_f32 v186, v186, v48
    v_fma_f32 v186, -v52, v42, v186
    v_add_f32 v122, 1.0, v122
    v_rcp_f32 v122, v122
    s_nop 0
    v_mul_f32 v186, v186, v122
    v_mul_f32 v123, v123, v48
    v_fma_f32 v123, -v52, v27, v123
    v_mul_f32 v123, -1.4426950408889634, v123
    v_exp_f32 v123, v123
    v_mul_f32 v187, v187, v48
    v_fma_f32 v187, -v52, v43, v187
    v_add_f32 v123, 1.0, v123
    v_rcp_f32 v123, v123
    s_nop 0
    v_mul_f32 v187, v187, v123
    v_cvt_pk_bf16_f32 v56, v184, v185
    v_cvt_pk_bf16_f32 v57, v186, v187
    buffer_store_dwordx2 v[56:57], v5, s[56:59], s36 offen offset:1024
    v_mul_f32 v124, v124, v48
    s_waitcnt vmcnt(4)
    v_fma_f32 v124, -v52, v28, v124
    v_mul_f32 v124, -1.4426950408889634, v124
    v_exp_f32 v124, v124
    v_mul_f32 v188, v188, v48
    s_waitcnt vmcnt(3)
    v_fma_f32 v188, -v52, v44, v188
    v_add_f32 v124, 1.0, v124
    v_rcp_f32 v124, v124
    s_nop 0
    v_mul_f32 v188, v188, v124
    v_mul_f32 v125, v125, v48
    v_fma_f32 v125, -v52, v29, v125
    v_mul_f32 v125, -1.4426950408889634, v125
    v_exp_f32 v125, v125
    v_mul_f32 v189, v189, v48
    v_fma_f32 v189, -v52, v45, v189
    v_add_f32 v125, 1.0, v125
    v_rcp_f32 v125, v125
    s_nop 0
    v_mul_f32 v189, v189, v125
    v_mul_f32 v126, v126, v48
    v_fma_f32 v126, -v52, v30, v126
    v_mul_f32 v126, -1.4426950408889634, v126
    v_exp_f32 v126, v126
    v_mul_f32 v190, v190, v48
    v_fma_f32 v190, -v52, v46, v190
    v_add_f32 v126, 1.0, v126
    v_rcp_f32 v126, v126
    s_nop 0
    v_mul_f32 v190, v190, v126
    v_mul_f32 v127, v127, v48
    v_fma_f32 v127, -v52, v31, v127
    v_mul_f32 v127, -1.4426950408889634, v127
    v_exp_f32 v127, v127
    v_mul_f32 v191, v191, v48
    v_fma_f32 v191, -v52, v47, v191
    v_add_f32 v127, 1.0, v127
    v_rcp_f32 v127, v127
    s_nop 0
    v_mul_f32 v191, v191, v127
    v_cvt_pk_bf16_f32 v56, v188, v189
    v_cvt_pk_bf16_f32 v57, v190, v191
    buffer_store_dwordx2 v[56:57], v5, s[56:59], s36 offen offset:1536
    s_add_u32 s36, s36, 114688
    s_waitcnt lgkmcnt(5)
    v_mul_f32 v128, v128, v49
    s_waitcnt lgkmcnt(4)
    v_fma_f32 v128, -v53, v16, v128
    v_mul_f32 v128, -1.4426950408889634, v128
    v_exp_f32 v128, v128
    v_mul_f32 v192, v192, v49
    v_fma_f32 v192, -v53, v32, v192
    v_add_f32 v128, 1.0, v128
    v_rcp_f32 v128, v128
    s_nop 0
    v_mul_f32 v192, v192, v128
    v_mul_f32 v129, v129, v49
    v_fma_f32 v129, -v53, v17, v129
    v_mul_f32 v129, -1.4426950408889634, v129
    v_exp_f32 v129, v129
    v_mul_f32 v193, v193, v49
    v_fma_f32 v193, -v53, v33, v193
    v_add_f32 v129, 1.0, v129
    v_rcp_f32 v129, v129
    s_nop 0
    v_mul_f32 v193, v193, v129
    v_mul_f32 v130, v130, v49
    v_fma_f32 v130, -v53, v18, v130
    v_mul_f32 v130, -1.4426950408889634, v130
    v_exp_f32 v130, v130
    v_mul_f32 v194, v194, v49
    v_fma_f32 v194, -v53, v34, v194
    v_add_f32 v130, 1.0, v130
    v_rcp_f32 v130, v130
    s_nop 0
    v_mul_f32 v194, v194, v130
    v_mul_f32 v131, v131, v49
    v_fma_f32 v131, -v53, v19, v131
    v_mul_f32 v131, -1.4426950408889634, v131
    v_exp_f32 v131, v131
    v_mul_f32 v195, v195, v49
    v_fma_f32 v195, -v53, v35, v195
    v_add_f32 v131, 1.0, v131
    v_rcp_f32 v131, v131
    s_nop 0
    v_mul_f32 v195, v195, v131
    v_cvt_pk_bf16_f32 v56, v192, v193
    v_cvt_pk_bf16_f32 v57, v194, v195
    buffer_store_dwordx2 v[56:57], v5, s[56:59], s36 offen offset:0
    v_mul_f32 v132, v132, v49
    v_fma_f32 v132, -v53, v20, v132
    v_mul_f32 v132, -1.4426950408889634, v132
    v_exp_f32 v132, v132
    v_mul_f32 v196, v196, v49
    v_fma_f32 v196, -v53, v36, v196
    v_add_f32 v132, 1.0, v132
    v_rcp_f32 v132, v132
    s_nop 0
    v_mul_f32 v196, v196, v132
    v_mul_f32 v133, v133, v49
    v_fma_f32 v133, -v53, v21, v133
    v_mul_f32 v133, -1.4426950408889634, v133
    v_exp_f32 v133, v133
    v_mul_f32 v197, v197, v49
    v_fma_f32 v197, -v53, v37, v197
    v_add_f32 v133, 1.0, v133
    v_rcp_f32 v133, v133
    s_nop 0
    v_mul_f32 v197, v197, v133
    v_mul_f32 v134, v134, v49
    v_fma_f32 v134, -v53, v22, v134
    v_mul_f32 v134, -1.4426950408889634, v134
    v_exp_f32 v134, v134
    v_mul_f32 v198, v198, v49
    v_fma_f32 v198, -v53, v38, v198
    v_add_f32 v134, 1.0, v134
    v_rcp_f32 v134, v134
    s_nop 0
    v_mul_f32 v198, v198, v134
    v_mul_f32 v135, v135, v49
    v_fma_f32 v135, -v53, v23, v135
    v_mul_f32 v135, -1.4426950408889634, v135
    v_exp_f32 v135, v135
    v_mul_f32 v199, v199, v49
    v_fma_f32 v199, -v53, v39, v199
    v_add_f32 v135, 1.0, v135
    v_rcp_f32 v135, v135
    s_nop 0
    v_mul_f32 v199, v199, v135
    v_cvt_pk_bf16_f32 v56, v196, v197
    v_cvt_pk_bf16_f32 v57, v198, v199
    buffer_store_dwordx2 v[56:57], v5, s[56:59], s36 offen offset:512
    v_mul_f32 v136, v136, v49
    v_fma_f32 v136, -v53, v24, v136
    v_mul_f32 v136, -1.4426950408889634, v136
    v_exp_f32 v136, v136
    v_mul_f32 v200, v200, v49
    v_fma_f32 v200, -v53, v40, v200
    v_add_f32 v136, 1.0, v136
    v_rcp_f32 v136, v136
    s_nop 0
    v_mul_f32 v200, v200, v136
    v_mul_f32 v137, v137, v49
    v_fma_f32 v137, -v53, v25, v137
    v_mul_f32 v137, -1.4426950408889634, v137
    v_exp_f32 v137, v137
    v_mul_f32 v201, v201, v49
    v_fma_f32 v201, -v53, v41, v201
    v_add_f32 v137, 1.0, v137
    v_rcp_f32 v137, v137
    s_nop 0
    v_mul_f32 v201, v201, v137
    v_mul_f32 v138, v138, v49
    v_fma_f32 v138, -v53, v26, v138
    v_mul_f32 v138, -1.4426950408889634, v138
    v_exp_f32 v138, v138
    v_mul_f32 v202, v202, v49
    v_fma_f32 v202, -v53, v42, v202
    v_add_f32 v138, 1.0, v138
    v_rcp_f32 v138, v138
    s_nop 0
    v_mul_f32 v202, v202, v138
    v_mul_f32 v139, v139, v49
    v_fma_f32 v139, -v53, v27, v139
    v_mul_f32 v139, -1.4426950408889634, v139
    v_exp_f32 v139, v139
    v_mul_f32 v203, v203, v49
    v_fma_f32 v203, -v53, v43, v203
    v_add_f32 v139, 1.0, v139
    v_rcp_f32 v139, v139
    s_nop 0
    v_mul_f32 v203, v203, v139
    v_cvt_pk_bf16_f32 v56, v200, v201
    v_cvt_pk_bf16_f32 v57, v202, v203
    buffer_store_dwordx2 v[56:57], v5, s[56:59], s36 offen offset:1024
    v_mul_f32 v140, v140, v49
    v_fma_f32 v140, -v53, v28, v140
    v_mul_f32 v140, -1.4426950408889634, v140
    v_exp_f32 v140, v140
    v_mul_f32 v204, v204, v49
    v_fma_f32 v204, -v53, v44, v204
    v_add_f32 v140, 1.0, v140
    v_rcp_f32 v140, v140
    s_nop 0
    v_mul_f32 v204, v204, v140
    v_mul_f32 v141, v141, v49
    v_fma_f32 v141, -v53, v29, v141
    v_mul_f32 v141, -1.4426950408889634, v141
    v_exp_f32 v141, v141
    v_mul_f32 v205, v205, v49
    v_fma_f32 v205, -v53, v45, v205
    v_add_f32 v141, 1.0, v141
    v_rcp_f32 v141, v141
    s_nop 0
    v_mul_f32 v205, v205, v141
    v_mul_f32 v142, v142, v49
    v_fma_f32 v142, -v53, v30, v142
    v_mul_f32 v142, -1.4426950408889634, v142
    v_exp_f32 v142, v142
    v_mul_f32 v206, v206, v49
    v_fma_f32 v206, -v53, v46, v206
    v_add_f32 v142, 1.0, v142
    v_rcp_f32 v142, v142
    s_nop 0
    v_mul_f32 v206, v206, v142
    v_mul_f32 v143, v143, v49
    v_fma_f32 v143, -v53, v31, v143
    v_mul_f32 v143, -1.4426950408889634, v143
    v_exp_f32 v143, v143
    v_mul_f32 v207, v207, v49
    v_fma_f32 v207, -v53, v47, v207
    v_add_f32 v143, 1.0, v143
    v_rcp_f32 v143, v143
    s_nop 0
    v_mul_f32 v207, v207, v143
    v_cvt_pk_bf16_f32 v56, v204, v205
    v_cvt_pk_bf16_f32 v57, v206, v207
    buffer_store_dwordx2 v[56:57], v5, s[56:59], s36 offen offset:1536
    s_add_u32 s36, s36, 114688
    s_waitcnt lgkmcnt(3)
    v_mul_f32 v144, v144, v50
    s_waitcnt lgkmcnt(2)
    v_fma_f32 v144, -v54, v16, v144
    v_mul_f32 v144, -1.4426950408889634, v144
    v_exp_f32 v144, v144
    v_mul_f32 v208, v208, v50
    v_fma_f32 v208, -v54, v32, v208
    v_add_f32 v144, 1.0, v144
    v_rcp_f32 v144, v144
    s_nop 0
    v_mul_f32 v208, v208, v144
    v_mul_f32 v145, v145, v50
    v_fma_f32 v145, -v54, v17, v145
    v_mul_f32 v145, -1.4426950408889634, v145
    v_exp_f32 v145, v145
    v_mul_f32 v209, v209, v50
    v_fma_f32 v209, -v54, v33, v209
    v_add_f32 v145, 1.0, v145
    v_rcp_f32 v145, v145
    s_nop 0
    v_mul_f32 v209, v209, v145
    v_mul_f32 v146, v146, v50
    v_fma_f32 v146, -v54, v18, v146
    v_mul_f32 v146, -1.4426950408889634, v146
    v_exp_f32 v146, v146
    v_mul_f32 v210, v210, v50
    v_fma_f32 v210, -v54, v34, v210
    v_add_f32 v146, 1.0, v146
    v_rcp_f32 v146, v146
    s_nop 0
    v_mul_f32 v210, v210, v146
    v_mul_f32 v147, v147, v50
    v_fma_f32 v147, -v54, v19, v147
    v_mul_f32 v147, -1.4426950408889634, v147
    v_exp_f32 v147, v147
    v_mul_f32 v211, v211, v50
    v_fma_f32 v211, -v54, v35, v211
    v_add_f32 v147, 1.0, v147
    v_rcp_f32 v147, v147
    s_nop 0
    v_mul_f32 v211, v211, v147
    v_cvt_pk_bf16_f32 v56, v208, v209
    v_cvt_pk_bf16_f32 v57, v210, v211
    buffer_store_dwordx2 v[56:57], v5, s[56:59], s36 offen offset:0
    v_mul_f32 v148, v148, v50
    v_fma_f32 v148, -v54, v20, v148
    v_mul_f32 v148, -1.4426950408889634, v148
    v_exp_f32 v148, v148
    v_mul_f32 v212, v212, v50
    v_fma_f32 v212, -v54, v36, v212
    v_add_f32 v148, 1.0, v148
    v_rcp_f32 v148, v148
    s_nop 0
    v_mul_f32 v212, v212, v148
    v_mul_f32 v149, v149, v50
    v_fma_f32 v149, -v54, v21, v149
    v_mul_f32 v149, -1.4426950408889634, v149
    v_exp_f32 v149, v149
    v_mul_f32 v213, v213, v50
    v_fma_f32 v213, -v54, v37, v213
    v_add_f32 v149, 1.0, v149
    v_rcp_f32 v149, v149
    s_nop 0
    v_mul_f32 v213, v213, v149
    v_mul_f32 v150, v150, v50
    v_fma_f32 v150, -v54, v22, v150
    v_mul_f32 v150, -1.4426950408889634, v150
    v_exp_f32 v150, v150
    v_mul_f32 v214, v214, v50
    v_fma_f32 v214, -v54, v38, v214
    v_add_f32 v150, 1.0, v150
    v_rcp_f32 v150, v150
    s_nop 0
    v_mul_f32 v214, v214, v150
    v_mul_f32 v151, v151, v50
    v_fma_f32 v151, -v54, v23, v151
    v_mul_f32 v151, -1.4426950408889634, v151
    v_exp_f32 v151, v151
    v_mul_f32 v215, v215, v50
    v_fma_f32 v215, -v54, v39, v215
    v_add_f32 v151, 1.0, v151
    v_rcp_f32 v151, v151
    s_nop 0
    v_mul_f32 v215, v215, v151
    v_cvt_pk_bf16_f32 v56, v212, v213
    v_cvt_pk_bf16_f32 v57, v214, v215
    buffer_store_dwordx2 v[56:57], v5, s[56:59], s36 offen offset:512
    v_mul_f32 v152, v152, v50
    v_fma_f32 v152, -v54, v24, v152
    v_mul_f32 v152, -1.4426950408889634, v152
    v_exp_f32 v152, v152
    v_mul_f32 v216, v216, v50
    v_fma_f32 v216, -v54, v40, v216
    v_add_f32 v152, 1.0, v152
    v_rcp_f32 v152, v152
    s_nop 0
    v_mul_f32 v216, v216, v152
    v_mul_f32 v153, v153, v50
    v_fma_f32 v153, -v54, v25, v153
    v_mul_f32 v153, -1.4426950408889634, v153
    v_exp_f32 v153, v153
    v_mul_f32 v217, v217, v50
    v_fma_f32 v217, -v54, v41, v217
    v_add_f32 v153, 1.0, v153
    v_rcp_f32 v153, v153
    s_nop 0
    v_mul_f32 v217, v217, v153
    v_mul_f32 v154, v154, v50
    v_fma_f32 v154, -v54, v26, v154
    v_mul_f32 v154, -1.4426950408889634, v154
    v_exp_f32 v154, v154
    v_mul_f32 v218, v218, v50
    v_fma_f32 v218, -v54, v42, v218
    v_add_f32 v154, 1.0, v154
    v_rcp_f32 v154, v154
    s_nop 0
    v_mul_f32 v218, v218, v154
    v_mul_f32 v155, v155, v50
    v_fma_f32 v155, -v54, v27, v155
    v_mul_f32 v155, -1.4426950408889634, v155
    v_exp_f32 v155, v155
    v_mul_f32 v219, v219, v50
    v_fma_f32 v219, -v54, v43, v219
    v_add_f32 v155, 1.0, v155
    v_rcp_f32 v155, v155
    s_nop 0
    v_mul_f32 v219, v219, v155
    v_cvt_pk_bf16_f32 v56, v216, v217
    v_cvt_pk_bf16_f32 v57, v218, v219
    buffer_store_dwordx2 v[56:57], v5, s[56:59], s36 offen offset:1024
    v_mul_f32 v156, v156, v50
    v_fma_f32 v156, -v54, v28, v156
    v_mul_f32 v156, -1.4426950408889634, v156
    v_exp_f32 v156, v156
    v_mul_f32 v220, v220, v50
    v_fma_f32 v220, -v54, v44, v220
    v_add_f32 v156, 1.0, v156
    v_rcp_f32 v156, v156
    s_nop 0
    v_mul_f32 v220, v220, v156
    v_mul_f32 v157, v157, v50
    v_fma_f32 v157, -v54, v29, v157
    v_mul_f32 v157, -1.4426950408889634, v157
    v_exp_f32 v157, v157
    v_mul_f32 v221, v221, v50
    v_fma_f32 v221, -v54, v45, v221
    v_add_f32 v157, 1.0, v157
    v_rcp_f32 v157, v157
    s_nop 0
    v_mul_f32 v221, v221, v157
    v_mul_f32 v158, v158, v50
    v_fma_f32 v158, -v54, v30, v158
    v_mul_f32 v158, -1.4426950408889634, v158
    v_exp_f32 v158, v158
    v_mul_f32 v222, v222, v50
    v_fma_f32 v222, -v54, v46, v222
    v_add_f32 v158, 1.0, v158
    v_rcp_f32 v158, v158
    s_nop 0
    v_mul_f32 v222, v222, v158
    v_mul_f32 v159, v159, v50
    v_fma_f32 v159, -v54, v31, v159
    v_mul_f32 v159, -1.4426950408889634, v159
    v_exp_f32 v159, v159
    v_mul_f32 v223, v223, v50
    v_fma_f32 v223, -v54, v47, v223
    v_add_f32 v159, 1.0, v159
    v_rcp_f32 v159, v159
    s_nop 0
    v_mul_f32 v223, v223, v159
    v_cvt_pk_bf16_f32 v56, v220, v221
    v_cvt_pk_bf16_f32 v57, v222, v223
    buffer_store_dwordx2 v[56:57], v5, s[56:59], s36 offen offset:1536
    s_add_u32 s36, s36, 114688
    s_waitcnt lgkmcnt(1)
    v_mul_f32 v160, v160, v51
    s_waitcnt lgkmcnt(0)
    v_fma_f32 v160, -v55, v16, v160
    v_mul_f32 v160, -1.4426950408889634, v160
    v_exp_f32 v160, v160
    v_mul_f32 v224, v224, v51
    v_fma_f32 v224, -v55, v32, v224
    v_add_f32 v160, 1.0, v160
    v_rcp_f32 v160, v160
    s_nop 0
    v_mul_f32 v224, v224, v160
    v_mul_f32 v161, v161, v51
    v_fma_f32 v161, -v55, v17, v161
    v_mul_f32 v161, -1.4426950408889634, v161
    v_exp_f32 v161, v161
    v_mul_f32 v225, v225, v51
    v_fma_f32 v225, -v55, v33, v225
    v_add_f32 v161, 1.0, v161
    v_rcp_f32 v161, v161
    s_nop 0
    v_mul_f32 v225, v225, v161
    v_mul_f32 v162, v162, v51
    v_fma_f32 v162, -v55, v18, v162
    v_mul_f32 v162, -1.4426950408889634, v162
    v_exp_f32 v162, v162
    v_mul_f32 v226, v226, v51
    v_fma_f32 v226, -v55, v34, v226
    v_add_f32 v162, 1.0, v162
    v_rcp_f32 v162, v162
    s_nop 0
    v_mul_f32 v226, v226, v162
    v_mul_f32 v163, v163, v51
    v_fma_f32 v163, -v55, v19, v163
    v_mul_f32 v163, -1.4426950408889634, v163
    v_exp_f32 v163, v163
    v_mul_f32 v227, v227, v51
    v_fma_f32 v227, -v55, v35, v227
    v_add_f32 v163, 1.0, v163
    v_rcp_f32 v163, v163
    s_nop 0
    v_mul_f32 v227, v227, v163
    v_cvt_pk_bf16_f32 v56, v224, v225
    v_cvt_pk_bf16_f32 v57, v226, v227
    buffer_store_dwordx2 v[56:57], v5, s[56:59], s36 offen offset:0
    v_mul_f32 v164, v164, v51
    v_fma_f32 v164, -v55, v20, v164
    v_mul_f32 v164, -1.4426950408889634, v164
    v_exp_f32 v164, v164
    v_mul_f32 v228, v228, v51
    v_fma_f32 v228, -v55, v36, v228
    v_add_f32 v164, 1.0, v164
    v_rcp_f32 v164, v164
    s_nop 0
    v_mul_f32 v228, v228, v164
    v_mul_f32 v165, v165, v51
    v_fma_f32 v165, -v55, v21, v165
    v_mul_f32 v165, -1.4426950408889634, v165
    v_exp_f32 v165, v165
    v_mul_f32 v229, v229, v51
    v_fma_f32 v229, -v55, v37, v229
    v_add_f32 v165, 1.0, v165
    v_rcp_f32 v165, v165
    s_nop 0
    v_mul_f32 v229, v229, v165
    v_mul_f32 v166, v166, v51
    v_fma_f32 v166, -v55, v22, v166
    v_mul_f32 v166, -1.4426950408889634, v166
    v_exp_f32 v166, v166
    v_mul_f32 v230, v230, v51
    v_fma_f32 v230, -v55, v38, v230
    v_add_f32 v166, 1.0, v166
    v_rcp_f32 v166, v166
    s_nop 0
    v_mul_f32 v230, v230, v166
    v_mul_f32 v167, v167, v51
    v_fma_f32 v167, -v55, v23, v167
    v_mul_f32 v167, -1.4426950408889634, v167
    v_exp_f32 v167, v167
    v_mul_f32 v231, v231, v51
    v_fma_f32 v231, -v55, v39, v231
    v_add_f32 v167, 1.0, v167
    v_rcp_f32 v167, v167
    s_nop 0
    v_mul_f32 v231, v231, v167
    v_cvt_pk_bf16_f32 v56, v228, v229
    v_cvt_pk_bf16_f32 v57, v230, v231
    buffer_store_dwordx2 v[56:57], v5, s[56:59], s36 offen offset:512
    v_mul_f32 v168, v168, v51
    v_fma_f32 v168, -v55, v24, v168
    v_mul_f32 v168, -1.4426950408889634, v168
    v_exp_f32 v168, v168
    v_mul_f32 v232, v232, v51
    v_fma_f32 v232, -v55, v40, v232
    v_add_f32 v168, 1.0, v168
    v_rcp_f32 v168, v168
    s_nop 0
    v_mul_f32 v232, v232, v168
    v_mul_f32 v169, v169, v51
    v_fma_f32 v169, -v55, v25, v169
    v_mul_f32 v169, -1.4426950408889634, v169
    v_exp_f32 v169, v169
    v_mul_f32 v233, v233, v51
    v_fma_f32 v233, -v55, v41, v233
    v_add_f32 v169, 1.0, v169
    v_rcp_f32 v169, v169
    s_nop 0
    v_mul_f32 v233, v233, v169
    v_mul_f32 v170, v170, v51
    v_fma_f32 v170, -v55, v26, v170
    v_mul_f32 v170, -1.4426950408889634, v170
    v_exp_f32 v170, v170
    v_mul_f32 v234, v234, v51
    v_fma_f32 v234, -v55, v42, v234
    v_add_f32 v170, 1.0, v170
    v_rcp_f32 v170, v170
    s_nop 0
    v_mul_f32 v234, v234, v170
    v_mul_f32 v171, v171, v51
    v_fma_f32 v171, -v55, v27, v171
    v_mul_f32 v171, -1.4426950408889634, v171
    v_exp_f32 v171, v171
    v_mul_f32 v235, v235, v51
    v_fma_f32 v235, -v55, v43, v235
    v_add_f32 v171, 1.0, v171
    v_rcp_f32 v171, v171
    s_nop 0
    v_mul_f32 v235, v235, v171
    v_cvt_pk_bf16_f32 v56, v232, v233
    v_cvt_pk_bf16_f32 v57, v234, v235
    buffer_store_dwordx2 v[56:57], v5, s[56:59], s36 offen offset:1024
    v_mul_f32 v172, v172, v51
    v_fma_f32 v172, -v55, v28, v172
    v_mul_f32 v172, -1.4426950408889634, v172
    v_exp_f32 v172, v172
    v_mul_f32 v236, v236, v51
    v_fma_f32 v236, -v55, v44, v236
    v_add_f32 v172, 1.0, v172
    v_rcp_f32 v172, v172
    s_nop 0
    v_mul_f32 v236, v236, v172
    v_mul_f32 v173, v173, v51
    v_fma_f32 v173, -v55, v29, v173
    v_mul_f32 v173, -1.4426950408889634, v173
    v_exp_f32 v173, v173
    v_mul_f32 v237, v237, v51
    v_fma_f32 v237, -v55, v45, v237
    v_add_f32 v173, 1.0, v173
    v_rcp_f32 v173, v173
    s_nop 0
    v_mul_f32 v237, v237, v173
    v_mul_f32 v174, v174, v51
    v_fma_f32 v174, -v55, v30, v174
    v_mul_f32 v174, -1.4426950408889634, v174
    v_exp_f32 v174, v174
    v_mul_f32 v238, v238, v51
    v_fma_f32 v238, -v55, v46, v238
    v_add_f32 v174, 1.0, v174
    v_rcp_f32 v174, v174
    s_nop 0
    v_mul_f32 v238, v238, v174
    v_mul_f32 v175, v175, v51
    v_fma_f32 v175, -v55, v31, v175
    v_mul_f32 v175, -1.4426950408889634, v175
    v_exp_f32 v175, v175
    v_mul_f32 v239, v239, v51
    v_fma_f32 v239, -v55, v47, v239
    v_add_f32 v175, 1.0, v175
    v_rcp_f32 v175, v175
    s_nop 0
    v_mul_f32 v239, v239, v175
    v_cvt_pk_bf16_f32 v56, v236, v237
    v_cvt_pk_bf16_f32 v57, v238, v239
    buffer_store_dwordx2 v[56:57], v5, s[56:59], s36 offen offset:1536
    s_add_u32 s36, s36, 114688
    s_endpgm
.section .rodata,"a"
.p2align 6
.amdhsa_kernel k4a_kernel
  .amdhsa_next_free_vgpr 240
  .amdhsa_next_free_sgpr 64
  .amdhsa_accum_offset 240
  .amdhsa_group_segment_fixed_size 0
  .amdhsa_kernarg_size 80
  .amdhsa_user_sgpr_count 2
  .amdhsa_user_sgpr_kernarg_segment_ptr 1
  .amdhsa_system_sgpr_workgroup_id_x 1
.end_amdhsa_kernel
.text
.globl k5a_kernel
.p2align 8
.type k5a_kernel,@function
k5a_kernel:
    s_cmp_ge_u32 s2, 224
    s_cbranch_scc0 k5a_kernel_go1
    s_endpgm
k5a_kernel_go1:
    s_load_dwordx2 s[4:5], s[0:1], 72
    s_waitcnt lgkmcnt(0)
    s_add_u32 s12, s4, 23068672
    s_addc_u32 s13, s5, 0
    s_mov_b32 s14, 7340032
    s_mov_b32 s15, 0x00020000
    s_add_u32 s16, s4, 6291456
    s_addc_u32 s17, s5, 0
    s_mov_b32 s18, 1605632
    s_mov_b32 s19, 0x00020000
    s_add_u32 s20, s4, 16777216
    s_addc_u32 s21, s5, 0
    s_mov_b32 s22, 1835008
    s_mov_b32 s23, 0x00020000
    s_add_u32 s24, s4, 18874368
    s_addc_u32 s25, s5, 0
    s_mov_b32 s26, 1835008
    s_mov_b32 s27, 0x00020000
    s_add_u32 s28, s4, 31981568
    s_addc_u32 s29, s5, 0
    s_mov_b32 s30, 229376
    s_mov_b32 s31, 0x00020000
    v_lshrrev_b32 v1, 6, v0
    s_nop 0
    v_readfirstlane_b32 s32, v1
    s_and_b32 s33, s2, 7
    s_lshl_b32 s33, s33, 2
    s_bfe_u32 s34, s2, 0x20003
    s_add_u32 s33, s33, s34
    s_lshr_b32 s34, s2, 5
    v_and_b32 v1, 63, v0
    v_lshlrev_b32 v2, 4, v1
    s_lshr_b32 s35, s32, 1
    s_and_b32 s36, s32, 1
    s_lshl_b32 s37, s33, 6
    s_lshl_b32 s38, s35, 5
    s_add_u32 s37, s37, s38
    v_and_b32 v3, 31, v1
    v_add_u32 v3, s37, v3
    v_mul_u32_u24 v4, 896, v3
    v_lshrrev_b32 v5, 5, v1
    v_lshl_add_u32 v4, v5, 3, v4
    s_lshl_b32 s38, s34, 7
    s_lshl_b32 s39, s36, 6
    s_add_u32 s38, s38, s39
    buffer_load_dwordx2 v[8:9], v4, s[20:23], s38 offen offset:0
    buffer_load_dwordx2 v[10:11], v4, s[20:23], s38 offen offset:16
    buffer_load_dwordx2 v[12:13], v4, s[20:23], s38 offen offset:32
    buffer_load_dwordx2 v[14:15], v4, s[20:23], s38 offen offset:48
    s_mul_i32 s40, s32, 28672
    s_mul_i32 s41, s33, 229376
    s_add_u32 s41, s41, s40
    s_add_u32 s42, s41, 114688
    s_mul_i32 s43, s34, 229376
    s_add_u32 s43, s43, s40
    s_add_u32 s44, s43, 114688
    buffer_load_dwordx4 v[80:83], v2, s[12:15], s41 offen offset:0
    buffer_load_dwordx4 v[84:87], v2, s[12:15], s42 offen offset:0
    buffer_load_dwordx4 v[88:91], v2, s[16:19], s43 offen offset:0
    buffer_load_dwordx4 v[92:95], v2, s[16:19], s44 offen offset:0
    buffer_load_dwordx4 v[96:99], v2, s[12:15], s41 offen offset:1024
    buffer_load_dwordx4 v[100:103], v2, s[12:15], s42 offen offset:1024
    buffer_load_dwordx4 v[104:107], v2, s[16:19], s43 offen offset:1024
    buffer_load_dwordx4 v[108:111], v2, s[16:19], s44 offen offset:1024
    buffer_load_dwordx4 v[112:115], v2, s[12:15], s41 offen offset:2048
    buffer_load_dwordx4 v[116:119], v2, s[12:15], s42 offen offset:2048
    buffer_load_dwordx4 v[120:123], v2, s[16:19], s43 offen offset:2048
    buffer_load_dwordx4 v[124:127], v2, s[16:19], s44 offen offset:2048
    buffer_load_dwordx4 v[128:131], v2, s[12:15], s41 offen offset:3072
    buffer_load_dwordx4 v[132:135], v2, s[12:15], s42 offen offset:3072
    buffer_load_dwordx4 v[136:139], v2, s[16:19], s43 offen offset:3072
    buffer_load_dwordx4 v[140:143], v2, s[16:19], s44 offen offset:3072
    s_add_u32 s41, s41, 4096
    s_add_u32 s42, s42, 4096
    s_add_u32 s43, s43, 4096
    s_add_u32 s44, s44, 4096
    buffer_load_dwordx4 v[144:147], v2, s[12:15], s41 offen offset:0
    buffer_load_dwordx4 v[148:151], v2, s[12:15], s42 offen offset:0
    buffer_load_dwordx4 v[152:155], v2, s[16:19], s43 offen offset:0
    buffer_load_dwordx4 v[156:159], v2, s[16:19], s44 offen offset:0
    buffer_load_dwordx4 v[160:163], v2, s[12:15], s41 offen offset:1024
    buffer_load_dwordx4 v[164:167], v2, s[12:15], s42 offen offset:1024
    buffer_load_dwordx4 v[168:171], v2, s[16:19], s43 offen offset:1024
    buffer_load_dwordx4 v[172:175], v2, s[16:19], s44 offen offset:1024
    buffer_load_dwordx4 v[176:179], v2, s[12:15], s41 offen offset:2048
    buffer_load_dwordx4 v[180:183], v2, s[12:15], s42 offen offset:2048
    buffer_load_dwordx4 v[184:187], v2, s[16:19], s43 offen offset:2048
    buffer_load_dwordx4 v[188:191], v2, s[16:19], s44 offen offset:2048
    buffer_load_dwordx4 v[192:195], v2, s[12:15], s41 offen offset:3072
    buffer_load_dwordx4 v[196:199], v2, s[12:15], s42 offen offset:3072
    buffer_load_dwordx4 v[200:203], v2, s[16:19], s43 offen offset:3072
    buffer_load_dwordx4 v[204:207], v2, s[16:19], s44 offen offset:3072
    s_add_u32 s41, s41, 4096
    s_add_u32 s42, s42, 4096
    s_add_u32 s43, s43, 4096
    s_add_u32 s44, s44, 4096
    s_waitcnt vmcnt(29)
    v_mfma_f32_32x32x16_bf16 v[16:31], v[88:91], v[80:83], 0
    s_waitcnt vmcnt(28)
    v_mfma_f32_32x32x16_bf16 v[32:47], v[92:95], v[80:83], 0
    v_mfma_f32_32x32x16_bf16 v[48:63], v[88:91], v[84:87], 0
    v_mfma_f32_32x32x16_bf16 v[64:79], v[92:95], v[84:87], 0
    s_waitcnt vmcnt(25)
    v_mfma_f32_32x32x16_bf16 v[16:31], v[104:107], v[96:99], v[16:31]
    s_waitcnt vmcnt(24)
    v_mfma_f32_32x32x16_bf16 v[32:47], v[108:111], v[96:99], v[32:47]
    v_mfma_f32_32x32x16_bf16 v[48:63], v[104:107], v[100:103], v[48:63]
    v_mfma_f32_32x32x16_bf16 v[64:79], v[108:111], v[100:103], v[64:79]
    s_waitcnt vmcnt(21)
    v_mfma_f32_32x32x16_bf16 v[16:31], v[120:123], v[112:115], v[16:31]
    s_waitcnt vmcnt(20)
    v_mfma_f32_32x32x16_bf16 v[32:47], v[124:127], v[112:115], v[32:47]
    v_mfma_f32_32x32x16_bf16 v[48:63], v[120:123], v[116:119], v[48:63]
    v_mfma_f32_32x32x16_bf16 v[64:79], v[124:127], v[116:119], v[64:79]
    s_waitcnt vmcnt(17)
    v_mfma_f32_32x32x16_bf16 v[16:31], v[136:139], v[128:131], v[16:31]
    s_waitcnt vmcnt(16)
    v_mfma_f32_32x32x16_bf16 v[32:47], v[140:143], v[128:131], v[32:47]
    v_mfma_f32_32x32x16_bf16 v[48:63], v[136:139], v[132:135], v[48:63]
    v_mfma_f32_32x32x16_bf16 v[64:79], v[140:143], v[132:135], v[64:79]
    buffer_load_dwordx4 v[80:83], v2, s[12:15], s41 offen offset:0
    buffer_load_dwordx4 v[84:87], v2, s[12:15], s42 offen offset:0
    buffer_load_dwordx4 v[88:91], v2, s[16:19], s43 offen offset:0
    buffer_load_dwordx4 v[92:95], v2, s[16:19], s44 offen offset:0
    buffer_load_dwordx4 v[96:99], v2, s[12:15], s41 offen offset:1024
    buffer_load_dwordx4 v[100:103], v2, s[12:15], s42 offen offset:1024
    buffer_load_dwordx4 v[104:107], v2, s[16:19], s43 offen offset:1024
    buffer_load_dwordx4 v[108:111], v2, s[16:19], s44 offen offset:1024
    buffer_load_dwordx4 v[112:115], v2, s[12:15], s41 offen offset:2048
    buffer_load_dwordx4 v[116:119], v2, s[12:15], s42 offen offset:2048
    buffer_load_dwordx4 v[120:123], v2, s[16:19], s43 offen offset:2048
    buffer_load_dwordx4 v[124:127], v2, s[16:19], s44 offen offset:2048
    buffer_load_dwordx4 v[128:131], v2, s[12:15], s41 offen offset:3072
    buffer_load_dwordx4 v[132:135], v2, s[12:15], s42 offen offset:3072
    buffer_load_dwordx4 v[136:139], v2, s[16:19], s43 offen offset:3072
    buffer_load_dwordx4 v[140:143], v2, s[16:19], s44 offen offset:3072
    s_add_u32 s41, s41, 4096
    s_add_u32 s42, s42, 4096
    s_add_u32 s43, s43, 4096
    s_add_u32 s44, s44, 4096
    s_waitcnt vmcnt(29)
    v_mfma_f32_32x32x16_bf16 v[16:31], v[152:155], v[144:147], v[16:31]
    s_waitcnt vmcnt(28)
    v_mfma_f32_32x32x16_bf16 v[32:47], v[156:159], v[144:147], v[32:47]
    v_mfma_f32_32x32x16_bf16 v[48:63], v[152:155], v[148:151], v[48:63]
    v_mfma_f32_32x32x16_bf16 v[64:79], v[156:159], v[148:151], v[64:79]
    s_waitcnt vmcnt(25)
    v_mfma_f32_32x32x16_bf16 v[16:31], v[168:171], v[160:163], v[16:31]
    s_waitcnt vmcnt(24)
    v_mfma_f32_32x32x16_bf16 v[32:47], v[172:175], v[160:163], v[32:47]
    v_mfma_f32_32x32x16_bf16 v[48:63], v[168:171], v[164:167], v[48:63]
    v_mfma_f32_32x32x16_bf16 v[64:79], v[172:175], v[164:167], v[64:79]
    s_waitcnt vmcnt(21)
    v_mfma_f32_32x32x16_bf16 v[16:31], v[184:187], v[176:179], v[16:31]
    s_waitcnt vmcnt(20)
    v_mfma_f32_32x32x16_bf16 v[32:47], v[188:191], v[176:179], v[32:47]
    v_mfma_f32_32x32x16_bf16 v[48:63], v[184:187], v[180:183], v[48:63]
    v_mfma_f32_32x32x16_bf16 v[64:79], v[188:191], v[180:183], v[64:79]
    s_waitcnt vmcnt(17)
    v_mfma_f32_32x32x16_bf16 v[16:31], v[200:203], v[192:195], v[16:31]
    s_waitcnt vmcnt(16)
    v_mfma_f32_32x32x16_bf16 v[32:47], v[204:207], v[192:195], v[32:47]
    v_mfma_f32_32x32x16_bf16 v[48:63], v[200:203], v[196:199], v[48:63]
    v_mfma_f32_32x32x16_bf16 v[64:79], v[204:207], v[196:199], v[64:79]
    buffer_load_dwordx4 v[144:147], v2, s[12:15], s41 offen offset:0
    buffer_load_dwordx4 v[148:151], v2, s[12:15], s42 offen offset:0
    buffer_load_dwordx4 v[152:155], v2, s[16:19], s43 offen offset:0
    buffer_load_dwordx4 v[156:159], v2, s[16:19], s44 offen offset:0
    buffer_load_dwordx4 v[160:163], v2, s[12:15], s41 offen offset:1024
    buffer_load_dwordx4 v[164:167], v2, s[12:15], s42 offen offset:1024
    buffer_load_dwordx4 v[168:171], v2, s[16:19], s43 offen offset:1024
    buffer_load_dwordx4 v[172:175], v2, s[16:19], s44 offen offset:1024
    buffer_load_dwordx4 v[176:179], v2, s[12:15], s41 offen offset:2048
    buffer_load_dwordx4 v[180:183], v2, s[12:15], s42 offen offset:2048
    buffer_load_dwordx4 v[184:187], v2, s[16:19], s43 offen offset:2048
    buffer_load_dwordx4 v[188:191], v2, s[16:19], s44 offen offset:2048
    buffer_load_dwordx4 v[192:195], v2, s[12:15], s41 offen offset:3072
    buffer_load_dwordx4 v[196:199], v2, s[12:15], s42 offen offset:3072
    buffer_load_dwordx4 v[200:203], v2, s[16:19], s43 offen offset:3072
    buffer_load_dwordx4 v[204:207], v2, s[16:19], s44 offen offset:3072
    s_add_u32 s41, s41, 4096
    s_add_u32 s42, s42, 4096
    s_add_u32 s43, s43, 4096
    s_add_u32 s44, s44, 4096
    s_waitcnt vmcnt(29)
    v_mfma_f32_32x32x16_bf16 v[16:31], v[88:91], v[80:83], v[16:31]
    s_waitcnt vmcnt(28)
    v_mfma_f32_32x32x16_bf16 v[32:47], v[92:95], v[80:83], v[32:47]
    v_mfma_f32_32x32x16_bf16 v[48:63], v[88:91], v[84:87], v[48:63]
    v_mfma_f32_32x32x16_bf16 v[64:79], v[92:95], v[84:87], v[64:79]
    s_waitcnt vmcnt(25)
    v_mfma_f32_32x32x16_bf16 v[16:31], v[104:107], v[96:99], v[16:31]
    s_waitcnt vmcnt(24)
    v_mfma_f32_32x32x16_bf16 v[32:47], v[108:111], v[96:99], v[32:47]
    v_mfma_f32_32x32x16_bf16 v[48:63], v[104:107], v[100:103], v[48:63]
    v_mfma_f32_32x32x16_bf16 v[64:79], v[108:111], v[100:103], v[64:79]
    s_waitcnt vmcnt(21)
    v_mfma_f32_32x32x16_bf16 v[16:31], v[120:123], v[112:115], v[16:31]
    s_waitcnt vmcnt(20)
    v_mfma_f32_32x32x16_bf16 v[32:47], v[124:127], v[112:115], v[32:47]
    v_mfma_f32_32x32x16_bf16 v[48:63], v[120:123], v[116:119], v[48:63]
    v_mfma_f32_32x32x16_bf16 v[64:79], v[124:127], v[116:119], v[64:79]
    s_waitcnt vmcnt(17)
    v_mfma_f32_32x32x16_bf16 v[16:31], v[136:139], v[128:131], v[16:31]
    s_waitcnt vmcnt(16)
    v_mfma_f32_32x32x16_bf16 v[32:47], v[140:143], v[128:131], v[32:47]
    v_mfma_f32_32x32x16_bf16 v[48:63], v[136:139], v[132:135], v[48:63]
    v_mfma_f32_32x32x16_bf16 v[64:79], v[140:143], v[132:135], v[64:79]
    buffer_load_dwordx4 v[80:83], v2, s[12:15], s41 offen offset:0
    buffer_load_dwordx4 v[84:87], v2, s[12:15], s42 offen offset:0
    buffer_load_dwordx4 v[88:91], v2, s[16:19], s43 offen offset:0
    buffer_load_dwordx4 v[92:95], v2, s[16:19], s44 offen offset:0
    buffer_load_dwordx4 v[96:99], v2, s[12:15], s41 offen offset:1024
    buffer_load_dwordx4 v[100:103], v2, s[12:15], s42 offen offset:1024
    buffer_load_dwordx4 v[104:107], v2, s[16:19], s43 offen offset:1024
    buffer_load_dwordx4 v[108:111], v2, s[16:19], s44 offen offset:1024
    buffer_load_dwordx4 v[112:115], v2, s[12:15], s41 offen offset:2048
    buffer_load_dwordx4 v[116:119], v2, s[12:15], s42 offen offset:2048
    buffer_load_dwordx4 v[120:123], v2, s[16:19], s43 offen offset:2048
    buffer_load_dwordx4 v[124:127], v2, s[16:19], s44 offen offset:2048
    buffer_load_dwordx4 v[128:131], v2, s[12:15], s41 offen offset:3072
    buffer_load_dwordx4 v[132:135], v2, s[12:15], s42 offen offset:3072
    buffer_load_dwordx4 v[136:139], v2, s[16:19], s43 offen offset:3072
    buffer_load_dwordx4 v[140:143], v2, s[16:19], s44 offen offset:3072
    s_add_u32 s41, s41, 4096
    s_add_u32 s42, s42, 4096
    s_add_u32 s43, s43, 4096
    s_add_u32 s44, s44, 4096
    s_waitcnt vmcnt(29)
    v_mfma_f32_32x32x16_bf16 v[16:31], v[152:155], v[144:147], v[16:31]
    s_waitcnt vmcnt(28)
    v_mfma_f32_32x32x16_bf16 v[32:47], v[156:159], v[144:147], v[32:47]
    v_mfma_f32_32x32x16_bf16 v[48:63], v[152:155], v[148:151], v[48:63]
    v_mfma_f32_32x32x16_bf16 v[64:79], v[156:159], v[148:151], v[64:79]
    s_waitcnt vmcnt(25)
    v_mfma_f32_32x32x16_bf16 v[16:31], v[168:171], v[160:163], v[16:31]
    s_waitcnt vmcnt(24)
    v_mfma_f32_32x32x16_bf16 v[32:47], v[172:175], v[160:163], v[32:47]
    v_mfma_f32_32x32x16_bf16 v[48:63], v[168:171], v[164:167], v[48:63]
    v_mfma_f32_32x32x16_bf16 v[64:79], v[172:175], v[164:167], v[64:79]
    s_waitcnt vmcnt(21)
    v_mfma_f32_32x32x16_bf16 v[16:31], v[184:187], v[176:179], v[16:31]
    s_waitcnt vmcnt(20)
    v_mfma_f32_32x32x16_bf16 v[32:47], v[188:191], v[176:179], v[32:47]
    v_mfma_f32_32x32x16_bf16 v[48:63], v[184:187], v[180:183], v[48:63]
    v_mfma_f32_32x32x16_bf16 v[64:79], v[188:191], v[180:183], v[64:79]
    s_waitcnt vmcnt(17)
    v_mfma_f32_32x32x16_bf16 v[16:31], v[200:203], v[192:195], v[16:31]
    s_waitcnt vmcnt(16)
    v_mfma_f32_32x32x16_bf16 v[32:47], v[204:207], v[192:195], v[32:47]
    v_mfma_f32_32x32x16_bf16 v[48:63], v[200:203], v[196:199], v[48:63]
    v_mfma_f32_32x32x16_bf16 v[64:79], v[204:207], v[196:199], v[64:79]
    buffer_load_dwordx4 v[144:147], v2, s[12:15], s41 offen offset:0
    buffer_load_dwordx4 v[148:151], v2, s[12:15], s42 offen offset:0
    buffer_load_dwordx4 v[152:155], v2, s[16:19], s43 offen offset:0
    buffer_load_dwordx4 v[156:159], v2, s[16:19], s44 offen offset:0
    buffer_load_dwordx4 v[160:163], v2, s[12:15], s41 offen offset:1024
    buffer_load_dwordx4 v[164:167], v2, s[12:15], s42 offen offset:1024
    buffer_load_dwordx4 v[168:171], v2, s[16:19], s43 offen offset:1024
    buffer_load_dwordx4 v[172:175], v2, s[16:19], s44 offen offset:1024
    buffer_load_dwordx4 v[176:179], v2, s[12:15], s41 offen offset:2048
    buffer_load_dwordx4 v[180:183], v2, s[12:15], s42 offen offset:2048
    buffer_load_dwordx4 v[184:187], v2, s[16:19], s43 offen offset:2048
    buffer_load_dwordx4 v[188:191], v2, s[16:19], s44 offen offset:2048
    buffer_load_dwordx4 v[192:195], v2, s[12:15], s41 offen offset:3072
    buffer_load_dwordx4 v[196:199], v2, s[12:15], s42 offen offset:3072
    buffer_load_dwordx4 v[200:203], v2, s[16:19], s43 offen offset:3072
    buffer_load_dwordx4 v[204:207], v2, s[16:19], s44 offen offset:3072
    s_add_u32 s41, s41, 4096
    s_add_u32 s42, s42, 4096
    s_add_u32 s43, s43, 4096
    s_add_u32 s44, s44, 4096
    s_waitcnt vmcnt(29)
    v_mfma_f32_32x32x16_bf16 v[16:31], v[88:91], v[80:83], v[16:31]
    s_waitcnt vmcnt(28)
    v_mfma_f32_32x32x16_bf16 v[32:47], v[92:95], v[80:83], v[32:47]
    v_mfma_f32_32x32x16_bf16 v[48:63], v[88:91], v[84:87], v[48:63]
    v_mfma_f32_32x32x16_bf16 v[64:79], v[92:95], v[84:87], v[64:79]
    s_waitcnt vmcnt(25)
    v_mfma_f32_32x32x16_bf16 v[16:31], v[104:107], v[96:99], v[16:31]
    s_waitcnt vmcnt(24)
    v_mfma_f32_32x32x16_bf16 v[32:47], v[108:111], v[96:99], v[32:47]
    v_mfma_f32_32x32x16_bf16 v[48:63], v[104:107], v[100:103], v[48:63]
    v_mfma_f32_32x32x16_bf16 v[64:79], v[108:111], v[100:103], v[64:79]
    s_waitcnt vmcnt(21)
    v_mfma_f32_32x32x16_bf16 v[16:31], v[120:123], v[112:115], v[16:31]
    s_waitcnt vmcnt(20)
    v_mfma_f32_32x32x16_bf16 v[32:47], v[124:127], v[112:115], v[32:47]
    v_mfma_f32_32x32x16_bf16 v[48:63], v[120:123], v[116:119], v[48:63]
    v_mfma_f32_32x32x16_bf16 v[64:79], v[124:127], v[116:119], v[64:79]
    s_waitcnt vmcnt(17)
    v_mfma_f32_32x32x16_bf16 v[16:31], v[136:139], v[128:131], v[16:31]
    s_waitcnt vmcnt(16)
    v_mfma_f32_32x32x16_bf16 v[32:47], v[140:143], v[128:131], v[32:47]
    v_mfma_f32_32x32x16_bf16 v[48:63], v[136:139], v[132:135], v[48:63]
    v_mfma_f32_32x32x16_bf16 v[64:79], v[140:143], v[132:135], v[64:79]
    buffer_load_dwordx4 v[80:83], v2, s[12:15], s41 offen offset:0
    buffer_load_dwordx4 v[84:87], v2, s[12:15], s42 offen offset:0
    buffer_load_dwordx4 v[88:91], v2, s[16:19], s43 offen offset:0
    buffer_load_dwordx4 v[92:95], v2, s[16:19], s44 offen offset:0
    buffer_load_dwordx4 v[96:99], v2, s[12:15], s41 offen offset:1024
    buffer_load_dwordx4 v[100:103], v2, s[12:15], s42 offen offset:1024
    buffer_load_dwordx4 v[104:107], v2, s[16:19], s43 offen offset:1024
    buffer_load_dwordx4 v[108:111], v2, s[16:19], s44 offen offset:1024
    buffer_load_dwordx4 v[112:115], v2, s[12:15], s41 offen offset:2048
    buffer_load_dwordx4 v[116:119], v2, s[12:15], s42 offen offset:2048
    buffer_load_dwordx4 v[120:123], v2, s[16:19], s43 offen offset:2048
    buffer_load_dwordx4 v[124:127], v2, s[16:19], s44 offen offset:2048
    buffer_load_dwordx4 v[128:131], v2, s[12:15], s41 offen offset:3072
    buffer_load_dwordx4 v[132:135], v2, s[12:15], s42 offen offset:3072
    buffer_load_dwordx4 v[136:139], v2, s[16:19], s43 offen offset:3072
    buffer_load_dwordx4 v[140:143], v2, s[16:19], s44 offen offset:3072
    s_add_u32 s41, s41, 4096
    s_add_u32 s42, s42, 4096
    s_add_u32 s43, s43, 4096
    s_add_u32 s44, s44, 4096
    s_waitcnt vmcnt(29)
    v_mfma_f32_32x32x16_bf16 v[16:31], v[152:155], v[144:147], v[16:31]
    s_waitcnt vmcnt(28)
    v_mfma_f32_32x32x16_bf16 v[32:47], v[156:159], v[144:147], v[32:47]
    v_mfma_f32_32x32x16_bf16 v[48:63], v[152:155], v[148:151], v[48:63]
    v_mfma_f32_32x32x16_bf16 v[64:79], v[156:159], v[148:151], v[64:79]
    s_waitcnt vmcnt(25)
    v_mfma_f32_32x32x16_bf16 v[16:31], v[168:171], v[160:163], v[16:31]
    s_waitcnt vmcnt(24)
    v_mfma_f32_32x32x16_bf16 v[32:47], v[172:175], v[160:163], v[32:47]
    v_mfma_f32_32x32x16_bf16 v[48:63], v[168:171], v[164:167], v[48:63]
    v_mfma_f32_32x32x16_bf16 v[64:79], v[172:175], v[164:167], v[64:79]
    s_waitcnt vmcnt(21)
    v_mfma_f32_32x32x16_bf16 v[16:31], v[184:187], v[176:179], v[16:31]
    s_waitcnt vmcnt(20)
    v_mfma_f32_32x32x16_bf16 v[32:47], v[188:191], v[176:179], v[32:47]
    v_mfma_f32_32x32x16_bf16 v[48:63], v[184:187], v[180:183], v[48:63]
    v_mfma_f32_32x32x16_bf16 v[64:79], v[188:191], v[180:183], v[64:79]
    s_waitcnt vmcnt(17)
    v_mfma_f32_32x32x16_bf16 v[16:31], v[200:203], v[192:195], v[16:31]
    s_waitcnt vmcnt(16)
    v_mfma_f32_32x32x16_bf16 v[32:47], v[204:207], v[192:195], v[32:47]
    v_mfma_f32_32x32x16_bf16 v[48:63], v[200:203], v[196:199], v[48:63]
    v_mfma_f32_32x32x16_bf16 v[64:79], v[204:207], v[196:199], v[64:79]
    s_waitcnt vmcnt(13)
    v_mfma_f32_32x32x16_bf16 v[16:31], v[88:91], v[80:83], v[16:31]
    s_waitcnt vmcnt(12)
    v_mfma_f32_32x32x16_bf16 v[32:47], v[92:95], v[80:83], v[32:47]
    v_mfma_f32_32x32x16_bf16 v[48:63], v[88:91], v[84:87], v[48:63]
    v_mfma_f32_32x32x16_bf16 v[64:79], v[92:95], v[84:87], v[64:79]
    s_waitcnt vmcnt(9)
    v_mfma_f32_32x32x16_bf16 v[16:31], v[104:107], v[96:99], v[16:31]
    s_waitcnt vmcnt(8)
    v_mfma_f32_32x32x16_bf16 v[32:47], v[108:111], v[96:99], v[32:47]
    v_mfma_f32_32x32x16_bf16 v[48:63], v[104:107], v[100:103], v[48:63]
    v_mfma_f32_32x32x16_bf16 v[64:79], v[108:111], v[100:103], v[64:79]
    s_waitcnt vmcnt(5)
    v_mfma_f32_32x32x16_bf16 v[16:31], v[120:123], v[112:115], v[16:31]
    s_waitcnt vmcnt(4)
    v_mfma_f32_32x32x16_bf16 v[32:47], v[124:127], v[112:115], v[32:47]
    v_mfma_f32_32x32x16_bf16 v[48:63], v[120:123], v[116:119], v[48:63]
    v_mfma_f32_32x32x16_bf16 v[64:79], v[124:127], v[116:119], v[64:79]
    s_waitcnt vmcnt(1)
    v_mfma_f32_32x32x16_bf16 v[16:31], v[136:139], v[128:131], v[16:31]
    s_waitcnt vmcnt(0)
    v_mfma_f32_32x32x16_bf16 v[32:47], v[140:143], v[128:131], v[32:47]
    v_mfma_f32_32x32x16_bf16 v[48:63], v[136:139], v[132:135], v[48:63]
    v_mfma_f32_32x32x16_bf16 v[64:79], v[140:143], v[132:135], v[64:79]
    s_lshl_b32 s40, s32, 14
    v_add_u32 v5, s40, v2
    s_nop 5
    ds_write_b128 v5, v[16:19] offset:0
    ds_write_b128 v5, v[20:23] offset:1024
    ds_write_b128 v5, v[24:27] offset:2048
    ds_write_b128 v5, v[28:31] offset:3072
    ds_write_b128 v5, v[32:35] offset:4096
    ds_write_b128 v5, v[36:39] offset:5120
    ds_write_b128 v5, v[40:43] offset:6144
    ds_write_b128 v5, v[44:47] offset:7168
    ds_write_b128 v5, v[48:51] offset:8192
    ds_write_b128 v5, v[52:55] offset:9216
    ds_write_b128 v5, v[56:59] offset:10240
    ds_write_b128 v5, v[60:63] offset:11264
    ds_write_b128 v5, v[64:67] offset:12288
    ds_write_b128 v5, v[68:71] offset:13312
    ds_write_b128 v5, v[72:75] offset:14336
    ds_write_b128 v5, v[76:79] offset:15360
    s_waitcnt lgkmcnt(0)
    s_barrier
    s_lshl_b32 s40, s32, 12
    v_add_u32 v5, s40, v2
    ds_read_b128 v[80:83], v5 offset:0
    ds_read_b128 v[84:87], v5 offset:1024
    ds_read_b128 v[88:91], v5 offset:2048
    ds_read_b128 v[92:95], v5 offset:3072
    ds_read_b128 v[96:99], v5 offset:16384
    ds_read_b128 v[100:103], v5 offset:17408
    ds_read_b128 v[104:107], v5 offset:18432
    ds_read_b128 v[108:111], v5 offset:19456
    ds_read_b128 v[112:115], v5 offset:32768
    ds_read_b128 v[116:119], v5 offset:33792
    ds_read_b128 v[120:123], v5 offset:34816
    ds_read_b128 v[124:127], v5 offset:35840
    ds_read_b128 v[128:131], v5 offset:49152
    ds_read_b128 v[132:135], v5 offset:50176
    ds_read_b128 v[136:139], v5 offset:51200
    ds_read_b128 v[140:143], v5 offset:52224
    s_waitcnt lgkmcnt(11)
    v_add_f32 v80, v80, v96
    s_waitcnt lgkmcnt(3)
    v_add_f32 v112, v112, v128
    v_add_f32 v80, v80, v112
    v_add_f32 v81, v81, v97
    v_add_f32 v113, v113, v129
    v_add_f32 v81, v81, v113
    v_add_f32 v82, v82, v98
    v_add_f32 v114, v114, v130
    v_add_f32 v82, v82, v114
    v_add_f32 v83, v83, v99
    v_add_f32 v115, v115, v131
    v_add_f32 v83, v83, v115
    v_add_f32 v84, v84, v100
    s_waitcnt lgkmcnt(2)
    v_add_f32 v116, v116, v132
    v_add_f32 v84, v84, v116
    v_add_f32 v85, v85, v101
    v_add_f32 v117, v117, v133
    v_add_f32 v85, v85, v117
    v_add_f32 v86, v86, v102
    v_add_f32 v118, v118, v134
    v_add_f32 v86, v86, v118
    v_add_f32 v87, v87, v103
    v_add_f32 v119, v119, v135
    v_add_f32 v87, v87, v119
    v_add_f32 v88, v88, v104
    s_waitcnt lgkmcnt(1)
    v_add_f32 v120, v120, v136
    v_add_f32 v88, v88, v120
    v_add_f32 v89, v89, v105
    v_add_f32 v121, v121, v137
    v_add_f32 v89, v89, v121
    v_add_f32 v90, v90, v106
    v_add_f32 v122, v122, v138
    v_add_f32 v90, v90, v122
    v_add_f32 v91, v91, v107
    v_add_f32 v123, v123, v139
    v_add_f32 v91, v91, v123
    v_add_f32 v92, v92, v108
    s_waitcnt lgkmcnt(0)
    v_add_f32 v124, v124, v140
    v_add_f32 v92, v92, v124
    v_add_f32 v93, v93, v109
    v_add_f32 v125, v125, v141
    v_add_f32 v93, v93, v125
    v_add_f32 v94, v94, v110
    v_add_f32 v126, v126, v142
    v_add_f32 v94, v94, v126
    v_add_f32 v95, v95, v111
    v_add_f32 v127, v127, v143
    v_add_f32 v95, v95, v127
    v_mov_b32 v6, 0
    v_mov_b32 v7, 0
    v_mov_b32 v20, 0xffff0000
    v_lshlrev_b32 v16, 16, v8
    v_and_b32 v17, v20, v8
    v_add_f32 v80, v80, v16
    v_add_f32 v81, v81, v17
    v_cvt_pk_bf16_f32 v18, v80, v81
    v_lshlrev_b32 v16, 16, v18
    v_and_b32 v17, v20, v18
    v_add_f32 v6, v6, v16
    v_fma_f32 v7, v16, v16, v7
    v_add_f32 v6, v6, v17
    v_fma_f32 v7, v17, v17, v7
    v_lshlrev_b32 v16, 16, v9
    v_and_b32 v17, v20, v9
    v_add_f32 v82, v82, v16
    v_add_f32 v83, v83, v17
    v_cvt_pk_bf16_f32 v19, v82, v83
    v_lshlrev_b32 v16, 16, v19
    v_and_b32 v17, v20, v19
    v_add_f32 v6, v6, v16
    v_fma_f32 v7, v16, v16, v7
    v_add_f32 v6, v6, v17
    v_fma_f32 v7, v17, v17, v7
    buffer_store_dwordx2 v[18:19], v4, s[24:27], s38 offen offset:0
    v_lshlrev_b32 v16, 16, v10
    v_and_b32 v17, v20, v10
    v_add_f32 v84, v84, v16
    v_add_f32 v85, v85, v17
    v_cvt_pk_bf16_f32 v18, v84, v85
    v_lshlrev_b32 v16, 16, v18
    v_and_b32 v17, v20, v18
    v_add_f32 v6, v6, v16
    v_fma_f32 v7, v16, v16, v7
    v_add_f32 v6, v6, v17
    v_fma_f32 v7, v17, v17, v7
    v_lshlrev_b32 v16, 16, v11
    v_and_b32 v17, v20, v11
    v_add_f32 v86, v86, v16
    v_add_f32 v87, v87, v17
    v_cvt_pk_bf16_f32 v19, v86, v87
    v_lshlrev_b32 v16, 16, v19
    v_and_b32 v17, v20, v19
    v_add_f32 v6, v6, v16
    v_fma_f32 v7, v16, v16, v7
    v_add_f32 v6, v6, v17
    v_fma_f32 v7, v17, v17, v7
    buffer_store_dwordx2 v[18:19], v4, s[24:27], s38 offen offset:16
    v_lshlrev_b32 v16, 16, v12
    v_and_b32 v17, v20, v12
    v_add_f32 v88, v88, v16
    v_add_f32 v89, v89, v17
    v_cvt_pk_bf16_f32 v18, v88, v89
    v_lshlrev_b32 v16, 16, v18
    v_and_b32 v17, v20, v18
    v_add_f32 v6, v6, v16
    v_fma_f32 v7, v16, v16, v7
    v_add_f32 v6, v6, v17
    v_fma_f32 v7, v17, v17, v7
    v_lshlrev_b32 v16, 16, v13
    v_and_b32 v17, v20, v13
    v_add_f32 v90, v90, v16
    v_add_f32 v91, v91, v17
    v_cvt_pk_bf16_f32 v19, v90, v91
    v_lshlrev_b32 v16, 16, v19
    v_and_b32 v17, v20, v19
    v_add_f32 v6, v6, v16
    v_fma_f32 v7, v16, v16, v7
    v_add_f32 v6, v6, v17
    v_fma_f32 v7, v17, v17, v7
    buffer_store_dwordx2 v[18:19], v4, s[24:27], s38 offen offset:32
    v_lshlrev_b32 v16, 16, v14
    v_and_b32 v17, v20, v14
    v_add_f32 v92, v92, v16
    v_add_f32 v93, v93, v17
    v_cvt_pk_bf16_f32 v18, v92, v93
    v_lshlrev_b32 v16, 16, v18
    v_and_b32 v17, v20, v18
    v_add_f32 v6, v6, v16
    v_fma_f32 v7, v16, v16, v7
    v_add_f32 v6, v6, v17
    v_fma_f32 v7, v17, v17, v7
    v_lshlrev_b32 v16, 16, v15
    v_and_b32 v17, v20, v15
    v_add_f32 v94, v94, v16
    v_add_f32 v95, v95, v17
    v_cvt_pk_bf16_f32 v19, v94, v95
    v_lshlrev_b32 v16, 16, v19
    v_and_b32 v17, v20, v19
    v_add_f32 v6, v6, v16
    v_fma_f32 v7, v16, v16, v7
    v_add_f32 v6, v6, v17
    v_fma_f32 v7, v17, v17, v7
    buffer_store_dwordx2 v[18:19], v4, s[24:27], s38 offen offset:48
    v_mov_b32 v16, v6
    v_mov_b32 v17, v7
    s_nop 0
    v_permlane32_swap_b32 v6, v16
    v_permlane32_swap_b32 v7, v17
    v_add_f32 v6, v6, v16
    v_add_f32 v7, v7, v17
    v_mul_u32_u24 v5, 112, v3
    s_lshl_b32 s40, s34, 4
    s_lshl_b32 s41, s36, 3
    s_add_u32 s40, s40, s41
    v_cmp_gt_u32 vcc, 32, v1
    s_and_saveexec_b64 s[44:45], vcc
    buffer_store_dwordx2 v[6:7], v5, s[28:31], s40 offen
    s_endpgm
.section .rodata,"a"
.p2align 6
.amdhsa_kernel k5a_kernel
  .amdhsa_next_free_vgpr 208
  .amdhsa_next_free_sgpr 64
  .amdhsa_accum_offset 208
  .amdhsa_group_segment_fixed_size 0
  .amdhsa_kernarg_size 80
  .amdhsa_user_sgpr_count 2
  .amdhsa_user_sgpr_kernarg_segment_ptr 1
  .amdhsa_system_sgpr_workgroup_id_x 1
.end_amdhsa_kernel
.text
.globl k1b_kernel
.p2align 8
.type k1b_kernel,@function
k1b_kernel:
    s_cmp_ge_u32 s2, 192
    s_cbranch_scc0 k1b_kernel_go1
    s_endpgm
k1b_kernel_go1:
    s_load_dwordx2 s[4:5], s[0:1], 72
    s_waitcnt lgkmcnt(0)
    s_add_u32 s12, s4, 18874368
    s_addc_u32 s13, s5, 0
    s_mov_b32 s14, 1835008
    s_mov_b32 s15, 0x00020000
    s_mov_b32 s16, s4
    s_mov_b32 s17, s5
    s_mov_b32 s18, 1376256
    s_mov_b32 s19, 0x00020000
    s_add_u32 s20, s4, 31981568
    s_addc_u32 s21, s5, 0
    s_mov_b32 s22, 229376
    s_mov_b32 s23, 0x00020000
    s_add_u32 s24, s4, 8126464
    s_addc_u32 s25, s5, 0
    s_mov_b32 s26, 6144
    s_mov_b32 s27, 0x00020000
    v_lshrrev_b32 v1, 6, v0
    s_nop 0
    v_readfirstlane_b32 s32, v1
    s_lshr_b32 s30, s2, 4
    s_and_b32 s31, s2, 15
    s_lshl_b32 s34, s31, 7
    s_lshl_b32 s33, s30, 2
    s_add_u32 s33, s33, s32
    s_mul_i32 s35, s33, 28672
    v_and_b32 v1, 63, v0
    v_lshlrev_b32 v2, 4, v1
    s_add_u32 s36, s35, 0
    buffer_load_dwordx4 v[16:19], v2, s[16:19], s36 offen offset:0
    buffer_load_dwordx4 v[20:23], v2, s[16:19], s36 offen offset:1024
    buffer_load_dwordx4 v[24:27], v2, s[16:19], s36 offen offset:2048
    buffer_load_dwordx4 v[28:31], v2, s[16:19], s36 offen offset:3072
    s_add_u32 s36, s35, 4096
    buffer_load_dwordx4 v[32:35], v2, s[16:19], s36 offen offset:0
    buffer_load_dwordx4 v[36:39], v2, s[16:19], s36 offen offset:1024
    buffer_load_dwordx4 v[40:43], v2, s[16:19], s36 offen offset:2048
    buffer_load_dwordx4 v[44:47], v2, s[16:19], s36 offen offset:3072
    s_add_u32 s36, s35, 8192
    buffer_load_dwordx4 v[48:51], v2, s[16:19], s36 offen offset:0
    buffer_load_dwordx4 v[52:55], v2, s[16:19], s36 offen offset:1024
    buffer_load_dwordx4 v[56:59], v2, s[16:19], s36 offen offset:2048
    buffer_load_dwordx4 v[60:63], v2, s[16:19], s36 offen offset:3072
    s_add_u32 s36, s35, 12288
    buffer_load_dwordx4 v[64:67], v2, s[16:19], s36 offen offset:0
    buffer_load_dwordx4 v[68:71], v2, s[16:19], s36 offen offset:1024
    buffer_load_dwordx4 v[72:75], v2, s[16:19], s36 offen offset:2048
    buffer_load_dwordx4 v[76:79], v2, s[16:19], s36 offen offset:3072
    s_add_u32 s36, s35, 16384
    buffer_load_dwordx4 v[80:83], v2, s[16:19], s36 offen offset:0
    buffer_load_dwordx4 v[84:87], v2, s[16:19], s36 offen offset:1024
    buffer_load_dwordx4 v[88:91], v2, s[16:19], s36 offen offset:2048
    buffer_load_dwordx4 v[92:95], v2, s[16:19], s36 offen offset:3072
    s_add_u32 s36, s35, 20480
    buffer_load_dwordx4 v[96:99], v2, s[16:19], s36 offen offset:0
    buffer_load_dwordx4 v[100:103], v2, s[16:19], s36 offen offset:1024
    buffer_load_dwordx4 v[104:107], v2, s[16:19], s36 offen offset:2048
    buffer_load_dwordx4 v[108:111], v2, s[16:19], s36 offen offset:3072
    s_add_u32 s36, s35, 24576
    buffer_load_dwordx4 v[112:115], v2, s[16:19], s36 offen offset:0
    buffer_load_dwordx4 v[116:119], v2, s[16:19], s36 offen offset:1024
    buffer_load_dwordx4 v[120:123], v2, s[16:19], s36 offen offset:2048
    buffer_load_dwordx4 v[124:127], v2, s[16:19], s36 offen offset:3072
    v_lshlrev_b32 v3, 4, v0
    s_mul_i32 s40, s34, 896
    s_add_u32 s41, s40, 0
    buffer_load_dwordx4 v[128:131], v3, s[12:15], s41 offen
    s_add_u32 s41, s40, 4096
    buffer_load_dwordx4 v[132:135], v3, s[12:15], s41 offen
    s_add_u32 s41, s40, 8192
    buffer_load_dwordx4 v[136:139], v3, s[12:15], s41 offen
    s_add_u32 s41, s40, 12288
    buffer_load_dwordx4 v[140:143], v3, s[12:15], s41 offen
    s_add_u32 s41, s40, 16384
    buffer_load_dwordx4 v[144:147], v3, s[12:15], s41 offen
    s_add_u32 s41, s40, 20480
    buffer_load_dwordx4 v[148:151], v3, s[12:15], s41 offen
    s_add_u32 s41, s40, 24576
    buffer_load_dwordx4 v[152:155], v3, s[12:15], s41 offen
    s_add_u32 s41, s40, 28672
    buffer_load_dwordx4 v[156:159], v3, s[12:15], s41 offen
    s_add_u32 s41, s40, 32768
    buffer_load_dwordx4 v[160:163], v3, s[12:15], s41 offen
    s_add_u32 s41, s40, 36864
    buffer_load_dwordx4 v[164:167], v3, s[12:15], s41 offen
    s_add_u32 s41, s40, 40960
    buffer_load_dwordx4 v[168:171], v3, s[12:15], s41 offen
    s_add_u32 s41, s40, 45056
    buffer_load_dwordx4 v[172:175], v3, s[12:15], s41 offen
    s_add_u32 s41, s40, 49152
    buffer_load_dwordx4 v[176:179], v3, s[12:15], s41 offen
    s_add_u32 s41, s40, 53248
    buffer_load_dwordx4 v[180:183], v3, s[12:15], s41 offen
    s_add_u32 s41, s40, 57344
    buffer_load_dwordx4 v[184:187], v3, s[12:15], s41 offen
    s_add_u32 s41, s40, 61440
    buffer_load_dwordx4 v[188:191], v3, s[12:15], s41 offen
    s_add_u32 s41, s40, 65536
    buffer_load_dwordx4 v[192:195], v3, s[12:15], s41 offen
    s_add_u32 s41, s40, 69632
    buffer_load_dwordx4 v[196:199], v3, s[12:15], s41 offen
    s_add_u32 s41, s40, 73728
    buffer_load_dwordx4 v[200:203], v3, s[12:15], s41 offen
    s_add_u32 s41, s40, 77824
    buffer_load_dwordx4 v[204:207], v3, s[12:15], s41 offen
    s_add_u32 s41, s40, 81920
    buffer_load_dwordx4 v[208:211], v3, s[12:15], s41 offen
    s_add_u32 s41, s40, 86016
    buffer_load_dwordx4 v[212:215], v3, s[12:15], s41 offen
    s_add_u32 s41, s40, 90112
    buffer_load_dwordx4 v[216:219], v3, s[12:15], s41 offen
    s_add_u32 s41, s40, 94208
    buffer_load_dwordx4 v[220:223], v3, s[12:15], s41 offen
    s_add_u32 s41, s40, 98304
    buffer_load_dwordx4 v[224:227], v3, s[12:15], s41 offen
    s_add_u32 s41, s40, 102400
    buffer_load_dwordx4 v[228:231], v3, s[12:15], s41 offen
    s_add_u32 s41, s40, 106496
    buffer_load_dwordx4 v[232:235], v3, s[12:15], s41 offen
    s_add_u32 s41, s40, 110592
    buffer_load_dwordx4 v[236:239], v3, s[12:15], s41 offen
    v_add_u32 v4, 0, v0
    v_mul_u32_u24 v5, 9363, v4
    v_lshrrev_b32 v5, 19, v5
    v_add_lshl_u32 v4, v4, v5, 4
    s_waitcnt vmcnt(27)
    ds_write_b128 v4, v[128:131] offset:1024
    v_add_u32 v4, 256, v0
    v_mul_u32_u24 v5, 9363, v4
    v_lshrrev_b32 v5, 19, v5
    v_add_lshl_u32 v4, v4, v5, 4
    s_waitcnt vmcnt(26)
    ds_write_b128 v4, v[132:135] offset:1024
    v_add_u32 v4, 512, v0
    v_mul_u32_u24 v5, 9363, v4
    v_lshrrev_b32 v5, 19, v5
    v_add_lshl_u32 v4, v4, v5, 4
    s_waitcnt vmcnt(25)
    ds_write_b128 v4, v[136:139] offset:1024
    v_add_u32 v4, 768, v0
    v_mul_u32_u24 v5, 9363, v4
    v_lshrrev_b32 v5, 19, v5
    v_add_lshl_u32 v4, v4, v5, 4
    s_waitcnt vmcnt(24)
    ds_write_b128 v4, v[140:143] offset:1024
    v_add_u32 v4, 1024, v0
    v_mul_u32_u24 v5, 9363, v4
    v_lshrrev_b32 v5, 19, v5
    v_add_lshl_u32 v4, v4, v5, 4
    s_waitcnt vmcnt(23)
    ds_write_b128 v4, v[144:147] offset:1024
    v_add_u32 v4, 1280, v0
    v_mul_u32_u24 v5, 9363, v4
    v_lshrrev_b32 v5, 19, v5
    v_add_lshl_u32 v4, v4, v5, 4
    s_waitcnt vmcnt(22)
    ds_write_b128 v4, v[148:151] offset:1024
    v_add_u32 v4, 1536, v0
    v_mul_u32_u24 v5, 9363, v4
    v_lshrrev_b32 v5, 19, v5
    v_add_lshl_u32 v4, v4, v5, 4
    s_waitcnt vmcnt(21)
    ds_write_b128 v4, v[152:155] offset:1024
    s_waitcnt lgkmcnt(0)
    v_add_u32 v7, s34, v0
    v_and_b32 v7, 2047, v7
    v_mul_u32_u24 v7, 112, v7
    buffer_load_dwordx4 v[128:131], v7, s[20:23], 0 offen offset:0
    buffer_load_dwordx4 v[132:135], v7, s[20:23], 0 offen offset:16
    buffer_load_dwordx4 v[136:139], v7, s[20:23], 0 offen offset:32
    buffer_load_dwordx4 v[140:143], v7, s[20:23], 0 offen offset:48
    buffer_load_dwordx4 v[144:147], v7, s[20:23], 0 offen offset:64
    buffer_load_dwordx4 v[148:151], v7, s[20:23], 0 offen offset:80
    buffer_load_dwordx4 v[152:155], v7, s[20:23], 0 offen offset:96
    v_add_u32 v4, 1792, v0
    v_mul_u32_u24 v5, 9363, v4
    v_lshrrev_b32 v5, 19, v5
    v_add_lshl_u32 v4, v4, v5, 4
    s_waitcnt vmcnt(27)
    ds_write_b128 v4, v[156:159] offset:1024
    v_add_u32 v4, 2048, v0
    v_mul_u32_u24 v5, 9363, v4
    v_lshrrev_b32 v5, 19, v5
    v_add_lshl_u32 v4, v4, v5, 4
    s_waitcnt vmcnt(26)
    ds_write_b128 v4, v[160:163] offset:1024
    v_add_u32 v4, 2304, v0
    v_mul_u32_u24 v5, 9363, v4
    v_lshrrev_b32 v5, 19, v5
    v_add_lshl_u32 v4, v4, v5, 4
    s_waitcnt vmcnt(25)
    ds_write_b128 v4, v[164:167] offset:1024
    v_add_u32 v4, 2560, v0
    v_mul_u32_u24 v5, 9363, v4
    v_lshrrev_b32 v5, 19, v5
    v_add_lshl_u32 v4, v4, v5, 4
    s_waitcnt vmcnt(24)
    ds_write_b128 v4, v[168:171] offset:1024
    v_add_u32 v4, 2816, v0
    v_mul_u32_u24 v5, 9363, v4
    v_lshrrev_b32 v5, 19, v5
    v_add_lshl_u32 v4, v4, v5, 4
    s_waitcnt vmcnt(23)
    ds_write_b128 v4, v[172:175] offset:1024
    v_add_u32 v4, 3072, v0
    v_mul_u32_u24 v5, 9363, v4
    v_lshrrev_b32 v5, 19, v5
    v_add_lshl_u32 v4, v4, v5, 4
    s_waitcnt vmcnt(22)
    ds_write_b128 v4, v[176:179] offset:1024
    v_add_u32 v4, 3328, v0
    v_mul_u32_u24 v5, 9363, v4
    v_lshrrev_b32 v5, 19, v5
    v_add_lshl_u32 v4, v4, v5, 4
    s_waitcnt vmcnt(21)
    ds_write_b128 v4, v[180:183] offset:1024
    v_add_u32 v4, 3584, v0
    v_mul_u32_u24 v5, 9363, v4
    v_lshrrev_b32 v5, 19, v5
    v_add_lshl_u32 v4, v4, v5, 4
    s_waitcnt vmcnt(20)
    ds_write_b128 v4, v[184:187] offset:1024
    v_add_u32 v4, 3840, v0
    v_mul_u32_u24 v5, 9363, v4
    v_lshrrev_b32 v5, 19, v5
    v_add_lshl_u32 v4, v4, v5, 4
    s_waitcnt vmcnt(19)
    ds_write_b128 v4, v[188:191] offset:1024
    v_add_u32 v4, 4096, v0
    v_mul_u32_u24 v5, 9363, v4
    v_lshrrev_b32 v5, 19, v5
    v_add_lshl_u32 v4, v4, v5, 4
    s_waitcnt vmcnt(18)
    ds_write_b128 v4, v[192:195] offset:1024
    v_add_u32 v4, 4352, v0
    v_mul_u32_u24 v5, 9363, v4
    v_lshrrev_b32 v5, 19, v5
    v_add_lshl_u32 v4, v4, v5, 4
    s_waitcnt vmcnt(17)
    ds_write_b128 v4, v[196:199] offset:1024
    v_add_u32 v4, 4608, v0
    v_mul_u32_u24 v5, 9363, v4
    v_lshrrev_b32 v5, 19, v5
    v_add_lshl_u32 v4, v4, v5, 4
    s_waitcnt vmcnt(16)
    ds_write_b128 v4, v[200:203] offset:1024
    v_add_u32 v4, 4864, v0
    v_mul_u32_u24 v5, 9363, v4
    v_lshrrev_b32 v5, 19, v5
    v_add_lshl_u32 v4, v4, v5, 4
    s_waitcnt vmcnt(15)
    ds_write_b128 v4, v[204:207] offset:1024
    v_add_u32 v4, 5120, v0
    v_mul_u32_u24 v5, 9363, v4
    v_lshrrev_b32 v5, 19, v5
    v_add_lshl_u32 v4, v4, v5, 4
    s_waitcnt vmcnt(14)
    ds_write_b128 v4, v[208:211] offset:1024
    v_add_u32 v4, 5376, v0
    v_mul_u32_u24 v5, 9363, v4
    v_lshrrev_b32 v5, 19, v5
    v_add_lshl_u32 v4, v4, v5, 4
    s_waitcnt vmcnt(13)
    ds_write_b128 v4, v[212:215] offset:1024
    v_add_u32 v4, 5632, v0
    v_mul_u32_u24 v5, 9363, v4
    v_lshrrev_b32 v5, 19, v5
    v_add_lshl_u32 v4, v4, v5, 4
    s_waitcnt vmcnt(12)
    ds_write_b128 v4, v[216:219] offset:1024
    v_add_u32 v4, 5888, v0
    v_mul_u32_u24 v5, 9363, v4
    v_lshrrev_b32 v5, 19, v5
    v_add_lshl_u32 v4, v4, v5, 4
    s_waitcnt vmcnt(11)
    ds_write_b128 v4, v[220:223] offset:1024
    v_add_u32 v4, 6144, v0
    v_mul_u32_u24 v5, 9363, v4
    v_lshrrev_b32 v5, 19, v5
    v_add_lshl_u32 v4, v4, v5, 4
    s_waitcnt vmcnt(10)
    ds_write_b128 v4, v[224:227] offset:1024
    v_add_u32 v4, 6400, v0
    v_mul_u32_u24 v5, 9363, v4
    v_lshrrev_b32 v5, 19, v5
    v_add_lshl_u32 v4, v4, v5, 4
    s_waitcnt vmcnt(9)
    ds_write_b128 v4, v[228:231] offset:1024
    v_add_u32 v4, 6656, v0
    v_mul_u32_u24 v5, 9363, v4
    v_lshrrev_b32 v5, 19, v5
    v_add_lshl_u32 v4, v4, v5, 4
    s_waitcnt vmcnt(8)
    ds_write_b128 v4, v[232:235] offset:1024
    v_add_u32 v4, 6912, v0
    v_mul_u32_u24 v5, 9363, v4
    v_lshrrev_b32 v5, 19, v5
    v_add_lshl_u32 v4, v4, v5, 4
    s_waitcnt vmcnt(7)
    ds_write_b128 v4, v[236:239] offset:1024
    v_cmp_gt_u32 vcc, 128, v0
    s_and_saveexec_b64 s[42:43], vcc
    s_cbranch_execz k1b_kernel_st2
    v_mov_b32 v5, 0
    v_mov_b32 v6, 0
    s_waitcnt vmcnt(6)
    v_add_f32 v5, v5, v128
    v_add_f32 v6, v6, v129
    v_add_f32 v5, v5, v130
    v_add_f32 v6, v6, v131
    s_waitcnt vmcnt(5)
    v_add_f32 v5, v5, v132
    v_add_f32 v6, v6, v133
    v_add_f32 v5, v5, v134
    v_add_f32 v6, v6, v135
    s_waitcnt vmcnt(4)
    v_add_f32 v5, v5, v136
    v_add_f32 v6, v6, v137
    v_add_f32 v5, v5, v138
    v_add_f32 v6, v6, v139
    s_waitcnt vmcnt(3)
    v_add_f32 v5, v5, v140
    v_add_f32 v6, v6, v141
    v_add_f32 v5, v5, v142
    v_add_f32 v6, v6, v143
    s_waitcnt vmcnt(2)
    v_add_f32 v5, v5, v144
    v_add_f32 v6, v6, v145
    v_add_f32 v5, v5, v146
    v_add_f32 v6, v6, v147
    s_waitcnt vmcnt(1)
    v_add_f32 v5, v5, v148
    v_add_f32 v6, v6, v149
    v_add_f32 v5, v5, v150
    v_add_f32 v6, v6, v151
    s_waitcnt vmcnt(0)
    v_add_f32 v5, v5, v152
    v_add_f32 v6, v6, v153
    v_add_f32 v5, v5, v154
    v_add_f32 v6, v6, v155
    v_mul_f32 v5, 0.002232142857142857, v5
    v_mul_f32 v6, 0.002232142857142857, v6
    v_fma_f32 v6, -v5, v5, v6
    v_max_f32 v6, 0, v6
    v_add_f32 v6, 1e-05, v6
    v_rsq_f32 v6, v6
    s_nop 0
    v_mul_f32 v5, v5, v6
    v_lshlrev_b32 v4, 2, v0
    ds_write_b32 v4, v6 offset:0
    ds_write_b32 v4, v5 offset:512
k1b_kernel_st2:
    s_waitcnt vmcnt(0)
    s_mov_b64 exec, s[42:43]
    s_waitcnt lgkmcnt(0)
    s_barrier
    v_and_b32 v3, 31, v1
    v_mul_u32_u24 v3, 912, v3
    v_lshrrev_b32 v4, 5, v1
    v_lshl_add_u32 v8, v4, 4, v3
    v_add_u32 v9, 58368, v8
    s_cmp_ge_u32 s30, 8
    s_cbranch_scc1 k1b_kernel_vpath3
    ds_read_b128 v[192:195], v8 offset:1024
    ds_read_b128 v[196:199], v8 offset:30208
    ds_read_b128 v[200:203], v9 offset:1024
    ds_read_b128 v[204:207], v9 offset:30208
    ds_read_b128 v[208:211], v8 offset:1056
    ds_read_b128 v[212:215], v8 offset:30240
    ds_read_b128 v[216:219], v9 offset:1056
    ds_read_b128 v[220:223], v9 offset:30240
    s_waitcnt lgkmcnt(7)
    v_mfma_f32_32x32x16_bf16 v[128:143], v[16:19], v[192:195], 0
    s_waitcnt lgkmcnt(6)
    v_mfma_f32_32x32x16_bf16 v[144:159], v[16:19], v[196:199], 0
    s_waitcnt lgkmcnt(5)
    v_mfma_f32_32x32x16_bf16 v[160:175], v[16:19], v[200:203], 0
    s_waitcnt lgkmcnt(4)
    v_mfma_f32_32x32x16_bf16 v[176:191], v[16:19], v[204:207], 0
    ds_read_b128 v[192:195], v8 offset:1088
    ds_read_b128 v[196:199], v8 offset:30272
    ds_read_b128 v[200:203], v9 offset:1088
    ds_read_b128 v[204:207], v9 offset:30272
    s_waitcnt lgkmcnt(7)
    v_mfma_f32_32x32x16_bf16 v[128:143], v[20:23], v[208:211], v[128:143]
    s_waitcnt lgkmcnt(6)
    v_mfma_f32_32x32x16_bf16 v[144:159], v[20:23], v[212:215], v[144:159]
    s_waitcnt lgkmcnt(5)
    v_mfma_f32_32x32x16_bf16 v[160:175], v[20:23], v[216:219], v[160:175]
    s_waitcnt lgkmcnt(4)
    v_mfma_f32_32x32x16_bf16 v[176:191], v[20:23], v[220:223], v[176:191]
    ds_read_b128 v[208:211], v8 offset:1120
    ds_read_b128 v[212:215], v8 offset:30304
    ds_read_b128 v[216:219], v9 offset:1120
    ds_read_b128 v[220:223], v9 offset:30304
    s_waitcnt lgkmcnt(7)
    v_mfma_f32_32x32x16_bf16 v[128:143], v[24:27], v[192:195], v[128:143]
    s_waitcnt lgkmcnt(6)
    v_mfma_f32_32x32x16_bf16 v[144:159], v[24:27], v[196:199], v[144:159]
    s_waitcnt lgkmcnt(5)
    v_mfma_f32_32x32x16_bf16 v[160:175], v[24:27], v[200:203], v[160:175]
    s_waitcnt lgkmcnt(4)
    v_mfma_f32_32x32x16_bf16 v[176:191], v[24:27], v[204:207], v[176:191]
    ds_read_b128 v[192:195], v8 offset:1152
    ds_read_b128 v[196:199], v8 offset:30336
    ds_read_b128 v[200:203], v9 offset:1152
    ds_read_b128 v[204:207], v9 offset:30336
    s_waitcnt lgkmcnt(7)
    v_mfma_f32_32x32x16_bf16 v[128:143], v[28:31], v[208:211], v[128:143]
    s_waitcnt lgkmcnt(6)
    v_mfma_f32_32x32x16_bf16 v[144:159], v[28:31], v[212:215], v[144:159]
    s_waitcnt lgkmcnt(5)
    v_mfma_f32_32x32x16_bf16 v[160:175], v[28:31], v[216:219], v[160:175]
    s_waitcnt lgkmcnt(4)
    v_mfma_f32_32x32x16_bf16 v[176:191], v[28:31], v[220:223], v[176:191]
    ds_read_b128 v[208:211], v8 offset:1184
    ds_read_b128 v[212:215], v8 offset:30368
    ds_read_b128 v[216:219], v9 offset:1184
    ds_read_b128 v[220:223], v9 offset:30368
    s_waitcnt lgkmcnt(7)
    v_mfma_f32_32x32x16_bf16 v[128:143], v[32:35], v[192:195], v[128:143]
    s_waitcnt lgkmcnt(6)
    v_mfma_f32_32x32x16_bf16 v[144:159], v[32:35], v[196:199], v[144:159]
    s_waitcnt lgkmcnt(5)
    v_mfma_f32_32x32x16_bf16 v[160:175], v[32:35], v[200:203], v[160:175]
    s_waitcnt lgkmcnt(4)
    v_mfma_f32_32x32x16_bf16 v[176:191], v[32:35], v[204:207], v[176:191]
    ds_read_b128 v[192:195], v8 offset:1216
    ds_read_b128 v[196:199], v8 offset:30400
    ds_read_b128 v[200:203], v9 offset:1216
    ds_read_b128 v[204:207], v9 offset:30400
    s_waitcnt lgkmcnt(7)
    v_mfma_f32_32x32x16_bf16 v[128:143], v[36:39], v[208:211], v[128:143]
    s_waitcnt lgkmcnt(6)
    v_mfma_f32_32x32x16_bf16 v[144:159], v[36:39], v[212:215], v[144:159]
    s_waitcnt lgkmcnt(5)
    v_mfma_f32_32x32x16_bf16 v[160:175], v[36:39], v[216:219], v[160:175]
    s_waitcnt lgkmcnt(4)
    v_mfma_f32_32x32x16_bf16 v[176:191], v[36:39], v[220:223], v[176:191]
    ds_read_b128 v[208:211], v8 offset:1248
    ds_read_b128 v[212:215], v8 offset:30432
    ds_read_b128 v[216:219], v9 offset:1248
    ds_read_b128 v[220:223], v9 offset:30432
    s_waitcnt lgkmcnt(7)
    v_mfma_f32_32x32x16_bf16 v[128:143], v[40:43], v[192:195], v[128:143]
    s_waitcnt lgkmcnt(6)
    v_mfma_f32_32x32x16_bf16 v[144:159], v[40:43], v[196:199], v[144:159]
    s_waitcnt lgkmcnt(5)
    v_mfma_f32_32x32x16_bf16 v[160:175], v[40:43], v[200:203], v[160:175]
    s_waitcnt lgkmcnt(4)
    v_mfma_f32_32x32x16_bf16 v[176:191], v[40:43], v[204:207], v[176:191]
    ds_read_b128 v[192:195], v8 offset:1280
    ds_read_b128 v[196:199], v8 offset:30464
    ds_read_b128 v[200:203], v9 offset:1280
    ds_read_b128 v[204:207], v9 offset:30464
    s_waitcnt lgkmcnt(7)
    v_mfma_f32_32x32x16_bf16 v[128:143], v[44:47], v[208:211], v[128:143]
    s_waitcnt lgkmcnt(6)
    v_mfma_f32_32x32x16_bf16 v[144:159], v[44:47], v[212:215], v[144:159]
    s_waitcnt lgkmcnt(5)
    v_mfma_f32_32x32x16_bf16 v[160:175], v[44:47], v[216:219], v[160:175]
    s_waitcnt lgkmcnt(4)
    v_mfma_f32_32x32x16_bf16 v[176:191], v[44:47], v[220:223], v[176:191]
    ds_read_b128 v[208:211], v8 offset:1312
    ds_read_b128 v[212:215], v8 offset:30496
    ds_read_b128 v[216:219], v9 offset:1312
    ds_read_b128 v[220:223], v9 offset:30496
    s_waitcnt lgkmcnt(7)
    v_mfma_f32_32x32x16_bf16 v[128:143], v[48:51], v[192:195], v[128:143]
    s_waitcnt lgkmcnt(6)
    v_mfma_f32_32x32x16_bf16 v[144:159], v[48:51], v[196:199], v[144:159]
    s_waitcnt lgkmcnt(5)
    v_mfma_f32_32x32x16_bf16 v[160:175], v[48:51], v[200:203], v[160:175]
    s_waitcnt lgkmcnt(4)
    v_mfma_f32_32x32x16_bf16 v[176:191], v[48:51], v[204:207], v[176:191]
    ds_read_b128 v[192:195], v8 offset:1344
    ds_read_b128 v[196:199], v8 offset:30528
    ds_read_b128 v[200:203], v9 offset:1344
    ds_read_b128 v[204:207], v9 offset:30528
    s_waitcnt lgkmcnt(7)
    v_mfma_f32_32x32x16_bf16 v[128:143], v[52:55], v[208:211], v[128:143]
    s_waitcnt lgkmcnt(6)
    v_mfma_f32_32x32x16_bf16 v[144:159], v[52:55], v[212:215], v[144:159]
    s_waitcnt lgkmcnt(5)
    v_mfma_f32_32x32x16_bf16 v[160:175], v[52:55], v[216:219], v[160:175]
    s_waitcnt lgkmcnt(4)
    v_mfma_f32_32x32x16_bf16 v[176:191], v[52:55], v[220:223], v[176:191]
    ds_read_b128 v[208:211], v8 offset:1376
    ds_read_b128 v[212:215], v8 offset:30560
    ds_read_b128 v[216:219], v9 offset:1376
    ds_read_b128 v[220:223], v9 offset:30560
    s_waitcnt lgkmcnt(7)
    v_mfma_f32_32x32x16_bf16 v[128:143], v[56:59], v[192:195], v[128:143]
    s_waitcnt lgkmcnt(6)
    v_mfma_f32_32x32x16_bf16 v[144:159], v[56:59], v[196:199], v[144:159]
    s_waitcnt lgkmcnt(5)
    v_mfma_f32_32x32x16_bf16 v[160:175], v[56:59], v[200:203], v[160:175]
    s_waitcnt lgkmcnt(4)
    v_mfma_f32_32x32x16_bf16 v[176:191], v[56:59], v[204:207], v[176:191]
    ds_read_b128 v[192:195], v8 offset:1408
    ds_read_b128 v[196:199], v8 offset:30592
    ds_read_b128 v[200:203], v9 offset:1408
    ds_read_b128 v[204:207], v9 offset:30592
    s_waitcnt lgkmcnt(7)
    v_mfma_f32_32x32x16_bf16 v[128:143], v[60:63], v[208:211], v[128:143]
    s_waitcnt lgkmcnt(6)
    v_mfma_f32_32x32x16_bf16 v[144:159], v[60:63], v[212:215], v[144:159]
    s_waitcnt lgkmcnt(5)
    v_mfma_f32_32x32x16_bf16 v[160:175], v[60:63], v[216:219], v[160:175]
    s_waitcnt lgkmcnt(4)
    v_mfma_f32_32x32x16_bf16 v[176:191], v[60:63], v[220:223], v[176:191]
    ds_read_b128 v[208:211], v8 offset:1440
    ds_read_b128 v[212:215], v8 offset:30624
    ds_read_b128 v[216:219], v9 offset:1440
    ds_read_b128 v[220:223], v9 offset:30624
    s_waitcnt lgkmcnt(7)
    v_mfma_f32_32x32x16_bf16 v[128:143], v[64:67], v[192:195], v[128:143]
    s_waitcnt lgkmcnt(6)
    v_mfma_f32_32x32x16_bf16 v[144:159], v[64:67], v[196:199], v[144:159]
    s_waitcnt lgkmcnt(5)
    v_mfma_f32_32x32x16_bf16 v[160:175], v[64:67], v[200:203], v[160:175]
    s_waitcnt lgkmcnt(4)
    v_mfma_f32_32x32x16_bf16 v[176:191], v[64:67], v[204:207], v[176:191]
    ds_read_b128 v[192:195], v8 offset:1472
    ds_read_b128 v[196:199], v8 offset:30656
    ds_read_b128 v[200:203], v9 offset:1472
    ds_read_b128 v[204:207], v9 offset:30656
    s_waitcnt lgkmcnt(7)
    v_mfma_f32_32x32x16_bf16 v[128:143], v[68:71], v[208:211], v[128:143]
    s_waitcnt lgkmcnt(6)
    v_mfma_f32_32x32x16_bf16 v[144:159], v[68:71], v[212:215], v[144:159]
    s_waitcnt lgkmcnt(5)
    v_mfma_f32_32x32x16_bf16 v[160:175], v[68:71], v[216:219], v[160:175]
    s_waitcnt lgkmcnt(4)
    v_mfma_f32_32x32x16_bf16 v[176:191], v[68:71], v[220:223], v[176:191]
    ds_read_b128 v[208:211], v8 offset:1504
    ds_read_b128 v[212:215], v8 offset:30688
    ds_read_b128 v[216:219], v9 offset:1504
    ds_read_b128 v[220:223], v9 offset:30688
    s_waitcnt lgkmcnt(7)
    v_mfma_f32_32x32x16_bf16 v[128:143], v[72:75], v[192:195], v[128:143]
    s_waitcnt lgkmcnt(6)
    v_mfma_f32_32x32x16_bf16 v[144:159], v[72:75], v[196:199], v[144:159]
    s_waitcnt lgkmcnt(5)
    v_mfma_f32_32x32x16_bf16 v[160:175], v[72:75], v[200:203], v[160:175]
    s_waitcnt lgkmcnt(4)
    v_mfma_f32_32x32x16_bf16 v[176:191], v[72:75], v[204:207], v[176:191]
    ds_read_b128 v[192:195], v8 offset:1536
    ds_read_b128 v[196:199], v8 offset:30720
    ds_read_b128 v[200:203], v9 offset:1536
    ds_read_b128 v[204:207], v9 offset:30720
    s_waitcnt lgkmcnt(7)
    v_mfma_f32_32x32x16_bf16 v[128:143], v[76:79], v[208:211], v[128:143]
    s_waitcnt lgkmcnt(6)
    v_mfma_f32_32x32x16_bf16 v[144:159], v[76:79], v[212:215], v[144:159]
    s_waitcnt lgkmcnt(5)
    v_mfma_f32_32x32x16_bf16 v[160:175], v[76:79], v[216:219], v[160:175]
    s_waitcnt lgkmcnt(4)
    v_mfma_f32_32x32x16_bf16 v[176:191], v[76:79], v[220:223], v[176:191]
    ds_read_b128 v[208:211], v8 offset:1568
    ds_read_b128 v[212:215], v8 offset:30752
    ds_read_b128 v[216:219], v9 offset:1568
    ds_read_b128 v[220:223], v9 offset:30752
    s_waitcnt lgkmcnt(7)
    v_mfma_f32_32x32x16_bf16 v[128:143], v[80:83], v[192:195], v[128:143]
    s_waitcnt lgkmcnt(6)
    v_mfma_f32_32x32x16_bf16 v[144:159], v[80:83], v[196:199], v[144:159]
    s_waitcnt lgkmcnt(5)
    v_mfma_f32_32x32x16_bf16 v[160:175], v[80:83], v[200:203], v[160:175]
    s_waitcnt lgkmcnt(4)
    v_mfma_f32_32x32x16_bf16 v[176:191], v[80:83], v[204:207], v[176:191]
    ds_read_b128 v[192:195], v8 offset:1600
    ds_read_b128 v[196:199], v8 offset:30784
    ds_read_b128 v[200:203], v9 offset:1600
    ds_read_b128 v[204:207], v9 offset:30784
    s_waitcnt lgkmcnt(7)
    v_mfma_f32_32x32x16_bf16 v[128:143], v[84:87], v[208:211], v[128:143]
    s_waitcnt lgkmcnt(6)
    v_mfma_f32_32x32x16_bf16 v[144:159], v[84:87], v[212:215], v[144:159]
    s_waitcnt lgkmcnt(5)
    v_mfma_f32_32x32x16_bf16 v[160:175], v[84:87], v[216:219], v[160:175]
    s_waitcnt lgkmcnt(4)
    v_mfma_f32_32x32x16_bf16 v[176:191], v[84:87], v[220:223], v[176:191]
    ds_read_b128 v[208:211], v8 offset:1632
    ds_read_b128 v[212:215], v8 offset:30816
    ds_read_b128 v[216:219], v9 offset:1632
    ds_read_b128 v[220:223], v9 offset:30816
    s_waitcnt lgkmcnt(7)
    v_mfma_f32_32x32x16_bf16 v[128:143], v[88:91], v[192:195], v[128:143]
    s_waitcnt lgkmcnt(6)
    v_mfma_f32_32x32x16_bf16 v[144:159], v[88:91], v[196:199], v[144:159]
    s_waitcnt lgkmcnt(5)
    v_mfma_f32_32x32x16_bf16 v[160:175], v[88:91], v[200:203], v[160:175]
    s_waitcnt lgkmcnt(4)
    v_mfma_f32_32x32x16_bf16 v[176:191], v[88:91], v[204:207], v[176:191]
    ds_read_b128 v[192:195], v8 offset:1664
    ds_read_b128 v[196:199], v8 offset:30848
    ds_read_b128 v[200:203], v9 offset:1664
    ds_read_b128 v[204:207], v9 offset:30848
    s_waitcnt lgkmcnt(7)
    v_mfma_f32_32x32x16_bf16 v[128:143], v[92:95], v[208:211], v[128:143]
    s_waitcnt lgkmcnt(6)
    v_mfma_f32_32x32x16_bf16 v[144:159], v[92:95], v[212:215], v[144:159]
    s_waitcnt lgkmcnt(5)
    v_mfma_f32_32x32x16_bf16 v[160:175], v[92:95], v[216:219], v[160:175]
    s_waitcnt lgkmcnt(4)
    v_mfma_f32_32x32x16_bf16 v[176:191], v[92:95], v[220:223], v[176:191]
    ds_read_b128 v[208:211], v8 offset:1696
    ds_read_b128 v[212:215], v8 offset:30880
    ds_read_b128 v[216:219], v9 offset:1696
    ds_read_b128 v[220:223], v9 offset:30880
    s_waitcnt lgkmcnt(7)
    v_mfma_f32_32x32x16_bf16 v[128:143], v[96:99], v[192:195], v[128:143]
    s_waitcnt lgkmcnt(6)
    v_mfma_f32_32x32x16_bf16 v[144:159], v[96:99], v[196:199], v[144:159]
    s_waitcnt lgkmcnt(5)
    v_mfma_f32_32x32x16_bf16 v[160:175], v[96:99], v[200:203], v[160:175]
    s_waitcnt lgkmcnt(4)
    v_mfma_f32_32x32x16_bf16 v[176:191], v[96:99], v[204:207], v[176:191]
    ds_read_b128 v[192:195], v8 offset:1728
    ds_read_b128 v[196:199], v8 offset:30912
    ds_read_b128 v[200:203], v9 offset:1728
    ds_read_b128 v[204:207], v9 offset:30912
    s_waitcnt lgkmcnt(7)
    v_mfma_f32_32x32x16_bf16 v[128:143], v[100:103], v[208:211], v[128:143]
    s_waitcnt lgkmcnt(6)
    v_mfma_f32_32x32x16_bf16 v[144:159], v[100:103], v[212:215], v[144:159]
    s_waitcnt lgkmcnt(5)
    v_mfma_f32_32x32x16_bf16 v[160:175], v[100:103], v[216:219], v[160:175]
    s_waitcnt lgkmcnt(4)
    v_mfma_f32_32x32x16_bf16 v[176:191], v[100:103], v[220:223], v[176:191]
    ds_read_b128 v[208:211], v8 offset:1760
    ds_read_b128 v[212:215], v8 offset:30944
    ds_read_b128 v[216:219], v9 offset:1760
    ds_read_b128 v[220:223], v9 offset:30944
    s_waitcnt lgkmcnt(7)
    v_mfma_f32_32x32x16_bf16 v[128:143], v[104:107], v[192:195], v[128:143]
    s_waitcnt lgkmcnt(6)
    v_mfma_f32_32x32x16_bf16 v[144:159], v[104:107], v[196:199], v[144:159]
    s_waitcnt lgkmcnt(5)
    v_mfma_f32_32x32x16_bf16 v[160:175], v[104:107], v[200:203], v[160:175]
    s_waitcnt lgkmcnt(4)
    v_mfma_f32_32x32x16_bf16 v[176:191], v[104:107], v[204:207], v[176:191]
    ds_read_b128 v[192:195], v8 offset:1792
    ds_read_b128 v[196:199], v8 offset:30976
    ds_read_b128 v[200:203], v9 offset:1792
    ds_read_b128 v[204:207], v9 offset:30976
    s_waitcnt lgkmcnt(7)
    v_mfma_f32_32x32x16_bf16 v[128:143], v[108:111], v[208:211], v[128:143]
    s_waitcnt lgkmcnt(6)
    v_mfma_f32_32x32x16_bf16 v[144:159], v[108:111], v[212:215], v[144:159]
    s_waitcnt lgkmcnt(5)
    v_mfma_f32_32x32x16_bf16 v[160:175], v[108:111], v[216:219], v[160:175]
    s_waitcnt lgkmcnt(4)
    v_mfma_f32_32x32x16_bf16 v[176:191], v[108:111], v[220:223], v[176:191]
    ds_read_b128 v[208:211], v8 offset:1824
    ds_read_b128 v[212:215], v8 offset:31008
    ds_read_b128 v[216:219], v9 offset:1824
    ds_read_b128 v[220:223], v9 offset:31008
    s_waitcnt lgkmcnt(7)
    v_mfma_f32_32x32x16_bf16 v[128:143], v[112:115], v[192:195], v[128:143]
    s_waitcnt lgkmcnt(6)
    v_mfma_f32_32x32x16_bf16 v[144:159], v[112:115], v[196:199], v[144:159]
    s_waitcnt lgkmcnt(5)
    v_mfma_f32_32x32x16_bf16 v[160:175], v[112:115], v[200:203], v[160:175]
    s_waitcnt lgkmcnt(4)
    v_mfma_f32_32x32x16_bf16 v[176:191], v[112:115], v[204:207], v[176:191]
    ds_read_b128 v[192:195], v8 offset:1856
    ds_read_b128 v[196:199], v8 offset:31040
    ds_read_b128 v[200:203], v9 offset:1856
    ds_read_b128 v[204:207], v9 offset:31040
    s_waitcnt lgkmcnt(7)
    v_mfma_f32_32x32x16_bf16 v[128:143], v[116:119], v[208:211], v[128:143]
    s_waitcnt lgkmcnt(6)
    v_mfma_f32_32x32x16_bf16 v[144:159], v[116:119], v[212:215], v[144:159]
    s_waitcnt lgkmcnt(5)
    v_mfma_f32_32x32x16_bf16 v[160:175], v[116:119], v[216:219], v[160:175]
    s_waitcnt lgkmcnt(4)
    v_mfma_f32_32x32x16_bf16 v[176:191], v[116:119], v[220:223], v[176:191]
    ds_read_b128 v[208:211], v8 offset:1888
    ds_read_b128 v[212:215], v8 offset:31072
    ds_read_b128 v[216:219], v9 offset:1888
    ds_read_b128 v[220:223], v9 offset:31072
    s_waitcnt lgkmcnt(7)
    v_mfma_f32_32x32x16_bf16 v[128:143], v[120:123], v[192:195], v[128:143]
    s_waitcnt lgkmcnt(6)
    v_mfma_f32_32x32x16_bf16 v[144:159], v[120:123], v[196:199], v[144:159]
    s_waitcnt lgkmcnt(5)
    v_mfma_f32_32x32x16_bf16 v[160:175], v[120:123], v[200:203], v[160:175]
    s_waitcnt lgkmcnt(4)
    v_mfma_f32_32x32x16_bf16 v[176:191], v[120:123], v[204:207], v[176:191]
    s_waitcnt lgkmcnt(3)
    v_mfma_f32_32x32x16_bf16 v[128:143], v[124:127], v[208:211], v[128:143]
    s_waitcnt lgkmcnt(2)
    v_mfma_f32_32x32x16_bf16 v[144:159], v[124:127], v[212:215], v[144:159]
    s_waitcnt lgkmcnt(1)
    v_mfma_f32_32x32x16_bf16 v[160:175], v[124:127], v[216:219], v[160:175]
    s_waitcnt lgkmcnt(0)
    v_mfma_f32_32x32x16_bf16 v[176:191], v[124:127], v[220:223], v[176:191]
    s_cmp_lt_u32 s30, 4
    s_mov_b32 s36, 10485760
    s_cselect_b32 s36, 8388608, s36
    s_add_u32 s28, s4, s36
    s_addc_u32 s29, s5, 0
    s_mov_b32 s30, 2097152
    s_mov_b32 s31, 0x00020000
    s_and_b32 s36, s33, 15
    s_lshl_b32 s36, s36, 17
    v_lshrrev_b32 v4, 5, v1
    v_lshlrev_b32 v4, 4, v4
    s_lshl_b32 s37, s33, 7
    buffer_load_dwordx4 v[16:19], v4, s[24:27], s37 offen offset:0
    buffer_load_dwordx4 v[20:23], v4, s[24:27], s37 offen offset:32
    buffer_load_dwordx4 v[24:27], v4, s[24:27], s37 offen offset:64
    buffer_load_dwordx4 v[28:31], v4, s[24:27], s37 offen offset:96
    v_and_b32 v5, 31, v1
    v_lshlrev_b32 v5, 2, v5
    ds_read_b32 v32, v5 offset:0
    ds_read_b32 v36, v5 offset:512
    ds_read_b32 v33, v5 offset:128
    ds_read_b32 v37, v5 offset:640
    ds_read_b32 v34, v5 offset:256
    ds_read_b32 v38, v5 offset:768
    ds_read_b32 v35, v5 offset:384
    ds_read_b32 v39, v5 offset:896
    s_cmp_lt_u32 s33, 16
    s_cselect_b32 s38, 0x3e8b97f6, 1.0
    s_waitcnt lgkmcnt(7)
    v_mul_f32 v32, s38, v32
    s_waitcnt lgkmcnt(6)
    v_mul_f32 v36, s38, v36
    s_waitcnt lgkmcnt(5)
    v_mul_f32 v33, s38, v33
    s_waitcnt lgkmcnt(4)
    v_mul_f32 v37, s38, v37
    s_waitcnt lgkmcnt(3)
    v_mul_f32 v34, s38, v34
    s_waitcnt lgkmcnt(2)
    v_mul_f32 v38, s38, v38
    s_waitcnt lgkmcnt(1)
    v_mul_f32 v35, s38, v35
    s_waitcnt lgkmcnt(0)
    v_mul_f32 v39, s38, v39
    v_and_b32 v5, 31, v1
    v_lshlrev_b32 v5, 4, v5
    v_lshrrev_b32 v6, 5, v1
    v_lshl_add_u32 v5, v6, 3, v5
    s_lshl_b32 s37, s34, 6
    s_add_u32 s36, s36, s37
    v_mul_f32 v128, v128, v32
    s_waitcnt vmcnt(3)
    v_fma_f32 v128, -v36, v16, v128
    v_mul_f32 v129, v129, v32
    v_fma_f32 v129, -v36, v17, v129
    v_mul_f32 v130, v130, v32
    v_fma_f32 v130, -v36, v18, v130
    v_mul_f32 v131, v131, v32
    v_fma_f32 v131, -v36, v19, v131
    v_cvt_pk_bf16_f32 v40, v128, v129
    v_cvt_pk_bf16_f32 v41, v130, v131
    buffer_store_dwordx2 v[40:41], v5, s[28:31], s36 offen offset:0
    v_mul_f32 v132, v132, v32
    s_waitcnt vmcnt(3)
    v_fma_f32 v132, -v36, v20, v132
    v_mul_f32 v133, v133, v32
    v_fma_f32 v133, -v36, v21, v133
    v_mul_f32 v134, v134, v32
    v_fma_f32 v134, -v36, v22, v134
    v_mul_f32 v135, v135, v32
    v_fma_f32 v135, -v36, v23, v135
    v_cvt_pk_bf16_f32 v40, v132, v133
    v_cvt_pk_bf16_f32 v41, v134, v135
    buffer_store_dwordx2 v[40:41], v5, s[28:31], s36 offen offset:512
    v_mul_f32 v136, v136, v32
    s_waitcnt vmcnt(3)
    v_fma_f32 v136, -v36, v24, v136
    v_mul_f32 v137, v137, v32
    v_fma_f32 v137, -v36, v25, v137
    v_mul_f32 v138, v138, v32
    v_fma_f32 v138, -v36, v26, v138
    v_mul_f32 v139, v139, v32
    v_fma_f32 v139, -v36, v27, v139
    v_cvt_pk_bf16_f32 v40, v136, v137
    v_cvt_pk_bf16_f32 v41, v138, v139
    buffer_store_dwordx2 v[40:41], v5, s[28:31], s36 offen offset:1024
    v_mul_f32 v140, v140, v32
    s_waitcnt vmcnt(3)
    v_fma_f32 v140, -v36, v28, v140
    v_mul_f32 v141, v141, v32
    v_fma_f32 v141, -v36, v29, v141
    v_mul_f32 v142, v142, v32
    v_fma_f32 v142, -v36, v30, v142
    v_mul_f32 v143, v143, v32
    v_fma_f32 v143, -v36, v31, v143
    v_cvt_pk_bf16_f32 v40, v140, v141
    v_cvt_pk_bf16_f32 v41, v142, v143
    buffer_store_dwordx2 v[40:41], v5, s[28:31], s36 offen offset:1536
    s_add_u32 s36, s36, 2048
    v_mul_f32 v144, v144, v33
    v_fma_f32 v144, -v37, v16, v144
    v_mul_f32 v145, v145, v33
    v_fma_f32 v145, -v37, v17, v145
    v_mul_f32 v146, v146, v33
    v_fma_f32 v146, -v37, v18, v146
    v_mul_f32 v147, v147, v33
    v_fma_f32 v147, -v37, v19, v147
    v_cvt_pk_bf16_f32 v40, v144, v145
    v_cvt_pk_bf16_f32 v41, v146, v147
    buffer_store_dwordx2 v[40:41], v5, s[28:31], s36 offen offset:0
    v_mul_f32 v148, v148, v33
    v_fma_f32 v148, -v37, v20, v148
    v_mul_f32 v149, v149, v33
    v_fma_f32 v149, -v37, v21, v149
    v_mul_f32 v150, v150, v33
    v_fma_f32 v150, -v37, v22, v150
    v_mul_f32 v151, v151, v33
    v_fma_f32 v151, -v37, v23, v151
    v_cvt_pk_bf16_f32 v40, v148, v149
    v_cvt_pk_bf16_f32 v41, v150, v151
    buffer_store_dwordx2 v[40:41], v5, s[28:31], s36 offen offset:512
    v_mul_f32 v152, v152, v33
    v_fma_f32 v152, -v37, v24, v152
    v_mul_f32 v153, v153, v33
    v_fma_f32 v153, -v37, v25, v153
    v_mul_f32 v154, v154, v33
    v_fma_f32 v154, -v37, v26, v154
    v_mul_f32 v155, v155, v33
    v_fma_f32 v155, -v37, v27, v155
    v_cvt_pk_bf16_f32 v40, v152, v153
    v_cvt_pk_bf16_f32 v41, v154, v155
    buffer_store_dwordx2 v[40:41], v5, s[28:31], s36 offen offset:1024
    v_mul_f32 v156, v156, v33
    v_fma_f32 v156, -v37, v28, v156
    v_mul_f32 v157, v157, v33
    v_fma_f32 v157, -v37, v29, v157
    v_mul_f32 v158, v158, v33
    v_fma_f32 v158, -v37, v30, v158
    v_mul_f32 v159, v159, v33
    v_fma_f32 v159, -v37, v31, v159
    v_cvt_pk_bf16_f32 v40, v156, v157
    v_cvt_pk_bf16_f32 v41, v158, v159
    buffer_store_dwordx2 v[40:41], v5, s[28:31], s36 offen offset:1536
    s_add_u32 s36, s36, 2048
    v_mul_f32 v160, v160, v34
    v_fma_f32 v160, -v38, v16, v160
    v_mul_f32 v161, v161, v34
    v_fma_f32 v161, -v38, v17, v161
    v_mul_f32 v162, v162, v34
    v_fma_f32 v162, -v38, v18, v162
    v_mul_f32 v163, v163, v34
    v_fma_f32 v163, -v38, v19, v163
    v_cvt_pk_bf16_f32 v40, v160, v161
    v_cvt_pk_bf16_f32 v41, v162, v163
    buffer_store_dwordx2 v[40:41], v5, s[28:31], s36 offen offset:0
    v_mul_f32 v164, v164, v34
    v_fma_f32 v164, -v38, v20, v164
    v_mul_f32 v165, v165, v34
    v_fma_f32 v165, -v38, v21, v165
    v_mul_f32 v166, v166, v34
    v_fma_f32 v166, -v38, v22, v166
    v_mul_f32 v167, v167, v34
    v_fma_f32 v167, -v38, v23, v167
    v_cvt_pk_bf16_f32 v40, v164, v165
    v_cvt_pk_bf16_f32 v41, v166, v167
    buffer_store_dwordx2 v[40:41], v5, s[28:31], s36 offen offset:512
    v_mul_f32 v168, v168, v34
    v_fma_f32 v168, -v38, v24, v168
    v_mul_f32 v169, v169, v34
    v_fma_f32 v169, -v38, v25, v169
    v_mul_f32 v170, v170, v34
    v_fma_f32 v170, -v38, v26, v170
    v_mul_f32 v171, v171, v34
    v_fma_f32 v171, -v38, v27, v171
    v_cvt_pk_bf16_f32 v40, v168, v169
    v_cvt_pk_bf16_f32 v41, v170, v171
    buffer_store_dwordx2 v[40:41], v5, s[28:31], s36 offen offset:1024
    v_mul_f32 v172, v172, v34
    v_fma_f32 v172, -v38, v28, v172
    v_mul_f32 v173, v173, v34
    v_fma_f32 v173, -v38, v29, v173
    v_mul_f32 v174, v174, v34
    v_fma_f32 v174, -v38, v30, v174
    v_mul_f32 v175, v175, v34
    v_fma_f32 v175, -v38, v31, v175
    v_cvt_pk_bf16_f32 v40, v172, v173
    v_cvt_pk_bf16_f32 v41, v174, v175
    buffer_store_dwordx2 v[40:41], v5, s[28:31], s36 offen offset:1536
    s_add_u32 s36, s36, 2048
    v_mul_f32 v176, v176, v35
    v_fma_f32 v176, -v39, v16, v176
    v_mul_f32 v177, v177, v35
    v_fma_f32 v177, -v39, v17, v177
    v_mul_f32 v178, v178, v35
    v_fma_f32 v178, -v39, v18, v178
    v_mul_f32 v179, v179, v35
    v_fma_f32 v179, -v39, v19, v179
    v_cvt_pk_bf16_f32 v40, v176, v177
    v_cvt_pk_bf16_f32 v41, v178, v179
    buffer_store_dwordx2 v[40:41], v5, s[28:31], s36 offen offset:0
    v_mul_f32 v180, v180, v35
    v_fma_f32 v180, -v39, v20, v180
    v_mul_f32 v181, v181, v35
    v_fma_f32 v181, -v39, v21, v181
    v_mul_f32 v182, v182, v35
    v_fma_f32 v182, -v39, v22, v182
    v_mul_f32 v183, v183, v35
    v_fma_f32 v183, -v39, v23, v183
    v_cvt_pk_bf16_f32 v40, v180, v181
    v_cvt_pk_bf16_f32 v41, v182, v183
    buffer_store_dwordx2 v[40:41], v5, s[28:31], s36 offen offset:512
    v_mul_f32 v184, v184, v35
    v_fma_f32 v184, -v39, v24, v184
    v_mul_f32 v185, v185, v35
    v_fma_f32 v185, -v39, v25, v185
    v_mul_f32 v186, v186, v35
    v_fma_f32 v186, -v39, v26, v186
    v_mul_f32 v187, v187, v35
    v_fma_f32 v187, -v39, v27, v187
    v_cvt_pk_bf16_f32 v40, v184, v185
    v_cvt_pk_bf16_f32 v41, v186, v187
    buffer_store_dwordx2 v[40:41], v5, s[28:31], s36 offen offset:1024
    v_mul_f32 v188, v188, v35
    v_fma_f32 v188, -v39, v28, v188
    v_mul_f32 v189, v189, v35
    v_fma_f32 v189, -v39, v29, v189
    v_mul_f32 v190, v190, v35
    v_fma_f32 v190, -v39, v30, v190
    v_mul_f32 v191, v191, v35
    v_fma_f32 v191, -v39, v31, v191
    v_cvt_pk_bf16_f32 v40, v188, v189
    v_cvt_pk_bf16_f32 v41, v190, v191
    buffer_store_dwordx2 v[40:41], v5, s[28:31], s36 offen offset:1536
    s_add_u32 s36, s36, 2048
    s_endpgm
k1b_kernel_vpath3:
    ds_read_b128 v[192:195], v8 offset:1024
    ds_read_b128 v[196:199], v8 offset:30208
    ds_read_b128 v[200:203], v9 offset:1024
    ds_read_b128 v[204:207], v9 offset:30208
    ds_read_b128 v[208:211], v8 offset:1056
    ds_read_b128 v[212:215], v8 offset:30240
    ds_read_b128 v[216:219], v9 offset:1056
    ds_read_b128 v[220:223], v9 offset:30240
    s_waitcnt lgkmcnt(7)
    v_mfma_f32_32x32x16_bf16 v[128:143], v[192:195], v[16:19], 0
    s_waitcnt lgkmcnt(6)
    v_mfma_f32_32x32x16_bf16 v[144:159], v[196:199], v[16:19], 0
    s_waitcnt lgkmcnt(5)
    v_mfma_f32_32x32x16_bf16 v[160:175], v[200:203], v[16:19], 0
    s_waitcnt lgkmcnt(4)
    v_mfma_f32_32x32x16_bf16 v[176:191], v[204:207], v[16:19], 0
    ds_read_b128 v[192:195], v8 offset:1088
    ds_read_b128 v[196:199], v8 offset:30272
    ds_read_b128 v[200:203], v9 offset:1088
    ds_read_b128 v[204:207], v9 offset:30272
    s_waitcnt lgkmcnt(7)
    v_mfma_f32_32x32x16_bf16 v[128:143], v[208:211], v[20:23], v[128:143]
    s_waitcnt lgkmcnt(6)
    v_mfma_f32_32x32x16_bf16 v[144:159], v[212:215], v[20:23], v[144:159]
    s_waitcnt lgkmcnt(5)
    v_mfma_f32_32x32x16_bf16 v[160:175], v[216:219], v[20:23], v[160:175]
    s_waitcnt lgkmcnt(4)
    v_mfma_f32_32x32x16_bf16 v[176:191], v[220:223], v[20:23], v[176:191]
    ds_read_b128 v[208:211], v8 offset:1120
    ds_read_b128 v[212:215], v8 offset:30304
    ds_read_b128 v[216:219], v9 offset:1120
    ds_read_b128 v[220:223], v9 offset:30304
    s_waitcnt lgkmcnt(7)
    v_mfma_f32_32x32x16_bf16 v[128:143], v[192:195], v[24:27], v[128:143]
    s_waitcnt lgkmcnt(6)
    v_mfma_f32_32x32x16_bf16 v[144:159], v[196:199], v[24:27], v[144:159]
    s_waitcnt lgkmcnt(5)
    v_mfma_f32_32x32x16_bf16 v[160:175], v[200:203], v[24:27], v[160:175]
    s_waitcnt lgkmcnt(4)
    v_mfma_f32_32x32x16_bf16 v[176:191], v[204:207], v[24:27], v[176:191]
    ds_read_b128 v[192:195], v8 offset:1152
    ds_read_b128 v[196:199], v8 offset:30336
    ds_read_b128 v[200:203], v9 offset:1152
    ds_read_b128 v[204:207], v9 offset:30336
    s_waitcnt lgkmcnt(7)
    v_mfma_f32_32x32x16_bf16 v[128:143], v[208:211], v[28:31], v[128:143]
    s_waitcnt lgkmcnt(6)
    v_mfma_f32_32x32x16_bf16 v[144:159], v[212:215], v[28:31], v[144:159]
    s_waitcnt lgkmcnt(5)
    v_mfma_f32_32x32x16_bf16 v[160:175], v[216:219], v[28:31], v[160:175]
    s_waitcnt lgkmcnt(4)
    v_mfma_f32_32x32x16_bf16 v[176:191], v[220:223], v[28:31], v[176:191]
    ds_read_b128 v[208:211], v8 offset:1184
    ds_read_b128 v[212:215], v8 offset:30368
    ds_read_b128 v[216:219], v9 offset:1184
    ds_read_b128 v[220:223], v9 offset:30368
    s_waitcnt lgkmcnt(7)
    v_mfma_f32_32x32x16_bf16 v[128:143], v[192:195], v[32:35], v[128:143]
    s_waitcnt lgkmcnt(6)
    v_mfma_f32_32x32x16_bf16 v[144:159], v[196:199], v[32:35], v[144:159]
    s_waitcnt lgkmcnt(5)
    v_mfma_f32_32x32x16_bf16 v[160:175], v[200:203], v[32:35], v[160:175]
    s_waitcnt lgkmcnt(4)
    v_mfma_f32_32x32x16_bf16 v[176:191], v[204:207], v[32:35], v[176:191]
    ds_read_b128 v[192:195], v8 offset:1216
    ds_read_b128 v[196:199], v8 offset:30400
    ds_read_b128 v[200:203], v9 offset:1216
    ds_read_b128 v[204:207], v9 offset:30400
    s_waitcnt lgkmcnt(7)
    v_mfma_f32_32x32x16_bf16 v[128:143], v[208:211], v[36:39], v[128:143]
    s_waitcnt lgkmcnt(6)
    v_mfma_f32_32x32x16_bf16 v[144:159], v[212:215], v[36:39], v[144:159]
    s_waitcnt lgkmcnt(5)
    v_mfma_f32_32x32x16_bf16 v[160:175], v[216:219], v[36:39], v[160:175]
    s_waitcnt lgkmcnt(4)
    v_mfma_f32_32x32x16_bf16 v[176:191], v[220:223], v[36:39], v[176:191]
    ds_read_b128 v[208:211], v8 offset:1248
    ds_read_b128 v[212:215], v8 offset:30432
    ds_read_b128 v[216:219], v9 offset:1248
    ds_read_b128 v[220:223], v9 offset:30432
    s_waitcnt lgkmcnt(7)
    v_mfma_f32_32x32x16_bf16 v[128:143], v[192:195], v[40:43], v[128:143]
    s_waitcnt lgkmcnt(6)
    v_mfma_f32_32x32x16_bf16 v[144:159], v[196:199], v[40:43], v[144:159]
    s_waitcnt lgkmcnt(5)
    v_mfma_f32_32x32x16_bf16 v[160:175], v[200:203], v[40:43], v[160:175]
    s_waitcnt lgkmcnt(4)
    v_mfma_f32_32x32x16_bf16 v[176:191], v[204:207], v[40:43], v[176:191]
    ds_read_b128 v[192:195], v8 offset:1280
    ds_read_b128 v[196:199], v8 offset:30464
    ds_read_b128 v[200:203], v9 offset:1280
    ds_read_b128 v[204:207], v9 offset:30464
    s_waitcnt lgkmcnt(7)
    v_mfma_f32_32x32x16_bf16 v[128:143], v[208:211], v[44:47], v[128:143]
    s_waitcnt lgkmcnt(6)
    v_mfma_f32_32x32x16_bf16 v[144:159], v[212:215], v[44:47], v[144:159]
    s_waitcnt lgkmcnt(5)
    v_mfma_f32_32x32x16_bf16 v[160:175], v[216:219], v[44:47], v[160:175]
    s_waitcnt lgkmcnt(4)
    v_mfma_f32_32x32x16_bf16 v[176:191], v[220:223], v[44:47], v[176:191]
    ds_read_b128 v[208:211], v8 offset:1312
    ds_read_b128 v[212:215], v8 offset:30496
    ds_read_b128 v[216:219], v9 offset:1312
    ds_read_b128 v[220:223], v9 offset:30496
    s_waitcnt lgkmcnt(7)
    v_mfma_f32_32x32x16_bf16 v[128:143], v[192:195], v[48:51], v[128:143]
    s_waitcnt lgkmcnt(6)
    v_mfma_f32_32x32x16_bf16 v[144:159], v[196:199], v[48:51], v[144:159]
    s_waitcnt lgkmcnt(5)
    v_mfma_f32_32x32x16_bf16 v[160:175], v[200:203], v[48:51], v[160:175]
    s_waitcnt lgkmcnt(4)
    v_mfma_f32_32x32x16_bf16 v[176:191], v[204:207], v[48:51], v[176:191]
    ds_read_b128 v[192:195], v8 offset:1344
    ds_read_b128 v[196:199], v8 offset:30528
    ds_read_b128 v[200:203], v9 offset:1344
    ds_read_b128 v[204:207], v9 offset:30528
    s_waitcnt lgkmcnt(7)
    v_mfma_f32_32x32x16_bf16 v[128:143], v[208:211], v[52:55], v[128:143]
    s_waitcnt lgkmcnt(6)
    v_mfma_f32_32x32x16_bf16 v[144:159], v[212:215], v[52:55], v[144:159]
    s_waitcnt lgkmcnt(5)
    v_mfma_f32_32x32x16_bf16 v[160:175], v[216:219], v[52:55], v[160:175]
    s_waitcnt lgkmcnt(4)
    v_mfma_f32_32x32x16_bf16 v[176:191], v[220:223], v[52:55], v[176:191]
    ds_read_b128 v[208:211], v8 offset:1376
    ds_read_b128 v[212:215], v8 offset:30560
    ds_read_b128 v[216:219], v9 offset:1376
    ds_read_b128 v[220:223], v9 offset:30560
    s_waitcnt lgkmcnt(7)
    v_mfma_f32_32x32x16_bf16 v[128:143], v[192:195], v[56:59], v[128:143]
    s_waitcnt lgkmcnt(6)
    v_mfma_f32_32x32x16_bf16 v[144:159], v[196:199], v[56:59], v[144:159]
    s_waitcnt lgkmcnt(5)
    v_mfma_f32_32x32x16_bf16 v[160:175], v[200:203], v[56:59], v[160:175]
    s_waitcnt lgkmcnt(4)
    v_mfma_f32_32x32x16_bf16 v[176:191], v[204:207], v[56:59], v[176:191]
    ds_read_b128 v[192:195], v8 offset:1408
    ds_read_b128 v[196:199], v8 offset:30592
    ds_read_b128 v[200:203], v9 offset:1408
    ds_read_b128 v[204:207], v9 offset:30592
    s_waitcnt lgkmcnt(7)
    v_mfma_f32_32x32x16_bf16 v[128:143], v[208:211], v[60:63], v[128:143]
    s_waitcnt lgkmcnt(6)
    v_mfma_f32_32x32x16_bf16 v[144:159], v[212:215], v[60:63], v[144:159]
    s_waitcnt lgkmcnt(5)
    v_mfma_f32_32x32x16_bf16 v[160:175], v[216:219], v[60:63], v[160:175]
    s_waitcnt lgkmcnt(4)
    v_mfma_f32_32x32x16_bf16 v[176:191], v[220:223], v[60:63], v[176:191]
    ds_read_b128 v[208:211], v8 offset:1440
    ds_read_b128 v[212:215], v8 offset:30624
    ds_read_b128 v[216:219], v9 offset:1440
    ds_read_b128 v[220:223], v9 offset:30624
    s_waitcnt lgkmcnt(7)
    v_mfma_f32_32x32x16_bf16 v[128:143], v[192:195], v[64:67], v[128:143]
    s_waitcnt lgkmcnt(6)
    v_mfma_f32_32x32x16_bf16 v[144:159], v[196:199], v[64:67], v[144:159]
    s_waitcnt lgkmcnt(5)
    v_mfma_f32_32x32x16_bf16 v[160:175], v[200:203], v[64:67], v[160:175]
    s_waitcnt lgkmcnt(4)
    v_mfma_f32_32x32x16_bf16 v[176:191], v[204:207], v[64:67], v[176:191]
    ds_read_b128 v[192:195], v8 offset:1472
    ds_read_b128 v[196:199], v8 offset:30656
    ds_read_b128 v[200:203], v9 offset:1472
    ds_read_b128 v[204:207], v9 offset:30656
    s_waitcnt lgkmcnt(7)
    v_mfma_f32_32x32x16_bf16 v[128:143], v[208:211], v[68:71], v[128:143]
    s_waitcnt lgkmcnt(6)
    v_mfma_f32_32x32x16_bf16 v[144:159], v[212:215], v[68:71], v[144:159]
    s_waitcnt lgkmcnt(5)
    v_mfma_f32_32x32x16_bf16 v[160:175], v[216:219], v[68:71], v[160:175]
    s_waitcnt lgkmcnt(4)
    v_mfma_f32_32x32x16_bf16 v[176:191], v[220:223], v[68:71], v[176:191]
    ds_read_b128 v[208:211], v8 offset:1504
    ds_read_b128 v[212:215], v8 offset:30688
    ds_read_b128 v[216:219], v9 offset:1504
    ds_read_b128 v[220:223], v9 offset:30688
    s_waitcnt lgkmcnt(7)
    v_mfma_f32_32x32x16_bf16 v[128:143], v[192:195], v[72:75], v[128:143]
    s_waitcnt lgkmcnt(6)
    v_mfma_f32_32x32x16_bf16 v[144:159], v[196:199], v[72:75], v[144:159]
    s_waitcnt lgkmcnt(5)
    v_mfma_f32_32x32x16_bf16 v[160:175], v[200:203], v[72:75], v[160:175]
    s_waitcnt lgkmcnt(4)
    v_mfma_f32_32x32x16_bf16 v[176:191], v[204:207], v[72:75], v[176:191]
    ds_read_b128 v[192:195], v8 offset:1536
    ds_read_b128 v[196:199], v8 offset:30720
    ds_read_b128 v[200:203], v9 offset:1536
    ds_read_b128 v[204:207], v9 offset:30720
    s_waitcnt lgkmcnt(7)
    v_mfma_f32_32x32x16_bf16 v[128:143], v[208:211], v[76:79], v[128:143]
    s_waitcnt lgkmcnt(6)
    v_mfma_f32_32x32x16_bf16 v[144:159], v[212:215], v[76:79], v[144:159]
    s_waitcnt lgkmcnt(5)
    v_mfma_f32_32x32x16_bf16 v[160:175], v[216:219], v[76:79], v[160:175]
    s_waitcnt lgkmcnt(4)
    v_mfma_f32_32x32x16_bf16 v[176:191], v[220:223], v[76:79], v[176:191]
    ds_read_b128 v[208:211], v8 offset:1568
    ds_read_b128 v[212:215], v8 offset:30752
    ds_read_b128 v[216:219], v9 offset:1568
    ds_read_b128 v[220:223], v9 offset:30752
    s_waitcnt lgkmcnt(7)
    v_mfma_f32_32x32x16_bf16 v[128:143], v[192:195], v[80:83], v[128:143]
    s_waitcnt lgkmcnt(6)
    v_mfma_f32_32x32x16_bf16 v[144:159], v[196:199], v[80:83], v[144:159]
    s_waitcnt lgkmcnt(5)
    v_mfma_f32_32x32x16_bf16 v[160:175], v[200:203], v[80:83], v[160:175]
    s_waitcnt lgkmcnt(4)
    v_mfma_f32_32x32x16_bf16 v[176:191], v[204:207], v[80:83], v[176:191]
    ds_read_b128 v[192:195], v8 offset:1600
    ds_read_b128 v[196:199], v8 offset:30784
    ds_read_b128 v[200:203], v9 offset:1600
    ds_read_b128 v[204:207], v9 offset:30784
    s_waitcnt lgkmcnt(7)
    v_mfma_f32_32x32x16_bf16 v[128:143], v[208:211], v[84:87], v[128:143]
    s_waitcnt lgkmcnt(6)
    v_mfma_f32_32x32x16_bf16 v[144:159], v[212:215], v[84:87], v[144:159]
    s_waitcnt lgkmcnt(5)
    v_mfma_f32_32x32x16_bf16 v[160:175], v[216:219], v[84:87], v[160:175]
    s_waitcnt lgkmcnt(4)
    v_mfma_f32_32x32x16_bf16 v[176:191], v[220:223], v[84:87], v[176:191]
    ds_read_b128 v[208:211], v8 offset:1632
    ds_read_b128 v[212:215], v8 offset:30816
    ds_read_b128 v[216:219], v9 offset:1632
    ds_read_b128 v[220:223], v9 offset:30816
    s_waitcnt lgkmcnt(7)
    v_mfma_f32_32x32x16_bf16 v[128:143], v[192:195], v[88:91], v[128:143]
    s_waitcnt lgkmcnt(6)
    v_mfma_f32_32x32x16_bf16 v[144:159], v[196:199], v[88:91], v[144:159]
    s_waitcnt lgkmcnt(5)
    v_mfma_f32_32x32x16_bf16 v[160:175], v[200:203], v[88:91], v[160:175]
    s_waitcnt lgkmcnt(4)
    v_mfma_f32_32x32x16_bf16 v[176:191], v[204:207], v[88:91], v[176:191]
    ds_read_b128 v[192:195], v8 offset:1664
    ds_read_b128 v[196:199], v8 offset:30848
    ds_read_b128 v[200:203], v9 offset:1664
    ds_read_b128 v[204:207], v9 offset:30848
    s_waitcnt lgkmcnt(7)
    v_mfma_f32_32x32x16_bf16 v[128:143], v[208:211], v[92:95], v[128:143]
    s_waitcnt lgkmcnt(6)
    v_mfma_f32_32x32x16_bf16 v[144:159], v[212:215], v[92:95], v[144:159]
    s_waitcnt lgkmcnt(5)
    v_mfma_f32_32x32x16_bf16 v[160:175], v[216:219], v[92:95], v[160:175]
    s_waitcnt lgkmcnt(4)
    v_mfma_f32_32x32x16_bf16 v[176:191], v[220:223], v[92:95], v[176:191]
    ds_read_b128 v[208:211], v8 offset:1696
    ds_read_b128 v[212:215], v8 offset:30880
    ds_read_b128 v[216:219], v9 offset:1696
    ds_read_b128 v[220:223], v9 offset:30880
    s_waitcnt lgkmcnt(7)
    v_mfma_f32_32x32x16_bf16 v[128:143], v[192:195], v[96:99], v[128:143]
    s_waitcnt lgkmcnt(6)
    v_mfma_f32_32x32x16_bf16 v[144:159], v[196:199], v[96:99], v[144:159]
    s_waitcnt lgkmcnt(5)
    v_mfma_f32_32x32x16_bf16 v[160:175], v[200:203], v[96:99], v[160:175]
    s_waitcnt lgkmcnt(4)
    v_mfma_f32_32x32x16_bf16 v[176:191], v[204:207], v[96:99], v[176:191]
    ds_read_b128 v[192:195], v8 offset:1728
    ds_read_b128 v[196:199], v8 offset:30912
    ds_read_b128 v[200:203], v9 offset:1728
    ds_read_b128 v[204:207], v9 offset:30912
    s_waitcnt lgkmcnt(7)
    v_mfma_f32_32x32x16_bf16 v[128:143], v[208:211], v[100:103], v[128:143]
    s_waitcnt lgkmcnt(6)
    v_mfma_f32_32x32x16_bf16 v[144:159], v[212:215], v[100:103], v[144:159]
    s_waitcnt lgkmcnt(5)
    v_mfma_f32_32x32x16_bf16 v[160:175], v[216:219], v[100:103], v[160:175]
    s_waitcnt lgkmcnt(4)
    v_mfma_f32_32x32x16_bf16 v[176:191], v[220:223], v[100:103], v[176:191]
    ds_read_b128 v[208:211], v8 offset:1760
    ds_read_b128 v[212:215], v8 offset:30944
    ds_read_b128 v[216:219], v9 offset:1760
    ds_read_b128 v[220:223], v9 offset:30944
    s_waitcnt lgkmcnt(7)
    v_mfma_f32_32x32x16_bf16 v[128:143], v[192:195], v[104:107], v[128:143]
    s_waitcnt lgkmcnt(6)
    v_mfma_f32_32x32x16_bf16 v[144:159], v[196:199], v[104:107], v[144:159]
    s_waitcnt lgkmcnt(5)
    v_mfma_f32_32x32x16_bf16 v[160:175], v[200:203], v[104:107], v[160:175]
    s_waitcnt lgkmcnt(4)
    v_mfma_f32_32x32x16_bf16 v[176:191], v[204:207], v[104:107], v[176:191]
    ds_read_b128 v[192:195], v8 offset:1792
    ds_read_b128 v[196:199], v8 offset:30976
    ds_read_b128 v[200:203], v9 offset:1792
    ds_read_b128 v[204:207], v9 offset:30976
    s_waitcnt lgkmcnt(7)
    v_mfma_f32_32x32x16_bf16 v[128:143], v[208:211], v[108:111], v[128:143]
    s_waitcnt lgkmcnt(6)
    v_mfma_f32_32x32x16_bf16 v[144:159], v[212:215], v[108:111], v[144:159]
    s_waitcnt lgkmcnt(5)
    v_mfma_f32_32x32x16_bf16 v[160:175], v[216:219], v[108:111], v[160:175]
    s_waitcnt lgkmcnt(4)
    v_mfma_f32_32x32x16_bf16 v[176:191], v[220:223], v[108:111], v[176:191]
    ds_read_b128 v[208:211], v8 offset:1824
    ds_read_b128 v[212:215], v8 offset:31008
    ds_read_b128 v[216:219], v9 offset:1824
    ds_read_b128 v[220:223], v9 offset:31008
    s_waitcnt lgkmcnt(7)
    v_mfma_f32_32x32x16_bf16 v[128:143], v[192:195], v[112:115], v[128:143]
    s_waitcnt lgkmcnt(6)
    v_mfma_f32_32x32x16_bf16 v[144:159], v[196:199], v[112:115], v[144:159]
    s_waitcnt lgkmcnt(5)
    v_mfma_f32_32x32x16_bf16 v[160:175], v[200:203], v[112:115], v[160:175]
    s_waitcnt lgkmcnt(4)
    v_mfma_f32_32x32x16_bf16 v[176:191], v[204:207], v[112:115], v[176:191]
    ds_read_b128 v[192:195], v8 offset:1856
    ds_read_b128 v[196:199], v8 offset:31040
    ds_read_b128 v[200:203], v9 offset:1856
    ds_read_b128 v[204:207], v9 offset:31040
    s_waitcnt lgkmcnt(7)
    v_mfma_f32_32x32x16_bf16 v[128:143], v[208:211], v[116:119], v[128:143]
    s_waitcnt lgkmcnt(6)
    v_mfma_f32_32x32x16_bf16 v[144:159], v[212:215], v[116:119], v[144:159]
    s_waitcnt lgkmcnt(5)
    v_mfma_f32_32x32x16_bf16 v[160:175], v[216:219], v[116:119], v[160:175]
    s_waitcnt lgkmcnt(4)
    v_mfma_f32_32x32x16_bf16 v[176:191], v[220:223], v[116:119], v[176:191]
    ds_read_b128 v[208:211], v8 offset:1888
    ds_read_b128 v[212:215], v8 offset:31072
    ds_read_b128 v[216:219], v9 offset:1888
    ds_read_b128 v[220:223], v9 offset:31072
    s_waitcnt lgkmcnt(7)
    v_mfma_f32_32x32x16_bf16 v[128:143], v[192:195], v[120:123], v[128:143]
    s_waitcnt lgkmcnt(6)
    v_mfma_f32_32x32x16_bf16 v[144:159], v[196:199], v[120:123], v[144:159]
    s_waitcnt lgkmcnt(5)
    v_mfma_f32_32x32x16_bf16 v[160:175], v[200:203], v[120:123], v[160:175]
    s_waitcnt lgkmcnt(4)
    v_mfma_f32_32x32x16_bf16 v[176:191], v[204:207], v[120:123], v[176:191]
    s_waitcnt lgkmcnt(3)
    v_mfma_f32_32x32x16_bf16 v[128:143], v[208:211], v[124:127], v[128:143]
    s_waitcnt lgkmcnt(2)
    v_mfma_f32_32x32x16_bf16 v[144:159], v[212:215], v[124:127], v[144:159]
    s_waitcnt lgkmcnt(1)
    v_mfma_f32_32x32x16_bf16 v[160:175], v[216:219], v[124:127], v[160:175]
    s_waitcnt lgkmcnt(0)
    v_mfma_f32_32x32x16_bf16 v[176:191], v[220:223], v[124:127], v[176:191]
    s_add_u32 s28, s4, 12582912
    s_addc_u32 s29, s5, 0
    s_mov_b32 s30, 2097152
    s_mov_b32 s31, 0x00020000
    s_sub_u32 s36, s33, 32
    s_lshl_b32 s36, s36, 17
    s_lshl_b32 s37, s34, 6
    s_add_u32 s36, s36, s37
    v_and_b32 v4, 31, v1
    v_lshlrev_b32 v4, 2, v4
    s_lshl_b32 s37, s33, 7
    buffer_load_dword v16, v4, s[24:27], s37 offen
    v_and_b32 v4, 31, v1
    v_cmp_eq_u32 vcc, 28, v4
    v_mov_b32 v17, 0x3f803f80
    v_lshrrev_b32 v5, 5, v1
    v_lshlrev_b32 v5, 4, v5
    ds_read_b128 v[20:23], v5 offset:0
    ds_read_b128 v[24:27], v5 offset:512
    s_waitcnt lgkmcnt(1)
    v_mul_f32 v128, v128, v20
    s_waitcnt vmcnt(0) lgkmcnt(0)
    v_fma_f32 v128, -v24, v16, v128
    v_mul_f32 v129, v129, v21
    v_fma_f32 v129, -v25, v16, v129
    v_mul_f32 v130, v130, v22
    v_fma_f32 v130, -v26, v16, v130
    v_mul_f32 v131, v131, v23
    v_fma_f32 v131, -v27, v16, v131
    v_cvt_pk_bf16_f32 v40, v128, v129
    v_cvt_pk_bf16_f32 v41, v130, v131
    ds_read_b128 v[28:31], v5 offset:32
    ds_read_b128 v[32:35], v5 offset:544
    s_waitcnt lgkmcnt(1)
    v_mul_f32 v132, v132, v28
    s_waitcnt lgkmcnt(0)
    v_fma_f32 v132, -v32, v16, v132
    v_mul_f32 v133, v133, v29
    v_fma_f32 v133, -v33, v16, v133
    v_mul_f32 v134, v134, v30
    v_fma_f32 v134, -v34, v16, v134
    v_mul_f32 v135, v135, v31
    v_fma_f32 v135, -v35, v16, v135
    v_cvt_pk_bf16_f32 v42, v132, v133
    v_cvt_pk_bf16_f32 v43, v134, v135
    v_cndmask_b32 v40, v40, v17, vcc
    v_cndmask_b32 v41, v41, v17, vcc
    v_cndmask_b32 v42, v42, v17, vcc
    v_cndmask_b32 v43, v43, v17, vcc
    buffer_store_dwordx4 v[40:43], v2, s[28:31], s36 offen offset:0
    ds_read_b128 v[20:23], v5 offset:64
    ds_read_b128 v[24:27], v5 offset:576
    s_waitcnt lgkmcnt(1)
    v_mul_f32 v136, v136, v20
    s_waitcnt lgkmcnt(0)
    v_fma_f32 v136, -v24, v16, v136
    v_mul_f32 v137, v137, v21
    v_fma_f32 v137, -v25, v16, v137
    v_mul_f32 v138, v138, v22
    v_fma_f32 v138, -v26, v16, v138
    v_mul_f32 v139, v139, v23
    v_fma_f32 v139, -v27, v16, v139
    v_cvt_pk_bf16_f32 v40, v136, v137
    v_cvt_pk_bf16_f32 v41, v138, v139
    ds_read_b128 v[28:31], v5 offset:96
    ds_read_b128 v[32:35], v5 offset:608
    s_waitcnt lgkmcnt(1)
    v_mul_f32 v140, v140, v28
    s_waitcnt lgkmcnt(0)
    v_fma_f32 v140, -v32, v16, v140
    v_mul_f32 v141, v141, v29
    v_fma_f32 v141, -v33, v16, v141
    v_mul_f32 v142, v142, v30
    v_fma_f32 v142, -v34, v16, v142
    v_mul_f32 v143, v143, v31
    v_fma_f32 v143, -v35, v16, v143
    v_cvt_pk_bf16_f32 v42, v140, v141
    v_cvt_pk_bf16_f32 v43, v142, v143
    v_cndmask_b32 v40, v40, v17, vcc
    v_cndmask_b32 v41, v41, v17, vcc
    v_cndmask_b32 v42, v42, v17, vcc
    v_cndmask_b32 v43, v43, v17, vcc
    buffer_store_dwordx4 v[40:43], v2, s[28:31], s36 offen offset:1024
    ds_read_b128 v[20:23], v5 offset:128
    ds_read_b128 v[24:27], v5 offset:640
    s_waitcnt lgkmcnt(1)
    v_mul_f32 v144, v144, v20
    s_waitcnt lgkmcnt(0)
    v_fma_f32 v144, -v24, v16, v144
    v_mul_f32 v145, v145, v21
    v_fma_f32 v145, -v25, v16, v145
    v_mul_f32 v146, v146, v22
    v_fma_f32 v146, -v26, v16, v146
    v_mul_f32 v147, v147, v23
    v_fma_f32 v147, -v27, v16, v147
    v_cvt_pk_bf16_f32 v40, v144, v145
    v_cvt_pk_bf16_f32 v41, v146, v147
    ds_read_b128 v[28:31], v5 offset:160
    ds_read_b128 v[32:35], v5 offset:672
    s_waitcnt lgkmcnt(1)
    v_mul_f32 v148, v148, v28
    s_waitcnt lgkmcnt(0)
    v_fma_f32 v148, -v32, v16, v148
    v_mul_f32 v149, v149, v29
    v_fma_f32 v149, -v33, v16, v149
    v_mul_f32 v150, v150, v30
    v_fma_f32 v150, -v34, v16, v150
    v_mul_f32 v151, v151, v31
    v_fma_f32 v151, -v35, v16, v151
    v_cvt_pk_bf16_f32 v42, v148, v149
    v_cvt_pk_bf16_f32 v43, v150, v151
    v_cndmask_b32 v40, v40, v17, vcc
    v_cndmask_b32 v41, v41, v17, vcc
    v_cndmask_b32 v42, v42, v17, vcc
    v_cndmask_b32 v43, v43, v17, vcc
    buffer_store_dwordx4 v[40:43], v2, s[28:31], s36 offen offset:2048
    ds_read_b128 v[20:23], v5 offset:192
    ds_read_b128 v[24:27], v5 offset:704
    s_waitcnt lgkmcnt(1)
    v_mul_f32 v152, v152, v20
    s_waitcnt lgkmcnt(0)
    v_fma_f32 v152, -v24, v16, v152
    v_mul_f32 v153, v153, v21
    v_fma_f32 v153, -v25, v16, v153
    v_mul_f32 v154, v154, v22
    v_fma_f32 v154, -v26, v16, v154
    v_mul_f32 v155, v155, v23
    v_fma_f32 v155, -v27, v16, v155
    v_cvt_pk_bf16_f32 v40, v152, v153
    v_cvt_pk_bf16_f32 v41, v154, v155
    ds_read_b128 v[28:31], v5 offset:224
    ds_read_b128 v[32:35], v5 offset:736
    s_waitcnt lgkmcnt(1)
    v_mul_f32 v156, v156, v28
    s_waitcnt lgkmcnt(0)
    v_fma_f32 v156, -v32, v16, v156
    v_mul_f32 v157, v157, v29
    v_fma_f32 v157, -v33, v16, v157
    v_mul_f32 v158, v158, v30
    v_fma_f32 v158, -v34, v16, v158
    v_mul_f32 v159, v159, v31
    v_fma_f32 v159, -v35, v16, v159
    v_cvt_pk_bf16_f32 v42, v156, v157
    v_cvt_pk_bf16_f32 v43, v158, v159
    v_cndmask_b32 v40, v40, v17, vcc
    v_cndmask_b32 v41, v41, v17, vcc
    v_cndmask_b32 v42, v42, v17, vcc
    v_cndmask_b32 v43, v43, v17, vcc
    buffer_store_dwordx4 v[40:43], v2, s[28:31], s36 offen offset:3072
    s_add_u32 s36, s36, 4096
    ds_read_b128 v[20:23], v5 offset:256
    ds_read_b128 v[24:27], v5 offset:768
    s_waitcnt lgkmcnt(1)
    v_mul_f32 v160, v160, v20
    s_waitcnt lgkmcnt(0)
    v_fma_f32 v160, -v24, v16, v160
    v_mul_f32 v161, v161, v21
    v_fma_f32 v161, -v25, v16, v161
    v_mul_f32 v162, v162, v22
    v_fma_f32 v162, -v26, v16, v162
    v_mul_f32 v163, v163, v23
    v_fma_f32 v163, -v27, v16, v163
    v_cvt_pk_bf16_f32 v40, v160, v161
    v_cvt_pk_bf16_f32 v41, v162, v163
    ds_read_b128 v[28:31], v5 offset:288
    ds_read_b128 v[32:35], v5 offset:800
    s_waitcnt lgkmcnt(1)
    v_mul_f32 v164, v164, v28
    s_waitcnt lgkmcnt(0)
    v_fma_f32 v164, -v32, v16, v164
    v_mul_f32 v165, v165, v29
    v_fma_f32 v165, -v33, v16, v165
    v_mul_f32 v166, v166, v30
    v_fma_f32 v166, -v34, v16, v166
    v_mul_f32 v167, v167, v31
    v_fma_f32 v167, -v35, v16, v167
    v_cvt_pk_bf16_f32 v42, v164, v165
    v_cvt_pk_bf16_f32 v43, v166, v167
    v_cndmask_b32 v40, v40, v17, vcc
    v_cndmask_b32 v41, v41, v17, vcc
    v_cndmask_b32 v42, v42, v17, vcc
    v_cndmask_b32 v43, v43, v17, vcc
    buffer_store_dwordx4 v[40:43], v2, s[28:31], s36 offen offset:0
    ds_read_b128 v[20:23], v5 offset:320
    ds_read_b128 v[24:27], v5 offset:832
    s_waitcnt lgkmcnt(1)
    v_mul_f32 v168, v168, v20
    s_waitcnt lgkmcnt(0)
    v_fma_f32 v168, -v24, v16, v168
    v_mul_f32 v169, v169, v21
    v_fma_f32 v169, -v25, v16, v169
    v_mul_f32 v170, v170, v22
    v_fma_f32 v170, -v26, v16, v170
    v_mul_f32 v171, v171, v23
    v_fma_f32 v171, -v27, v16, v171
    v_cvt_pk_bf16_f32 v40, v168, v169
    v_cvt_pk_bf16_f32 v41, v170, v171
    ds_read_b128 v[28:31], v5 offset:352
    ds_read_b128 v[32:35], v5 offset:864
    s_waitcnt lgkmcnt(1)
    v_mul_f32 v172, v172, v28
    s_waitcnt lgkmcnt(0)
    v_fma_f32 v172, -v32, v16, v172
    v_mul_f32 v173, v173, v29
    v_fma_f32 v173, -v33, v16, v173
    v_mul_f32 v174, v174, v30
    v_fma_f32 v174, -v34, v16, v174
    v_mul_f32 v175, v175, v31
    v_fma_f32 v175, -v35, v16, v175
    v_cvt_pk_bf16_f32 v42, v172, v173
    v_cvt_pk_bf16_f32 v43, v174, v175
    v_cndmask_b32 v40, v40, v17, vcc
    v_cndmask_b32 v41, v41, v17, vcc
    v_cndmask_b32 v42, v42, v17, vcc
    v_cndmask_b32 v43, v43, v17, vcc
    buffer_store_dwordx4 v[40:43], v2, s[28:31], s36 offen offset:1024
    ds_read_b128 v[20:23], v5 offset:384
    ds_read_b128 v[24:27], v5 offset:896
    s_waitcnt lgkmcnt(1)
    v_mul_f32 v176, v176, v20
    s_waitcnt lgkmcnt(0)
    v_fma_f32 v176, -v24, v16, v176
    v_mul_f32 v177, v177, v21
    v_fma_f32 v177, -v25, v16, v177
    v_mul_f32 v178, v178, v22
    v_fma_f32 v178, -v26, v16, v178
    v_mul_f32 v179, v179, v23
    v_fma_f32 v179, -v27, v16, v179
    v_cvt_pk_bf16_f32 v40, v176, v177
    v_cvt_pk_bf16_f32 v41, v178, v179
    ds_read_b128 v[28:31], v5 offset:416
    ds_read_b128 v[32:35], v5 offset:928
    s_waitcnt lgkmcnt(1)
    v_mul_f32 v180, v180, v28
    s_waitcnt lgkmcnt(0)
    v_fma_f32 v180, -v32, v16, v180
    v_mul_f32 v181, v181, v29
    v_fma_f32 v181, -v33, v16, v181
    v_mul_f32 v182, v182, v30
    v_fma_f32 v182, -v34, v16, v182
    v_mul_f32 v183, v183, v31
    v_fma_f32 v183, -v35, v16, v183
    v_cvt_pk_bf16_f32 v42, v180, v181
    v_cvt_pk_bf16_f32 v43, v182, v183
    v_cndmask_b32 v40, v40, v17, vcc
    v_cndmask_b32 v41, v41, v17, vcc
    v_cndmask_b32 v42, v42, v17, vcc
    v_cndmask_b32 v43, v43, v17, vcc
    buffer_store_dwordx4 v[40:43], v2, s[28:31], s36 offen offset:2048
    ds_read_b128 v[20:23], v5 offset:448
    ds_read_b128 v[24:27], v5 offset:960
    s_waitcnt lgkmcnt(1)
    v_mul_f32 v184, v184, v20
    s_waitcnt lgkmcnt(0)
    v_fma_f32 v184, -v24, v16, v184
    v_mul_f32 v185, v185, v21
    v_fma_f32 v185, -v25, v16, v185
    v_mul_f32 v186, v186, v22
    v_fma_f32 v186, -v26, v16, v186
    v_mul_f32 v187, v187, v23
    v_fma_f32 v187, -v27, v16, v187
    v_cvt_pk_bf16_f32 v40, v184, v185
    v_cvt_pk_bf16_f32 v41, v186, v187
    ds_read_b128 v[28:31], v5 offset:480
    ds_read_b128 v[32:35], v5 offset:992
    s_waitcnt lgkmcnt(1)
    v_mul_f32 v188, v188, v28
    s_waitcnt lgkmcnt(0)
    v_fma_f32 v188, -v32, v16, v188
    v_mul_f32 v189, v189, v29
    v_fma_f32 v189, -v33, v16, v189
    v_mul_f32 v190, v190, v30
    v_fma_f32 v190, -v34, v16, v190
    v_mul_f32 v191, v191, v31
    v_fma_f32 v191, -v35, v16, v191
    v_cvt_pk_bf16_f32 v42, v188, v189
    v_cvt_pk_bf16_f32 v43, v190, v191
    v_cndmask_b32 v40, v40, v17, vcc
    v_cndmask_b32 v41, v41, v17, vcc
    v_cndmask_b32 v42, v42, v17, vcc
    v_cndmask_b32 v43, v43, v17, vcc
    buffer_store_dwordx4 v[40:43], v2, s[28:31], s36 offen offset:3072
    s_endpgm
.section .rodata,"a"
.p2align 6
.amdhsa_kernel k1b_kernel
  .amdhsa_next_free_vgpr 256
  .amdhsa_next_free_sgpr 64
  .amdhsa_accum_offset 256
  .amdhsa_group_segment_fixed_size 0
  .amdhsa_kernarg_size 80
  .amdhsa_user_sgpr_count 2
  .amdhsa_user_sgpr_kernarg_segment_ptr 1
  .amdhsa_system_sgpr_workgroup_id_x 1
.end_amdhsa_kernel
.text
.globl k2b_kernel
.p2align 8
.type k2b_kernel,@function
k2b_kernel:
    s_cmp_ge_u32 s2, 512
    s_cbranch_scc0 k2b_kernel_go1
    s_endpgm
k2b_kernel_go1:
    s_load_dwordx2 s[4:5], s[0:1], 72
    s_waitcnt lgkmcnt(0)
    s_add_u32 s12, s4, 8388608
    s_addc_u32 s13, s5, 0
    s_mov_b32 s14, 2097152
    s_mov_b32 s15, 0x00020000
    s_add_u32 s16, s4, 10485760
    s_addc_u32 s17, s5, 0
    s_mov_b32 s18, 2097152
    s_mov_b32 s19, 0x00020000
    s_add_u32 s20, s4, 12582912
    s_addc_u32 s21, s5, 0
    s_mov_b32 s22, 2097152
    s_mov_b32 s23, 0x00020000
    s_add_u32 s24, s4, 14680064
    s_addc_u32 s25, s5, 0
    s_mov_b32 s26, 1835008
    s_mov_b32 s27, 0x00020000
    v_lshrrev_b32 v1, 6, v0
    s_nop 0
    v_readfirstlane_b32 s32, v1
    s_and_b32 s30, s2, 7
    s_lshl_b32 s30, s30, 1
    s_bfe_u32 s31, s2, 0x10003
    s_add_u32 s30, s30, s31
    s_lshr_b32 s31, s2, 4
    s_lshl_b32 s33, s30, 17
    v_and_b32 v1, 63, v0
    v_lshlrev_b32 v2, 4, v1
    v_lshlrev_b32 v3, 4, v1
    s_lshl_b32 s34, s31, 12
    s_add_u32 s34, s34, s33
    buffer_load_dwordx4 v[16:19], v2, s[12:15], s34 offen offset:0
    buffer_load_dwordx4 v[20:23], v2, s[12:15], s34 offen offset:1024
    buffer_load_dwordx4 v[24:27], v2, s[12:15], s34 offen offset:2048
    buffer_load_dwordx4 v[28:31], v2, s[12:15], s34 offen offset:3072
    s_lshl_b32 s35, s32, 15
    s_add_u32 s35, s35, s33
    s_lshl_b32 s36, s32, 15
    s_add_u32 s36, s36, s33
    s_mov_b32 s40, 0.2726437354213113
    s_mov_b32 s38, s35
    v_mov_b32 v144, -1e30
    v_mov_b32 v145, -1e30
    buffer_load_dwordx4 v[112:115], v2, s[16:19], s35 offen offset:0
    buffer_load_dwordx4 v[116:119], v2, s[16:19], s35 offen offset:1024
    s_add_u32 s35, s35, 2048
    buffer_load_dwordx4 v[120:123], v2, s[16:19], s35 offen offset:0
    buffer_load_dwordx4 v[124:127], v2, s[16:19], s35 offen offset:1024
    s_add_u32 s35, s35, 2048
    buffer_load_dwordx4 v[128:131], v2, s[16:19], s35 offen offset:0
    buffer_load_dwordx4 v[132:135], v2, s[16:19], s35 offen offset:1024
    s_add_u32 s35, s35, 2048
    buffer_load_dwordx4 v[136:139], v2, s[16:19], s35 offen offset:0
    buffer_load_dwordx4 v[140:143], v2, s[16:19], s35 offen offset:1024
    s_add_u32 s35, s35, 2048
    buffer_load_dwordx4 v[224:227], v2, s[16:19], s35 offen offset:0
    buffer_load_dwordx4 v[228:231], v2, s[16:19], s35 offen offset:1024
    s_add_u32 s35, s35, 2048
    buffer_load_dwordx4 v[232:235], v2, s[16:19], s35 offen offset:0
    buffer_load_dwordx4 v[236:239], v2, s[16:19], s35 offen offset:1024
    s_add_u32 s35, s35, 2048
    buffer_load_dwordx4 v[240:243], v2, s[16:19], s35 offen offset:0
    buffer_load_dwordx4 v[244:247], v2, s[16:19], s35 offen offset:1024
    s_add_u32 s35, s35, 2048
    buffer_load_dwordx4 v[248:251], v2, s[16:19], s35 offen offset:0
    buffer_load_dwordx4 v[252:255], v2, s[16:19], s35 offen offset:1024
    s_add_u32 s35, s35, 2048
    buffer_load_dwordx4 v[192:195], v2, s[16:19], s35 offen offset:0
    buffer_load_dwordx4 v[196:199], v2, s[16:19], s35 offen offset:1024
    s_add_u32 s35, s35, 2048
    buffer_load_dwordx4 v[200:203], v2, s[16:19], s35 offen offset:0
    buffer_load_dwordx4 v[204:207], v2, s[16:19], s35 offen offset:1024
    s_add_u32 s35, s35, 2048
    buffer_load_dwordx4 v[208:211], v2, s[16:19], s35 offen offset:0
    buffer_load_dwordx4 v[212:215], v2, s[16:19], s35 offen offset:1024
    s_add_u32 s35, s35, 2048
    buffer_load_dwordx4 v[216:219], v2, s[16:19], s35 offen offset:0
    buffer_load_dwordx4 v[220:223], v2, s[16:19], s35 offen offset:1024
    s_add_u32 s35, s35, 2048
    buffer_load_dwordx4 v[32:35], v2, s[16:19], s35 offen offset:0
    buffer_load_dwordx4 v[36:39], v2, s[16:19], s35 offen offset:1024
    s_add_u32 s35, s35, 2048
    buffer_load_dwordx4 v[40:43], v2, s[16:19], s35 offen offset:0
    buffer_load_dwordx4 v[44:47], v2, s[16:19], s35 offen offset:1024
    s_add_u32 s35, s35, 2048
    buffer_load_dwordx4 v[48:51], v2, s[16:19], s35 offen offset:0
    buffer_load_dwordx4 v[52:55], v2, s[16:19], s35 offen offset:1024
    s_add_u32 s35, s35, 2048
    buffer_load_dwordx4 v[56:59], v2, s[16:19], s35 offen offset:0
    buffer_load_dwordx4 v[60:63], v2, s[16:19], s35 offen offset:1024
    s_add_u32 s35, s35, 2048
    s_waitcnt vmcnt(31)
    v_mfma_f32_32x32x16_bf16 v[64:79], v[112:115], v[16:19], 0
    v_mfma_f32_32x32x16_bf16 v[80:95], v[112:115], v[24:27], 0
    s_waitcnt vmcnt(30)
    v_mfma_f32_32x32x16_bf16 v[64:79], v[116:119], v[20:23], v[64:79]
    v_mfma_f32_32x32x16_bf16 v[80:95], v[116:119], v[28:31], v[80:95]
    s_waitcnt vmcnt(29)
    v_mfma_f32_32x32x16_bf16 v[160:175], v[120:123], v[16:19], 0
    s_nop 8
    v_max3_f32 v144, v144, v64, v65
    v_max3_f32 v144, v144, v66, v67
    v_max3_f32 v144, v144, v68, v69
    v_max3_f32 v144, v144, v70, v71
    v_mfma_f32_32x32x16_bf16 v[176:191], v[120:123], v[24:27], 0
    v_max3_f32 v144, v144, v72, v73
    v_max3_f32 v144, v144, v74, v75
    v_max3_f32 v144, v144, v76, v77
    v_max3_f32 v144, v144, v78, v79
    s_waitcnt vmcnt(28)
    v_mfma_f32_32x32x16_bf16 v[160:175], v[124:127], v[20:23], v[160:175]
    v_max3_f32 v145, v145, v80, v81
    v_max3_f32 v145, v145, v82, v83
    v_max3_f32 v145, v145, v84, v85
    v_max3_f32 v145, v145, v86, v87
    v_mfma_f32_32x32x16_bf16 v[176:191], v[124:127], v[28:31], v[176:191]
    v_max3_f32 v145, v145, v88, v89
    v_max3_f32 v145, v145, v90, v91
    v_max3_f32 v145, v145, v92, v93
    v_max3_f32 v145, v145, v94, v95
    s_waitcnt vmcnt(27)
    v_mfma_f32_32x32x16_bf16 v[64:79], v[128:131], v[16:19], 0
    s_nop 0
    v_max3_f32 v144, v144, v160, v161
    v_max3_f32 v144, v144, v162, v163
    v_max3_f32 v144, v144, v164, v165
    v_max3_f32 v144, v144, v166, v167
    v_mfma_f32_32x32x16_bf16 v[80:95], v[128:131], v[24:27], 0
    v_max3_f32 v144, v144, v168, v169
    v_max3_f32 v144, v144, v170, v171
    v_max3_f32 v144, v144, v172, v173
    v_max3_f32 v144, v144, v174, v175
    s_waitcnt vmcnt(26)
    v_mfma_f32_32x32x16_bf16 v[64:79], v[132:135], v[20:23], v[64:79]
    v_max3_f32 v145, v145, v176, v177
    v_max3_f32 v145, v145, v178, v179
    v_max3_f32 v145, v145, v180, v181
    v_max3_f32 v145, v145, v182, v183
    v_mfma_f32_32x32x16_bf16 v[80:95], v[132:135], v[28:31], v[80:95]
    v_max3_f32 v145, v145, v184, v185
    v_max3_f32 v145, v145, v186, v187
    v_max3_f32 v145, v145, v188, v189
    v_max3_f32 v145, v145, v190, v191
    s_waitcnt vmcnt(25)
    v_mfma_f32_32x32x16_bf16 v[160:175], v[136:139], v[16:19], 0
    s_nop 0
    v_max3_f32 v144, v144, v64, v65
    v_max3_f32 v144, v144, v66, v67
    v_max3_f32 v144, v144, v68, v69
    v_max3_f32 v144, v144, v70, v71
    v_mfma_f32_32x32x16_bf16 v[176:191], v[136:139], v[24:27], 0
    v_max3_f32 v144, v144, v72, v73
    v_max3_f32 v144, v144, v74, v75
    v_max3_f32 v144, v144, v76, v77
    v_max3_f32 v144, v144, v78, v79
    s_waitcnt vmcnt(24)
    v_mfma_f32_32x32x16_bf16 v[160:175], v[140:143], v[20:23], v[160:175]
    v_max3_f32 v145, v145, v80, v81
    v_max3_f32 v145, v145, v82, v83
    v_max3_f32 v145, v145, v84, v85
    v_max3_f32 v145, v145, v86, v87
    v_mfma_f32_32x32x16_bf16 v[176:191], v[140:143], v[28:31], v[176:191]
    v_max3_f32 v145, v145, v88, v89
    v_max3_f32 v145, v145, v90, v91
    v_max3_f32 v145, v145, v92, v93
    v_max3_f32 v145, v145, v94, v95
    s_waitcnt vmcnt(23)
    v_mfma_f32_32x32x16_bf16 v[64:79], v[224:227], v[16:19], 0
    s_nop 0
    v_max3_f32 v144, v144, v160, v161
    v_max3_f32 v144, v144, v162, v163
    v_max3_f32 v144, v144, v164, v165
    v_max3_f32 v144, v144, v166, v167
    v_mfma_f32_32x32x16_bf16 v[80:95], v[224:227], v[24:27], 0
    v_max3_f32 v144, v144, v168, v169
    v_max3_f32 v144, v144, v170, v171
    v_max3_f32 v144, v144, v172, v173
    v_max3_f32 v144, v144, v174, v175
    s_waitcnt vmcnt(22)
    v_mfma_f32_32x32x16_bf16 v[64:79], v[228:231], v[20:23], v[64:79]
    v_max3_f32 v145, v145, v176, v177
    v_max3_f32 v145, v145, v178, v179
    v_max3_f32 v145, v145, v180, v181
    v_max3_f32 v145, v145, v182, v183
    v_mfma_f32_32x32x16_bf16 v[80:95], v[228:231], v[28:31], v[80:95]
    v_max3_f32 v145, v145, v184, v185
    v_max3_f32 v145, v145, v186, v187
    v_max3_f32 v145, v145, v188, v189
    v_max3_f32 v145, v145, v190, v191
    s_waitcnt vmcnt(21)
    v_mfma_f32_32x32x16_bf16 v[160:175], v[232:235], v[16:19], 0
    s_nop 0
    v_max3_f32 v144, v144, v64, v65
    v_max3_f32 v144, v144, v66, v67
    v_max3_f32 v144, v144, v68, v69
    v_max3_f32 v144, v144, v70, v71
    v_mfma_f32_32x32x16_bf16 v[176:191], v[232:235], v[24:27], 0
    v_max3_f32 v144, v144, v72, v73
    v_max3_f32 v144, v144, v74, v75
    v_max3_f32 v144, v144, v76, v77
    v_max3_f32 v144, v144, v78, v79
    s_waitcnt vmcnt(20)
    v_mfma_f32_32x32x16_bf16 v[160:175], v[236:239], v[20:23], v[160:175]
    v_max3_f32 v145, v145, v80, v81
    v_max3_f32 v145, v145, v82, v83
    v_max3_f32 v145, v145, v84, v85
    v_max3_f32 v145, v145, v86, v87
    v_mfma_f32_32x32x16_bf16 v[176:191], v[236:239], v[28:31], v[176:191]
    v_max3_f32 v145, v145, v88, v89
    v_max3_f32 v145, v145, v90, v91
    v_max3_f32 v145, v145, v92, v93
    v_max3_f32 v145, v145, v94, v95
    s_waitcnt vmcnt(19)
    v_mfma_f32_32x32x16_bf16 v[64:79], v[240:243], v[16:19], 0
    s_nop 0
    v_max3_f32 v144, v144, v160, v161
    v_max3_f32 v144, v144, v162, v163
    v_max3_f32 v144, v144, v164, v165
    v_max3_f32 v144, v144, v166, v167
    v_mfma_f32_32x32x16_bf16 v[80:95], v[240:243], v[24:27], 0
    v_max3_f32 v144, v144, v168, v169
    v_max3_f32 v144, v144, v170, v171
    v_max3_f32 v144, v144, v172, v173
    v_max3_f32 v144, v144, v174, v175
    s_waitcnt vmcnt(18)
    v_mfma_f32_32x32x16_bf16 v[64:79], v[244:247], v[20:23], v[64:79]
    v_max3_f32 v145, v145, v176, v177
    v_max3_f32 v145, v145, v178, v179
    v_max3_f32 v145, v145, v180, v181
    v_max3_f32 v145, v145, v182, v183
    v_mfma_f32_32x32x16_bf16 v[80:95], v[244:247], v[28:31], v[80:95]
    v_max3_f32 v145, v145, v184, v185
    v_max3_f32 v145, v145, v186, v187
    v_max3_f32 v145, v145, v188, v189
    v_max3_f32 v145, v145, v190, v191
    s_waitcnt vmcnt(17)
    v_mfma_f32_32x32x16_bf16 v[160:175], v[248:251], v[16:19], 0
    s_nop 0
    v_max3_f32 v144, v144, v64, v65
    v_max3_f32 v144, v144, v66, v67
    v_max3_f32 v144, v144, v68, v69
    v_max3_f32 v144, v144, v70, v71
    v_mfma_f32_32x32x16_bf16 v[176:191], v[248:251], v[24:27], 0
    v_max3_f32 v144, v144, v72, v73
    v_max3_f32 v144, v144, v74, v75
    v_max3_f32 v144, v144, v76, v77
    v_max3_f32 v144, v144, v78, v79
    s_waitcnt vmcnt(16)
    v_mfma_f32_32x32x16_bf16 v[160:175], v[252:255], v[20:23], v[160:175]
    v_max3_f32 v145, v145, v80, v81
    v_max3_f32 v145, v145, v82, v83
    v_max3_f32 v145, v145, v84, v85
    v_max3_f32 v145, v145, v86, v87
    v_mfma_f32_32x32x16_bf16 v[176:191], v[252:255], v[28:31], v[176:191]
    v_max3_f32 v145, v145, v88, v89
    v_max3_f32 v145, v145, v90, v91
    v_max3_f32 v145, v145, v92, v93
    v_max3_f32 v145, v145, v94, v95
    s_waitcnt vmcnt(15)
    v_mfma_f32_32x32x16_bf16 v[64:79], v[192:195], v[16:19], 0
    s_nop 0
    v_max3_f32 v144, v144, v160, v161
    v_max3_f32 v144, v144, v162, v163
    v_max3_f32 v144, v144, v164, v165
    v_max3_f32 v144, v144, v166, v167
    v_mfma_f32_32x32x16_bf16 v[80:95], v[192:195], v[24:27], 0
    v_max3_f32 v144, v144, v168, v169
    v_max3_f32 v144, v144, v170, v171
    v_max3_f32 v144, v144, v172, v173
    v_max3_f32 v144, v144, v174, v175
    s_waitcnt vmcnt(14)
    v_mfma_f32_32x32x16_bf16 v[64:79], v[196:199], v[20:23], v[64:79]
    v_max3_f32 v145, v145, v176, v177
    v_max3_f32 v145, v145, v178, v179
    v_max3_f32 v145, v145, v180, v181
    v_max3_f32 v145, v145, v182, v183
    v_mfma_f32_32x32x16_bf16 v[80:95], v[196:199], v[28:31], v[80:95]
    v_max3_f32 v145, v145, v184, v185
    v_max3_f32 v145, v145, v186, v187
    v_max3_f32 v145, v145, v188, v189
    v_max3_f32 v145, v145, v190, v191
    s_waitcnt vmcnt(13)
    v_mfma_f32_32x32x16_bf16 v[160:175], v[200:203], v[16:19], 0
    s_nop 0
    v_max3_f32 v144, v144, v64, v65
    v_max3_f32 v144, v144, v66, v67
    v_max3_f32 v144, v144, v68, v69
    v_max3_f32 v144, v144, v70, v71
    v_mfma_f32_32x32x16_bf16 v[176:191], v[200:203], v[24:27], 0
    v_max3_f32 v144, v144, v72, v73
    v_max3_f32 v144, v144, v74, v75
    v_max3_f32 v144, v144, v76, v77
    v_max3_f32 v144, v144, v78, v79
    s_waitcnt vmcnt(12)
    v_mfma_f32_32x32x16_bf16 v[160:175], v[204:207], v[20:23], v[160:175]
    v_max3_f32 v145, v145, v80, v81
    v_max3_f32 v145, v145, v82, v83
    v_max3_f32 v145, v145, v84, v85
    v_max3_f32 v145, v145, v86, v87
    v_mfma_f32_32x32x16_bf16 v[176:191], v[204:207], v[28:31], v[176:191]
    v_max3_f32 v145, v145, v88, v89
    v_max3_f32 v145, v145, v90, v91
    v_max3_f32 v145, v145, v92, v93
    v_max3_f32 v145, v145, v94, v95
    s_waitcnt vmcnt(11)
    v_mfma_f32_32x32x16_bf16 v[64:79], v[208:211], v[16:19], 0
    s_nop 0
    v_max3_f32 v144, v144, v160, v161
    v_max3_f32 v144, v144, v162, v163
    v_max3_f32 v144, v144, v164, v165
    v_max3_f32 v144, v144, v166, v167
    v_mfma_f32_32x32x16_bf16 v[80:95], v[208:211], v[24:27], 0
    v_max3_f32 v144, v144, v168, v169
    v_max3_f32 v144, v144, v170, v171
    v_max3_f32 v144, v144, v172, v173
    v_max3_f32 v144, v144, v174, v175
    s_waitcnt vmcnt(10)
    v_mfma_f32_32x32x16_bf16 v[64:79], v[212:215], v[20:23], v[64:79]
    v_max3_f32 v145, v145, v176, v177
    v_max3_f32 v145, v145, v178, v179
    v_max3_f32 v145, v145, v180, v181
    v_max3_f32 v145, v145, v182, v183
    v_mfma_f32_32x32x16_bf16 v[80:95], v[212:215], v[28:31], v[80:95]
    v_max3_f32 v145, v145, v184, v185
    v_max3_f32 v145, v145, v186, v187
    v_max3_f32 v145, v145, v188, v189
    v_max3_f32 v145, v145, v190, v191
    s_waitcnt vmcnt(9)
    v_mfma_f32_32x32x16_bf16 v[160:175], v[216:219], v[16:19], 0
    s_nop 0
    v_max3_f32 v144, v144, v64, v65
    v_max3_f32 v144, v144, v66, v67
    v_max3_f32 v144, v144, v68, v69
    v_max3_f32 v144, v144, v70, v71
    v_mfma_f32_32x32x16_bf16 v[176:191], v[216:219], v[24:27], 0
    v_max3_f32 v144, v144, v72, v73
    v_max3_f32 v144, v144, v74, v75
    v_max3_f32 v144, v144, v76, v77
    v_max3_f32 v144, v144, v78, v79
    s_waitcnt vmcnt(8)
    v_mfma_f32_32x32x16_bf16 v[160:175], v[220:223], v[20:23], v[160:175]
    v_max3_f32 v145, v145, v80, v81
    v_max3_f32 v145, v145, v82, v83
    v_max3_f32 v145, v145, v84, v85
    v_max3_f32 v145, v145, v86, v87
    v_mfma_f32_32x32x16_bf16 v[176:191], v[220:223], v[28:31], v[176:191]
    v_max3_f32 v145, v145, v88, v89
    v_max3_f32 v145, v145, v90, v91
    v_max3_f32 v145, v145, v92, v93
    v_max3_f32 v145, v145, v94, v95
    s_waitcnt vmcnt(7)
    v_mfma_f32_32x32x16_bf16 v[64:79], v[32:35], v[16:19], 0
    s_nop 0
    v_max3_f32 v144, v144, v160, v161
    v_max3_f32 v144, v144, v162, v163
    v_max3_f32 v144, v144, v164, v165
    v_max3_f32 v144, v144, v166, v167
    v_mfma_f32_32x32x16_bf16 v[80:95], v[32:35], v[24:27], 0
    v_max3_f32 v144, v144, v168, v169
    v_max3_f32 v144, v144, v170, v171
    v_max3_f32 v144, v144, v172, v173
    v_max3_f32 v144, v144, v174, v175
    s_waitcnt vmcnt(6)
    v_mfma_f32_32x32x16_bf16 v[64:79], v[36:39], v[20:23], v[64:79]
    v_max3_f32 v145, v145, v176, v177
    v_max3_f32 v145, v145, v178, v179
    v_max3_f32 v145, v145, v180, v181
    v_max3_f32 v145, v145, v182, v183
    v_mfma_f32_32x32x16_bf16 v[80:95], v[36:39], v[28:31], v[80:95]
    v_max3_f32 v145, v145, v184, v185
    v_max3_f32 v145, v145, v186, v187
    v_max3_f32 v145, v145, v188, v189
    v_max3_f32 v145, v145, v190, v191
    s_waitcnt vmcnt(5)
    v_mfma_f32_32x32x16_bf16 v[160:175], v[40:43], v[16:19], 0
    s_nop 0
    v_max3_f32 v144, v144, v64, v65
    v_max3_f32 v144, v144, v66, v67
    v_max3_f32 v144, v144, v68, v69
    v_max3_f32 v144, v144, v70, v71
    v_mfma_f32_32x32x16_bf16 v[176:191], v[40:43], v[24:27], 0
    v_max3_f32 v144, v144, v72, v73
    v_max3_f32 v144, v144, v74, v75
    v_max3_f32 v144, v144, v76, v77
    v_max3_f32 v144, v144, v78, v79
    s_waitcnt vmcnt(4)
    v_mfma_f32_32x32x16_bf16 v[160:175], v[44:47], v[20:23], v[160:175]
    v_max3_f32 v145, v145, v80, v81
    v_max3_f32 v145, v145, v82, v83
    v_max3_f32 v145, v145, v84, v85
    v_max3_f32 v145, v145, v86, v87
    v_mfma_f32_32x32x16_bf16 v[176:191], v[44:47], v[28:31], v[176:191]
    v_max3_f32 v145, v145, v88, v89
    v_max3_f32 v145, v145, v90, v91
    v_max3_f32 v145, v145, v92, v93
    v_max3_f32 v145, v145, v94, v95
    s_waitcnt vmcnt(3)
    v_mfma_f32_32x32x16_bf16 v[64:79], v[48:51], v[16:19], 0
    s_nop 0
    v_max3_f32 v144, v144, v160, v161
    v_max3_f32 v144, v144, v162, v163
    v_max3_f32 v144, v144, v164, v165
    v_max3_f32 v144, v144, v166, v167
    v_mfma_f32_32x32x16_bf16 v[80:95], v[48:51], v[24:27], 0
    v_max3_f32 v144, v144, v168, v169
    v_max3_f32 v144, v144, v170, v171
    v_max3_f32 v144, v144, v172, v173
    v_max3_f32 v144, v144, v174, v175
    s_waitcnt vmcnt(2)
    v_mfma_f32_32x32x16_bf16 v[64:79], v[52:55], v[20:23], v[64:79]
    v_max3_f32 v145, v145, v176, v177
    v_max3_f32 v145, v145, v178, v179
    v_max3_f32 v145, v145, v180, v181
    v_max3_f32 v145, v145, v182, v183
    v_mfma_f32_32x32x16_bf16 v[80:95], v[52:55], v[28:31], v[80:95]
    v_max3_f32 v145, v145, v184, v185
    v_max3_f32 v145, v145, v186, v187
    v_max3_f32 v145, v145, v188, v189
    v_max3_f32 v145, v145, v190, v191
    s_waitcnt vmcnt(1)
    v_mfma_f32_32x32x16_bf16 v[160:175], v[56:59], v[16:19], 0
    s_nop 0
    v_max3_f32 v144, v144, v64, v65
    v_max3_f32 v144, v144, v66, v67
    v_max3_f32 v144, v144, v68, v69
    v_max3_f32 v144, v144, v70, v71
    v_mfma_f32_32x32x16_bf16 v[176:191], v[56:59], v[24:27], 0
    v_max3_f32 v144, v144, v72, v73
    v_max3_f32 v144, v144, v74, v75
    v_max3_f32 v144, v144, v76, v77
    v_max3_f32 v144, v144, v78, v79
    s_waitcnt vmcnt(0)
    v_mfma_f32_32x32x16_bf16 v[160:175], v[60:63], v[20:23], v[160:175]
    v_max3_f32 v145, v145, v80, v81
    v_max3_f32 v145, v145, v82, v83
    v_max3_f32 v145, v145, v84, v85
    v_max3_f32 v145, v145, v86, v87
    v_mfma_f32_32x32x16_bf16 v[176:191], v[60:63], v[28:31], v[176:191]
    v_max3_f32 v145, v145, v88, v89
    v_max3_f32 v145, v145, v90, v91
    v_max3_f32 v145, v145, v92, v93
    v_max3_f32 v145, v145, v94, v95
    s_nop 2
    v_max3_f32 v144, v144, v160, v161
    v_max3_f32 v144, v144, v162, v163
    v_max3_f32 v144, v144, v164, v165
    v_max3_f32 v144, v144, v166, v167
    v_max3_f32 v144, v144, v168, v169
    v_max3_f32 v144, v144, v170, v171
    v_max3_f32 v144, v144, v172, v173
    v_max3_f32 v144, v144, v174, v175
    v_max3_f32 v145, v145, v176, v177
    v_max3_f32 v145, v145, v178, v179
    v_max3_f32 v145, v145, v180, v181
    v_max3_f32 v145, v145, v182, v183
    v_max3_f32 v145, v145, v184, v185
    v_max3_f32 v145, v145, v186, v187
    v_max3_f32 v145, v145, v188, v189
    v_max3_f32 v145, v145, v190, v191
    v_mov_b32 v32, 0
    v_mov_b32 v33, 0
    v_mov_b32 v34, 0
    v_mov_b32 v35, 0
    v_mov_b32 v36, 0
    v_mov_b32 v37, 0
    v_mov_b32 v38, 0
    v_mov_b32 v39, 0
    v_mov_b32 v40, 0
    v_mov_b32 v41, 0
    v_mov_b32 v42, 0
    v_mov_b32 v43, 0
    v_mov_b32 v44, 0
    v_mov_b32 v45, 0
    v_mov_b32 v46, 0
    v_mov_b32 v47, 0
    v_mov_b32 v48, 0
    v_mov_b32 v49, 0
    v_mov_b32 v50, 0
    v_mov_b32 v51, 0
    v_mov_b32 v52, 0
    v_mov_b32 v53, 0
    v_mov_b32 v54, 0
    v_mov_b32 v55, 0
    v_mov_b32 v56, 0
    v_mov_b32 v57, 0
    v_mov_b32 v58, 0
    v_mov_b32 v59, 0
    v_mov_b32 v60, 0
    v_mov_b32 v61, 0
    v_mov_b32 v62, 0
    v_mov_b32 v63, 0
    s_mov_b32 s35, s38
    buffer_load_dwordx4 v[112:115], v2, s[16:19], s35 offen offset:0
    buffer_load_dwordx4 v[116:119], v2, s[16:19], s35 offen offset:1024
    s_add_u32 s35, s35, 2048
    buffer_load_dwordx4 v[224:227], v3, s[20:23], s36 offen offset:0
    buffer_load_dwordx4 v[228:231], v3, s[20:23], s36 offen offset:1024
    s_add_u32 s36, s36, 2048
    buffer_load_dwordx4 v[120:123], v2, s[16:19], s35 offen offset:0
    buffer_load_dwordx4 v[124:127], v2, s[16:19], s35 offen offset:1024
    s_add_u32 s35, s35, 2048
    buffer_load_dwordx4 v[232:235], v3, s[20:23], s36 offen offset:0
    buffer_load_dwordx4 v[236:239], v3, s[20:23], s36 offen offset:1024
    s_add_u32 s36, s36, 2048
    buffer_load_dwordx4 v[128:131], v2, s[16:19], s35 offen offset:0
    buffer_load_dwordx4 v[132:135], v2, s[16:19], s35 offen offset:1024
    s_add_u32 s35, s35, 2048
    buffer_load_dwordx4 v[240:243], v3, s[20:23], s36 offen offset:0
    buffer_load_dwordx4 v[244:247], v3, s[20:23], s36 offen offset:1024
    s_add_u32 s36, s36, 2048
    buffer_load_dwordx4 v[136:139], v2, s[16:19], s35 offen offset:0
    buffer_load_dwordx4 v[140:143], v2, s[16:19], s35 offen offset:1024
    s_add_u32 s35, s35, 2048
    v_mov_b32 v146, v144
    s_nop 1
    v_permlane32_swap_b32 v144, v146
    v_max_f32 v144, v144, v146
    v_sub_f32 v192, 0, v144
    v_sub_f32 v193, 0, v144
    v_sub_f32 v194, 0, v144
    v_sub_f32 v195, 0, v144
    v_sub_f32 v196, 0, v144
    v_sub_f32 v197, 0, v144
    v_sub_f32 v198, 0, v144
    v_sub_f32 v199, 0, v144
    v_sub_f32 v200, 0, v144
    v_sub_f32 v201, 0, v144
    v_sub_f32 v202, 0, v144
    v_sub_f32 v203, 0, v144
    v_sub_f32 v204, 0, v144
    v_sub_f32 v205, 0, v144
    v_sub_f32 v206, 0, v144
    v_sub_f32 v207, 0, v144
    v_mov_b32 v146, v145
    s_nop 1
    v_permlane32_swap_b32 v145, v146
    v_max_f32 v145, v145, v146
    v_sub_f32 v208, 0, v145
    v_sub_f32 v209, 0, v145
    v_sub_f32 v210, 0, v145
    v_sub_f32 v211, 0, v145
    v_sub_f32 v212, 0, v145
    v_sub_f32 v213, 0, v145
    v_sub_f32 v214, 0, v145
    v_sub_f32 v215, 0, v145
    v_sub_f32 v216, 0, v145
    v_sub_f32 v217, 0, v145
    v_sub_f32 v218, 0, v145
    v_sub_f32 v219, 0, v145
    v_sub_f32 v220, 0, v145
    v_sub_f32 v221, 0, v145
    v_sub_f32 v222, 0, v145
    v_sub_f32 v223, 0, v145
    s_waitcnt vmcnt(13)
    v_mfma_f32_32x32x16_bf16 v[64:79], v[112:115], v[16:19], v[192:207]
    v_mfma_f32_32x32x16_bf16 v[80:95], v[112:115], v[24:27], v[208:223]
    s_waitcnt vmcnt(12)
    v_mfma_f32_32x32x16_bf16 v[64:79], v[116:119], v[20:23], v[64:79]
    v_mfma_f32_32x32x16_bf16 v[80:95], v[116:119], v[28:31], v[80:95]
    s_mov_b32 s37, 0
    s_nop 10
k2b_kernel_loop2:
    buffer_load_dwordx4 v[248:251], v3, s[20:23], s36 offen offset:0
    buffer_load_dwordx4 v[252:255], v3, s[20:23], s36 offen offset:1024
    s_add_u32 s36, s36, 2048
    s_waitcnt vmcnt(11)
    v_mfma_f32_32x32x16_bf16 v[160:175], v[120:123], v[16:19], v[192:207]
    v_exp_f32 v64, v64
    v_exp_f32 v65, v65
    v_exp_f32 v66, v66
    v_exp_f32 v67, v67
    v_mfma_f32_32x32x16_bf16 v[176:191], v[120:123], v[24:27], v[208:223]
    v_exp_f32 v68, v68
    v_exp_f32 v69, v69
    v_exp_f32 v70, v70
    v_exp_f32 v71, v71
    s_waitcnt vmcnt(10)
    v_mfma_f32_32x32x16_bf16 v[160:175], v[124:127], v[20:23], v[160:175]
    v_exp_f32 v72, v72
    v_exp_f32 v73, v73
    v_exp_f32 v74, v74
    v_exp_f32 v75, v75
    v_mfma_f32_32x32x16_bf16 v[176:191], v[124:127], v[28:31], v[176:191]
    v_exp_f32 v76, v76
    v_exp_f32 v77, v77
    v_exp_f32 v78, v78
    v_exp_f32 v79, v79
    buffer_load_dwordx4 v[112:115], v2, s[16:19], s35 offen offset:0
    buffer_load_dwordx4 v[116:119], v2, s[16:19], s35 offen offset:1024
    s_add_u32 s35, s35, 2048
    v_cvt_pk_bf16_f32 v96, v64, v65
    v_cvt_pk_bf16_f32 v97, v66, v67
    v_cvt_pk_bf16_f32 v98, v68, v69
    v_cvt_pk_bf16_f32 v99, v70, v71
    v_cvt_pk_bf16_f32 v100, v72, v73
    v_cvt_pk_bf16_f32 v101, v74, v75
    v_cvt_pk_bf16_f32 v102, v76, v77
    v_cvt_pk_bf16_f32 v103, v78, v79
    v_mfma_f32_32x32x16_bf16 v[32:47], v[224:227], v[96:99], v[32:47]
    v_exp_f32 v80, v80
    v_exp_f32 v81, v81
    v_exp_f32 v82, v82
    v_exp_f32 v83, v83
    v_mfma_f32_32x32x16_bf16 v[32:47], v[228:231], v[100:103], v[32:47]
    v_exp_f32 v84, v84
    v_exp_f32 v85, v85
    v_exp_f32 v86, v86
    v_exp_f32 v87, v87
    v_exp_f32 v88, v88
    v_exp_f32 v89, v89
    v_exp_f32 v90, v90
    v_exp_f32 v91, v91
    v_exp_f32 v92, v92
    v_exp_f32 v93, v93
    v_exp_f32 v94, v94
    v_exp_f32 v95, v95
    v_cvt_pk_bf16_f32 v104, v80, v81
    v_cvt_pk_bf16_f32 v105, v82, v83
    v_cvt_pk_bf16_f32 v106, v84, v85
    v_cvt_pk_bf16_f32 v107, v86, v87
    v_cvt_pk_bf16_f32 v108, v88, v89
    v_cvt_pk_bf16_f32 v109, v90, v91
    v_cvt_pk_bf16_f32 v110, v92, v93
    v_cvt_pk_bf16_f32 v111, v94, v95
    v_mfma_f32_32x32x16_bf16 v[48:63], v[224:227], v[104:107], v[48:63]
    s_nop 0
    v_mfma_f32_32x32x16_bf16 v[48:63], v[228:231], v[108:111], v[48:63]
    buffer_load_dwordx4 v[224:227], v3, s[20:23], s36 offen offset:0
    buffer_load_dwordx4 v[228:231], v3, s[20:23], s36 offen offset:1024
    s_add_u32 s36, s36, 2048
    s_waitcnt vmcnt(11)
    v_mfma_f32_32x32x16_bf16 v[64:79], v[128:131], v[16:19], v[192:207]
    v_exp_f32 v160, v160
    v_exp_f32 v161, v161
    v_exp_f32 v162, v162
    v_exp_f32 v163, v163
    v_mfma_f32_32x32x16_bf16 v[80:95], v[128:131], v[24:27], v[208:223]
    v_exp_f32 v164, v164
    v_exp_f32 v165, v165
    v_exp_f32 v166, v166
    v_exp_f32 v167, v167
    s_waitcnt vmcnt(10)
    v_mfma_f32_32x32x16_bf16 v[64:79], v[132:135], v[20:23], v[64:79]
    v_exp_f32 v168, v168
    v_exp_f32 v169, v169
    v_exp_f32 v170, v170
    v_exp_f32 v171, v171
    v_mfma_f32_32x32x16_bf16 v[80:95], v[132:135], v[28:31], v[80:95]
    v_exp_f32 v172, v172
    v_exp_f32 v173, v173
    v_exp_f32 v174, v174
    v_exp_f32 v175, v175
    buffer_load_dwordx4 v[120:123], v2, s[16:19], s35 offen offset:0
    buffer_load_dwordx4 v[124:127], v2, s[16:19], s35 offen offset:1024
    s_add_u32 s35, s35, 2048
    v_cvt_pk_bf16_f32 v96, v160, v161
    v_cvt_pk_bf16_f32 v97, v162, v163
    v_cvt_pk_bf16_f32 v98, v164, v165
    v_cvt_pk_bf16_f32 v99, v166, v167
    v_cvt_pk_bf16_f32 v100, v168, v169
    v_cvt_pk_bf16_f32 v101, v170, v171
    v_cvt_pk_bf16_f32 v102, v172, v173
    v_cvt_pk_bf16_f32 v103, v174, v175
    v_mfma_f32_32x32x16_bf16 v[32:47], v[232:235], v[96:99], v[32:47]
    v_exp_f32 v176, v176
    v_exp_f32 v177, v177
    v_exp_f32 v178, v178
    v_exp_f32 v179, v179
    v_mfma_f32_32x32x16_bf16 v[32:47], v[236:239], v[100:103], v[32:47]
    v_exp_f32 v180, v180
    v_exp_f32 v181, v181
    v_exp_f32 v182, v182
    v_exp_f32 v183, v183
    v_exp_f32 v184, v184
    v_exp_f32 v185, v185
    v_exp_f32 v186, v186
    v_exp_f32 v187, v187
    v_exp_f32 v188, v188
    v_exp_f32 v189, v189
    v_exp_f32 v190, v190
    v_exp_f32 v191, v191
    v_cvt_pk_bf16_f32 v104, v176, v177
    v_cvt_pk_bf16_f32 v105, v178, v179
    v_cvt_pk_bf16_f32 v106, v180, v181
    v_cvt_pk_bf16_f32 v107, v182, v183
    v_cvt_pk_bf16_f32 v108, v184, v185
    v_cvt_pk_bf16_f32 v109, v186, v187
    v_cvt_pk_bf16_f32 v110, v188, v189
    v_cvt_pk_bf16_f32 v111, v190, v191
    v_mfma_f32_32x32x16_bf16 v[48:63], v[232:235], v[104:107], v[48:63]
    s_nop 0
    v_mfma_f32_32x32x16_bf16 v[48:63], v[236:239], v[108:111], v[48:63]
    buffer_load_dwordx4 v[232:235], v3, s[20:23], s36 offen offset:0
    buffer_load_dwordx4 v[236:239], v3, s[20:23], s36 offen offset:1024
    s_add_u32 s36, s36, 2048
    s_waitcnt vmcnt(11)
    v_mfma_f32_32x32x16_bf16 v[160:175], v[136:139], v[16:19], v[192:207]
    v_exp_f32 v64, v64
    v_exp_f32 v65, v65
    v_exp_f32 v66, v66
    v_exp_f32 v67, v67
    v_mfma_f32_32x32x16_bf16 v[176:191], v[136:139], v[24:27], v[208:223]
    v_exp_f32 v68, v68
    v_exp_f32 v69, v69
    v_exp_f32 v70, v70
    v_exp_f32 v71, v71
    s_waitcnt vmcnt(10)
    v_mfma_f32_32x32x16_bf16 v[160:175], v[140:143], v[20:23], v[160:175]
    v_exp_f32 v72, v72
    v_exp_f32 v73, v73
    v_exp_f32 v74, v74
    v_exp_f32 v75, v75
    v_mfma_f32_32x32x16_bf16 v[176:191], v[140:143], v[28:31], v[176:191]
    v_exp_f32 v76, v76
    v_exp_f32 v77, v77
    v_exp_f32 v78, v78
    v_exp_f32 v79, v79
    buffer_load_dwordx4 v[128:131], v2, s[16:19], s35 offen offset:0
    buffer_load_dwordx4 v[132:135], v2, s[16:19], s35 offen offset:1024
    s_add_u32 s35, s35, 2048
    v_cvt_pk_bf16_f32 v96, v64, v65
    v_cvt_pk_bf16_f32 v97, v66, v67
    v_cvt_pk_bf16_f32 v98, v68, v69
    v_cvt_pk_bf16_f32 v99, v70, v71
    v_cvt_pk_bf16_f32 v100, v72, v73
    v_cvt_pk_bf16_f32 v101, v74, v75
    v_cvt_pk_bf16_f32 v102, v76, v77
    v_cvt_pk_bf16_f32 v103, v78, v79
    v_mfma_f32_32x32x16_bf16 v[32:47], v[240:243], v[96:99], v[32:47]
    v_exp_f32 v80, v80
    v_exp_f32 v81, v81
    v_exp_f32 v82, v82
    v_exp_f32 v83, v83
    v_mfma_f32_32x32x16_bf16 v[32:47], v[244:247], v[100:103], v[32:47]
    v_exp_f32 v84, v84
    v_exp_f32 v85, v85
    v_exp_f32 v86, v86
    v_exp_f32 v87, v87
    v_exp_f32 v88, v88
    v_exp_f32 v89, v89
    v_exp_f32 v90, v90
    v_exp_f32 v91, v91
    v_exp_f32 v92, v92
    v_exp_f32 v93, v93
    v_exp_f32 v94, v94
    v_exp_f32 v95, v95
    v_cvt_pk_bf16_f32 v104, v80, v81
    v_cvt_pk_bf16_f32 v105, v82, v83
    v_cvt_pk_bf16_f32 v106, v84, v85
    v_cvt_pk_bf16_f32 v107, v86, v87
    v_cvt_pk_bf16_f32 v108, v88, v89
    v_cvt_pk_bf16_f32 v109, v90, v91
    v_cvt_pk_bf16_f32 v110, v92, v93
    v_cvt_pk_bf16_f32 v111, v94, v95
    v_mfma_f32_32x32x16_bf16 v[48:63], v[240:243], v[104:107], v[48:63]
    s_nop 0
    v_mfma_f32_32x32x16_bf16 v[48:63], v[244:247], v[108:111], v[48:63]
    buffer_load_dwordx4 v[240:243], v3, s[20:23], s36 offen offset:0
    buffer_load_dwordx4 v[244:247], v3, s[20:23], s36 offen offset:1024
    s_add_u32 s36, s36, 2048
    s_waitcnt vmcnt(11)
    v_mfma_f32_32x32x16_bf16 v[64:79], v[112:115], v[16:19], v[192:207]
    v_exp_f32 v160, v160
    v_exp_f32 v161, v161
    v_exp_f32 v162, v162
    v_exp_f32 v163, v163
    v_mfma_f32_32x32x16_bf16 v[80:95], v[112:115], v[24:27], v[208:223]
    v_exp_f32 v164, v164
    v_exp_f32 v165, v165
    v_exp_f32 v166, v166
    v_exp_f32 v167, v167
    s_waitcnt vmcnt(10)
    v_mfma_f32_32x32x16_bf16 v[64:79], v[116:119], v[20:23], v[64:79]
    v_exp_f32 v168, v168
    v_exp_f32 v169, v169
    v_exp_f32 v170, v170
    v_exp_f32 v171, v171
    v_mfma_f32_32x32x16_bf16 v[80:95], v[116:119], v[28:31], v[80:95]
    v_exp_f32 v172, v172
    v_exp_f32 v173, v173
    v_exp_f32 v174, v174
    v_exp_f32 v175, v175
    buffer_load_dwordx4 v[136:139], v2, s[16:19], s35 offen offset:0
    buffer_load_dwordx4 v[140:143], v2, s[16:19], s35 offen offset:1024
    s_add_u32 s35, s35, 2048
    v_cvt_pk_bf16_f32 v96, v160, v161
    v_cvt_pk_bf16_f32 v97, v162, v163
    v_cvt_pk_bf16_f32 v98, v164, v165
    v_cvt_pk_bf16_f32 v99, v166, v167
    v_cvt_pk_bf16_f32 v100, v168, v169
    v_cvt_pk_bf16_f32 v101, v170, v171
    v_cvt_pk_bf16_f32 v102, v172, v173
    v_cvt_pk_bf16_f32 v103, v174, v175
    v_mfma_f32_32x32x16_bf16 v[32:47], v[248:251], v[96:99], v[32:47]
    v_exp_f32 v176, v176
    v_exp_f32 v177, v177
    v_exp_f32 v178, v178
    v_exp_f32 v179, v179
    v_mfma_f32_32x32x16_bf16 v[32:47], v[252:255], v[100:103], v[32:47]
    v_exp_f32 v180, v180
    v_exp_f32 v181, v181
    v_exp_f32 v182, v182
    v_exp_f32 v183, v183
    v_exp_f32 v184, v184
    v_exp_f32 v185, v185
    v_exp_f32 v186, v186
    v_exp_f32 v187, v187
    v_exp_f32 v188, v188
    v_exp_f32 v189, v189
    v_exp_f32 v190, v190
    v_exp_f32 v191, v191
    v_cvt_pk_bf16_f32 v104, v176, v177
    v_cvt_pk_bf16_f32 v105, v178, v179
    v_cvt_pk_bf16_f32 v106, v180, v181
    v_cvt_pk_bf16_f32 v107, v182, v183
    v_cvt_pk_bf16_f32 v108, v184, v185
    v_cvt_pk_bf16_f32 v109, v186, v187
    v_cvt_pk_bf16_f32 v110, v188, v189
    v_cvt_pk_bf16_f32 v111, v190, v191
    v_mfma_f32_32x32x16_bf16 v[48:63], v[248:251], v[104:107], v[48:63]
    s_nop 0
    v_mfma_f32_32x32x16_bf16 v[48:63], v[252:255], v[108:111], v[48:63]
    s_add_u32 s37, s37, 1
    s_cmp_lt_u32 s37, 4
    s_nop 9
    s_cbranch_scc1 k2b_kernel_loop2
    s_waitcnt vmcnt(0) lgkmcnt(0)
    v_and_b32 v4, 31, v1
    v_lshlrev_b32 v4, 2, v4
    s_lshl_b32 s38, s32, 8
    v_add_u32 v5, s38, v4
    ds_write_b32 v5, v144
    ds_write_b32 v5, v145 offset:128
    s_waitcnt lgkmcnt(0)
    s_barrier
    ds_read_b32 v146, v4 offset:0
    ds_read_b32 v150, v4 offset:128
    ds_read_b32 v147, v4 offset:256
    ds_read_b32 v151, v4 offset:384
    ds_read_b32 v148, v4 offset:512
    ds_read_b32 v152, v4 offset:640
    ds_read_b32 v149, v4 offset:768
    ds_read_b32 v153, v4 offset:896
    s_waitcnt lgkmcnt(3)
    v_max3_f32 v146, v146, v147, v148
    s_waitcnt lgkmcnt(1)
    v_max_f32 v146, v146, v149
    v_max3_f32 v150, v150, v151, v152
    s_waitcnt lgkmcnt(0)
    v_max_f32 v150, v150, v153
    v_sub_f32 v146, v144, v146
    v_sub_f32 v150, v145, v150
    v_exp_f32 v146, v146
    v_exp_f32 v150, v150
    v_mul_f32 v32, v32, v146
    v_mul_f32 v48, v48, v150
    v_mul_f32 v33, v33, v146
    v_mul_f32 v49, v49, v150
    v_mul_f32 v34, v34, v146
    v_mul_f32 v50, v50, v150
    v_mul_f32 v35, v35, v146
    v_mul_f32 v51, v51, v150
    v_mul_f32 v36, v36, v146
    v_mul_f32 v52, v52, v150
    v_mul_f32 v37, v37, v146
    v_mul_f32 v53, v53, v150
    v_mul_f32 v38, v38, v146
    v_mul_f32 v54, v54, v150
    v_mul_f32 v39, v39, v146
    v_mul_f32 v55, v55, v150
    v_mul_f32 v40, v40, v146
    v_mul_f32 v56, v56, v150
    v_mul_f32 v41, v41, v146
    v_mul_f32 v57, v57, v150
    v_mul_f32 v42, v42, v146
    v_mul_f32 v58, v58, v150
    v_mul_f32 v43, v43, v146
    v_mul_f32 v59, v59, v150
    v_mul_f32 v44, v44, v146
    v_mul_f32 v60, v60, v150
    v_mul_f32 v45, v45, v146
    v_mul_f32 v61, v61, v150
    v_mul_f32 v46, v46, v146
    v_mul_f32 v62, v62, v150
    v_mul_f32 v47, v47, v146
    v_mul_f32 v63, v63, v150
    s_lshl_b32 s38, s32, 13
    v_add_u32 v5, s38, v3
    ds_write_b128 v5, v[32:35] offset:1024
    ds_write_b128 v5, v[36:39] offset:2048
    ds_write_b128 v5, v[40:43] offset:3072
    ds_write_b128 v5, v[44:47] offset:4096
    ds_write_b128 v5, v[48:51] offset:5120
    ds_write_b128 v5, v[52:55] offset:6144
    ds_write_b128 v5, v[56:59] offset:7168
    ds_write_b128 v5, v[60:63] offset:8192
    s_waitcnt lgkmcnt(0)
    s_barrier
    s_and_b32 s38, s32, 1
    s_lshr_b32 s39, s32, 1
    s_lshl_b32 s41, s38, 12
    s_lshl_b32 s42, s39, 11
    s_add_u32 s41, s41, s42
    v_add_u32 v5, s41, v3
    ds_read_b128 v[64:67], v5 offset:1024
    ds_read_b128 v[68:71], v5 offset:2048
    ds_read_b128 v[72:75], v5 offset:9216
    ds_read_b128 v[76:79], v5 offset:10240
    ds_read_b128 v[80:83], v5 offset:17408
    ds_read_b128 v[84:87], v5 offset:18432
    ds_read_b128 v[88:91], v5 offset:25600
    ds_read_b128 v[92:95], v5 offset:26624
    v_and_b32 v6, 31, v1
    v_lshlrev_b32 v6, 4, v6
    s_lshl_b32 s41, s38, 12
    v_add_u32 v6, s41, v6
    ds_read_b32 v100, v6 offset:4608
    ds_read_b32 v101, v6 offset:12800
    ds_read_b32 v102, v6 offset:20992
    ds_read_b32 v103, v6 offset:29184
    s_waitcnt lgkmcnt(9)
    v_add_f32 v64, v64, v72
    s_waitcnt lgkmcnt(5)
    v_add_f32 v80, v80, v88
    v_add_f32 v64, v64, v80
    v_add_f32 v65, v65, v73
    v_add_f32 v81, v81, v89
    v_add_f32 v65, v65, v81
    v_add_f32 v66, v66, v74
    v_add_f32 v82, v82, v90
    v_add_f32 v66, v66, v82
    v_add_f32 v67, v67, v75
    v_add_f32 v83, v83, v91
    v_add_f32 v67, v67, v83
    v_add_f32 v68, v68, v76
    s_waitcnt lgkmcnt(4)
    v_add_f32 v84, v84, v92
    v_add_f32 v68, v68, v84
    v_add_f32 v69, v69, v77
    v_add_f32 v85, v85, v93
    v_add_f32 v69, v69, v85
    v_add_f32 v70, v70, v78
    v_add_f32 v86, v86, v94
    v_add_f32 v70, v70, v86
    v_add_f32 v71, v71, v79
    v_add_f32 v87, v87, v95
    v_add_f32 v71, v71, v87
    s_waitcnt lgkmcnt(2)
    v_add_f32 v100, v100, v101
    s_waitcnt lgkmcnt(0)
    v_add_f32 v102, v102, v103
    v_add_f32 v100, v100, v102
    v_rcp_f32 v100, v100
    s_nop 0
    v_mul_f32 v64, v64, v100
    v_mul_f32 v65, v65, v100
    v_mul_f32 v66, v66, v100
    v_mul_f32 v67, v67, v100
    v_mul_f32 v68, v68, v100
    v_mul_f32 v69, v69, v100
    v_mul_f32 v70, v70, v100
    v_mul_f32 v71, v71, v100
    s_lshl_b32 s41, s31, 1
    s_add_u32 s41, s41, s38
    s_mul_i32 s41, s41, 28672
    s_mul_i32 s42, s30, 28
    s_lshl_b32 s43, s39, 4
    s_add_u32 s42, s42, s43
    v_lshrrev_b32 v7, 5, v1
    v_lshlrev_b32 v7, 2, v7
    v_and_b32 v8, 31, v1
    v_add_u32 v9, 0, v7
    v_add_u32 v9, s42, v9
    v_lshrrev_b32 v10, 4, v9
    v_lshlrev_b32 v10, 10, v10
    v_bfe_u32 v11, v9, 3, 1
    v_lshl_add_u32 v11, v11, 5, v8
    v_lshl_add_u32 v10, v11, 4, v10
    v_and_b32 v11, 7, v9
    v_lshl_add_u32 v10, v11, 1, v10
    v_cvt_pk_bf16_f32 v12, v64, v65
    v_cvt_pk_bf16_f32 v13, v66, v67
    s_mul_i32 s43, s30, 28
    v_subrev_u32 v14, s43, v9
    v_cmp_gt_u32 vcc, 28, v14
    s_and_saveexec_b64 s[44:45], vcc
    buffer_store_dwordx2 v[12:13], v10, s[24:27], s41 offen
    s_mov_b64 exec, s[44:45]
    v_add_u32 v9, 8, v7
    v_add_u32 v9, s42, v9
    v_lshrrev_b32 v10, 4, v9
    v_lshlrev_b32 v10, 10, v10
    v_bfe_u32 v11, v9, 3, 1
    v_lshl_add_u32 v11, v11, 5, v8
    v_lshl_add_u32 v10, v11, 4, v10
    v_and_b32 v11, 7, v9
    v_lshl_add_u32 v10, v11, 1, v10
    v_cvt_pk_bf16_f32 v12, v68, v69
    v_cvt_pk_bf16_f32 v13, v70, v71
    s_mul_i32 s43, s30, 28
    v_subrev_u32 v14, s43, v9
    v_cmp_gt_u32 vcc, 28, v14
    s_and_saveexec_b64 s[44:45], vcc
    buffer_store_dwordx2 v[12:13], v10, s[24:27], s41 offen
    s_mov_b64 exec, s[44:45]
    s_endpgm
.section .rodata,"a"
.p2align 6
.amdhsa_kernel k2b_kernel
  .amdhsa_next_free_vgpr 256
  .amdhsa_next_free_sgpr 64
  .amdhsa_accum_offset 256
  .amdhsa_group_segment_fixed_size 0
  .amdhsa_kernarg_size 80
  .amdhsa_user_sgpr_count 2
  .amdhsa_user_sgpr_kernarg_segment_ptr 1
  .amdhsa_system_sgpr_workgroup_id_x 1
.end_amdhsa_kernel
.text
.globl k3b_kernel
.p2align 8
.type k3b_kernel,@function
k3b_kernel:
    s_cmp_ge_u32 s2, 224
    s_cbranch_scc0 k3b_kernel_go1
    s_endpgm
k3b_kernel_go1:
    s_load_dwordx2 s[4:5], s[0:1], 72
    s_waitcnt lgkmcnt(0)
    s_add_u32 s12, s4, 14680064
    s_addc_u32 s13, s5, 0
    s_mov_b32 s14, 1835008
    s_mov_b32 s15, 0x00020000
    s_add_u32 s16, s4, 1441792
    s_addc_u32 s17, s5, 0
    s_mov_b32 s18, 401408
    s_mov_b32 s19, 0x00020000
    s_add_u32 s20, s4, 18874368
    s_addc_u32 s21, s5, 0
    s_mov_b32 s22, 1835008
    s_mov_b32 s23, 0x00020000
    s_add_u32 s24, s4, 20971520
    s_addc_u32 s25, s5, 0
    s_mov_b32 s26, 1835008
    s_mov_b32 s27, 0x00020000
    s_add_u32 s28, s4, 32243712
    s_addc_u32 s29, s5, 0
    s_mov_b32 s30, 229376
    s_mov_b32 s31, 0x00020000
    v_lshrrev_b32 v1, 6, v0
    s_nop 0
    v_readfirstlane_b32 s32, v1
    s_and_b32 s33, s2, 7
    s_lshl_b32 s33, s33, 2
    s_bfe_u32 s34, s2, 0x20003
    s_add_u32 s33, s33, s34
    s_lshr_b32 s34, s2, 5
    v_and_b32 v1, 63, v0
    v_lshlrev_b32 v2, 4, v1
    s_lshr_b32 s35, s32, 1
    s_and_b32 s36, s32, 1
    s_lshl_b32 s37, s33, 6
    s_lshl_b32 s38, s35, 5
    s_add_u32 s37, s37, s38
    v_and_b32 v3, 31, v1
    v_add_u32 v3, s37, v3
    v_mul_u32_u24 v4, 896, v3
    v_lshrrev_b32 v5, 5, v1
    v_lshl_add_u32 v4, v5, 3, v4
    s_lshl_b32 s38, s34, 7
    s_lshl_b32 s39, s36, 6
    s_add_u32 s38, s38, s39
    buffer_load_dwordx2 v[8:9], v4, s[20:23], s38 offen offset:0
    buffer_load_dwordx2 v[10:11], v4, s[20:23], s38 offen offset:16
    buffer_load_dwordx2 v[12:13], v4, s[20:23], s38 offen offset:32
    buffer_load_dwordx2 v[14:15], v4, s[20:23], s38 offen offset:48
    s_mul_i32 s40, s32, 7168
    s_mul_i32 s41, s33, 57344
    s_add_u32 s41, s41, s40
    s_add_u32 s42, s41, 28672
    s_mul_i32 s43, s34, 57344
    s_add_u32 s43, s43, s40
    s_add_u32 s44, s43, 28672
    buffer_load_dwordx4 v[80:83], v2, s[12:15], s41 offen offset:0
    buffer_load_dwordx4 v[84:87], v2, s[12:15], s42 offen offset:0
    buffer_load_dwordx4 v[88:91], v2, s[16:19], s43 offen offset:0
    buffer_load_dwordx4 v[92:95], v2, s[16:19], s44 offen offset:0
    buffer_load_dwordx4 v[96:99], v2, s[12:15], s41 offen offset:1024
    buffer_load_dwordx4 v[100:103], v2, s[12:15], s42 offen offset:1024
    buffer_load_dwordx4 v[104:107], v2, s[16:19], s43 offen offset:1024
    buffer_load_dwordx4 v[108:111], v2, s[16:19], s44 offen offset:1024
    buffer_load_dwordx4 v[112:115], v2, s[12:15], s41 offen offset:2048
    buffer_load_dwordx4 v[116:119], v2, s[12:15], s42 offen offset:2048
    buffer_load_dwordx4 v[120:123], v2, s[16:19], s43 offen offset:2048
    buffer_load_dwordx4 v[124:127], v2, s[16:19], s44 offen offset:2048
    buffer_load_dwordx4 v[128:131], v2, s[12:15], s41 offen offset:3072
    buffer_load_dwordx4 v[132:135], v2, s[12:15], s42 offen offset:3072
    buffer_load_dwordx4 v[136:139], v2, s[16:19], s43 offen offset:3072
    buffer_load_dwordx4 v[140:143], v2, s[16:19], s44 offen offset:3072
    s_add_u32 s41, s41, 4096
    s_add_u32 s42, s42, 4096
    s_add_u32 s43, s43, 4096
    s_add_u32 s44, s44, 4096
    buffer_load_dwordx4 v[144:147], v2, s[12:15], s41 offen offset:0
    buffer_load_dwordx4 v[148:151], v2, s[12:15], s42 offen offset:0
    buffer_load_dwordx4 v[152:155], v2, s[16:19], s43 offen offset:0
    buffer_load_dwordx4 v[156:159], v2, s[16:19], s44 offen offset:0
    buffer_load_dwordx4 v[160:163], v2, s[12:15], s41 offen offset:1024
    buffer_load_dwordx4 v[164:167], v2, s[12:15], s42 offen offset:1024
    buffer_load_dwordx4 v[168:171], v2, s[16:19], s43 offen offset:1024
    buffer_load_dwordx4 v[172:175], v2, s[16:19], s44 offen offset:1024
    buffer_load_dwordx4 v[176:179], v2, s[12:15], s41 offen offset:2048
    buffer_load_dwordx4 v[180:183], v2, s[12:15], s42 offen offset:2048
    buffer_load_dwordx4 v[184:187], v2, s[16:19], s43 offen offset:2048
    buffer_load_dwordx4 v[188:191], v2, s[16:19], s44 offen offset:2048
    s_add_u32 s41, s41, 3072
    s_add_u32 s42, s42, 3072
    s_add_u32 s43, s43, 3072
    s_add_u32 s44, s44, 3072
    s_waitcnt vmcnt(25)
    v_mfma_f32_32x32x16_bf16 v[16:31], v[88:91], v[80:83], 0
    s_waitcnt vmcnt(24)
    v_mfma_f32_32x32x16_bf16 v[32:47], v[92:95], v[80:83], 0
    v_mfma_f32_32x32x16_bf16 v[48:63], v[88:91], v[84:87], 0
    v_mfma_f32_32x32x16_bf16 v[64:79], v[92:95], v[84:87], 0
    s_waitcnt vmcnt(21)
    v_mfma_f32_32x32x16_bf16 v[16:31], v[104:107], v[96:99], v[16:31]
    s_waitcnt vmcnt(20)
    v_mfma_f32_32x32x16_bf16 v[32:47], v[108:111], v[96:99], v[32:47]
    v_mfma_f32_32x32x16_bf16 v[48:63], v[104:107], v[100:103], v[48:63]
    v_mfma_f32_32x32x16_bf16 v[64:79], v[108:111], v[100:103], v[64:79]
    s_waitcnt vmcnt(17)
    v_mfma_f32_32x32x16_bf16 v[16:31], v[120:123], v[112:115], v[16:31]
    s_waitcnt vmcnt(16)
    v_mfma_f32_32x32x16_bf16 v[32:47], v[124:127], v[112:115], v[32:47]
    v_mfma_f32_32x32x16_bf16 v[48:63], v[120:123], v[116:119], v[48:63]
    v_mfma_f32_32x32x16_bf16 v[64:79], v[124:127], v[116:119], v[64:79]
    s_waitcnt vmcnt(13)
    v_mfma_f32_32x32x16_bf16 v[16:31], v[136:139], v[128:131], v[16:31]
    s_waitcnt vmcnt(12)
    v_mfma_f32_32x32x16_bf16 v[32:47], v[140:143], v[128:131], v[32:47]
    v_mfma_f32_32x32x16_bf16 v[48:63], v[136:139], v[132:135], v[48:63]
    v_mfma_f32_32x32x16_bf16 v[64:79], v[140:143], v[132:135], v[64:79]
    s_waitcnt vmcnt(9)
    v_mfma_f32_32x32x16_bf16 v[16:31], v[152:155], v[144:147], v[16:31]
    s_waitcnt vmcnt(8)
    v_mfma_f32_32x32x16_bf16 v[32:47], v[156:159], v[144:147], v[32:47]
    v_mfma_f32_32x32x16_bf16 v[48:63], v[152:155], v[148:151], v[48:63]
    v_mfma_f32_32x32x16_bf16 v[64:79], v[156:159], v[148:151], v[64:79]
    s_waitcnt vmcnt(5)
    v_mfma_f32_32x32x16_bf16 v[16:31], v[168:171], v[160:163], v[16:31]
    s_waitcnt vmcnt(4)
    v_mfma_f32_32x32x16_bf16 v[32:47], v[172:175], v[160:163], v[32:47]
    v_mfma_f32_32x32x16_bf16 v[48:63], v[168:171], v[164:167], v[48:63]
    v_mfma_f32_32x32x16_bf16 v[64:79], v[172:175], v[164:167], v[64:79]
    s_waitcnt vmcnt(1)
    v_mfma_f32_32x32x16_bf16 v[16:31], v[184:187], v[176:179], v[16:31]
    s_waitcnt vmcnt(0)
    v_mfma_f32_32x32x16_bf16 v[32:47], v[188:191], v[176:179], v[32:47]
    v_mfma_f32_32x32x16_bf16 v[48:63], v[184:187], v[180:183], v[48:63]
    v_mfma_f32_32x32x16_bf16 v[64:79], v[188:191], v[180:183], v[64:79]
    s_lshl_b32 s40, s32, 14
    v_add_u32 v5, s40, v2
    s_nop 5
    ds_write_b128 v5, v[16:19] offset:0
    ds_write_b128 v5, v[20:23] offset:1024
    ds_write_b128 v5, v[24:27] offset:2048
    ds_write_b128 v5, v[28:31] offset:3072
    ds_write_b128 v5, v[32:35] offset:4096
    ds_write_b128 v5, v[36:39] offset:5120
    ds_write_b128 v5, v[40:43] offset:6144
    ds_write_b128 v5, v[44:47] offset:7168
    ds_write_b128 v5, v[48:51] offset:8192
    ds_write_b128 v5, v[52:55] offset:9216
    ds_write_b128 v5, v[56:59] offset:10240
    ds_write_b128 v5, v[60:63] offset:11264
    ds_write_b128 v5, v[64:67] offset:12288
    ds_write_b128 v5, v[68:71] offset:13312
    ds_write_b128 v5, v[72:75] offset:14336
    ds_write_b128 v5, v[76:79] offset:15360
    s_waitcnt lgkmcnt(0)
    s_barrier
    s_lshl_b32 s40, s32, 12
    v_add_u32 v5, s40, v2
    ds_read_b128 v[80:83], v5 offset:0
    ds_read_b128 v[84:87], v5 offset:1024
    ds_read_b128 v[88:91], v5 offset:2048
    ds_read_b128 v[92:95], v5 offset:3072
    ds_read_b128 v[96:99], v5 offset:16384
    ds_read_b128 v[100:103], v5 offset:17408
    ds_read_b128 v[104:107], v5 offset:18432
    ds_read_b128 v[108:111], v5 offset:19456
    ds_read_b128 v[112:115], v5 offset:32768
    ds_read_b128 v[116:119], v5 offset:33792
    ds_read_b128 v[120:123], v5 offset:34816
    ds_read_b128 v[124:127], v5 offset:35840
    ds_read_b128 v[128:131], v5 offset:49152
    ds_read_b128 v[132:135], v5 offset:50176
    ds_read_b128 v[136:139], v5 offset:51200
    ds_read_b128 v[140:143], v5 offset:52224
    s_waitcnt lgkmcnt(11)
    v_add_f32 v80, v80, v96
    s_waitcnt lgkmcnt(3)
    v_add_f32 v112, v112, v128
    v_add_f32 v80, v80, v112
    v_add_f32 v81, v81, v97
    v_add_f32 v113, v113, v129
    v_add_f32 v81, v81, v113
    v_add_f32 v82, v82, v98
    v_add_f32 v114, v114, v130
    v_add_f32 v82, v82, v114
    v_add_f32 v83, v83, v99
    v_add_f32 v115, v115, v131
    v_add_f32 v83, v83, v115
    v_add_f32 v84, v84, v100
    s_waitcnt lgkmcnt(2)
    v_add_f32 v116, v116, v132
    v_add_f32 v84, v84, v116
    v_add_f32 v85, v85, v101
    v_add_f32 v117, v117, v133
    v_add_f32 v85, v85, v117
    v_add_f32 v86, v86, v102
    v_add_f32 v118, v118, v134
    v_add_f32 v86, v86, v118
    v_add_f32 v87, v87, v103
    v_add_f32 v119, v119, v135
    v_add_f32 v87, v87, v119
    v_add_f32 v88, v88, v104
    s_waitcnt lgkmcnt(1)
    v_add_f32 v120, v120, v136
    v_add_f32 v88, v88, v120
    v_add_f32 v89, v89, v105
    v_add_f32 v121, v121, v137
    v_add_f32 v89, v89, v121
    v_add_f32 v90, v90, v106
    v_add_f32 v122, v122, v138
    v_add_f32 v90, v90, v122
    v_add_f32 v91, v91, v107
    v_add_f32 v123, v123, v139
    v_add_f32 v91, v91, v123
    v_add_f32 v92, v92, v108
    s_waitcnt lgkmcnt(0)
    v_add_f32 v124, v124, v140
    v_add_f32 v92, v92, v124
    v_add_f32 v93, v93, v109
    v_add_f32 v125, v125, v141
    v_add_f32 v93, v93, v125
    v_add_f32 v94, v94, v110
    v_add_f32 v126, v126, v142
    v_add_f32 v94, v94, v126
    v_add_f32 v95, v95, v111
    v_add_f32 v127, v127, v143
    v_add_f32 v95, v95, v127
    v_mov_b32 v6, 0
    v_mov_b32 v7, 0
    v_mov_b32 v20, 0xffff0000
    v_lshlrev_b32 v16, 16, v8
    v_and_b32 v17, v20, v8
    v_add_f32 v80, v80, v16
    v_add_f32 v81, v81, v17
    v_cvt_pk_bf16_f32 v18, v80, v81
    v_lshlrev_b32 v16, 16, v18
    v_and_b32 v17, v20, v18
    v_add_f32 v6, v6, v16
    v_fma_f32 v7, v16, v16, v7
    v_add_f32 v6, v6, v17
    v_fma_f32 v7, v17, v17, v7
    v_lshlrev_b32 v16, 16, v9
    v_and_b32 v17, v20, v9
    v_add_f32 v82, v82, v16
    v_add_f32 v83, v83, v17
    v_cvt_pk_bf16_f32 v19, v82, v83
    v_lshlrev_b32 v16, 16, v19
    v_and_b32 v17, v20, v19
    v_add_f32 v6, v6, v16
    v_fma_f32 v7, v16, v16, v7
    v_add_f32 v6, v6, v17
    v_fma_f32 v7, v17, v17, v7
    buffer_store_dwordx2 v[18:19], v4, s[24:27], s38 offen offset:0
    v_lshlrev_b32 v16, 16, v10
    v_and_b32 v17, v20, v10
    v_add_f32 v84, v84, v16
    v_add_f32 v85, v85, v17
    v_cvt_pk_bf16_f32 v18, v84, v85
    v_lshlrev_b32 v16, 16, v18
    v_and_b32 v17, v20, v18
    v_add_f32 v6, v6, v16
    v_fma_f32 v7, v16, v16, v7
    v_add_f32 v6, v6, v17
    v_fma_f32 v7, v17, v17, v7
    v_lshlrev_b32 v16, 16, v11
    v_and_b32 v17, v20, v11
    v_add_f32 v86, v86, v16
    v_add_f32 v87, v87, v17
    v_cvt_pk_bf16_f32 v19, v86, v87
    v_lshlrev_b32 v16, 16, v19
    v_and_b32 v17, v20, v19
    v_add_f32 v6, v6, v16
    v_fma_f32 v7, v16, v16, v7
    v_add_f32 v6, v6, v17
    v_fma_f32 v7, v17, v17, v7
    buffer_store_dwordx2 v[18:19], v4, s[24:27], s38 offen offset:16
    v_lshlrev_b32 v16, 16, v12
    v_and_b32 v17, v20, v12
    v_add_f32 v88, v88, v16
    v_add_f32 v89, v89, v17
    v_cvt_pk_bf16_f32 v18, v88, v89
    v_lshlrev_b32 v16, 16, v18
    v_and_b32 v17, v20, v18
    v_add_f32 v6, v6, v16
    v_fma_f32 v7, v16, v16, v7
    v_add_f32 v6, v6, v17
    v_fma_f32 v7, v17, v17, v7
    v_lshlrev_b32 v16, 16, v13
    v_and_b32 v17, v20, v13
    v_add_f32 v90, v90, v16
    v_add_f32 v91, v91, v17
    v_cvt_pk_bf16_f32 v19, v90, v91
    v_lshlrev_b32 v16, 16, v19
    v_and_b32 v17, v20, v19
    v_add_f32 v6, v6, v16
    v_fma_f32 v7, v16, v16, v7
    v_add_f32 v6, v6, v17
    v_fma_f32 v7, v17, v17, v7
    buffer_store_dwordx2 v[18:19], v4, s[24:27], s38 offen offset:32
    v_lshlrev_b32 v16, 16, v14
    v_and_b32 v17, v20, v14
    v_add_f32 v92, v92, v16
    v_add_f32 v93, v93, v17
    v_cvt_pk_bf16_f32 v18, v92, v93
    v_lshlrev_b32 v16, 16, v18
    v_and_b32 v17, v20, v18
    v_add_f32 v6, v6, v16
    v_fma_f32 v7, v16, v16, v7
    v_add_f32 v6, v6, v17
    v_fma_f32 v7, v17, v17, v7
    v_lshlrev_b32 v16, 16, v15
    v_and_b32 v17, v20, v15
    v_add_f32 v94, v94, v16
    v_add_f32 v95, v95, v17
    v_cvt_pk_bf16_f32 v19, v94, v95
    v_lshlrev_b32 v16, 16, v19
    v_and_b32 v17, v20, v19
    v_add_f32 v6, v6, v16
    v_fma_f32 v7, v16, v16, v7
    v_add_f32 v6, v6, v17
    v_fma_f32 v7, v17, v17, v7
    buffer_store_dwordx2 v[18:19], v4, s[24:27], s38 offen offset:48
    v_mov_b32 v16, v6
    v_mov_b32 v17, v7
    s_nop 0
    v_permlane32_swap_b32 v6, v16
    v_permlane32_swap_b32 v7, v17
    v_add_f32 v6, v6, v16
    v_add_f32 v7, v7, v17
    v_mul_u32_u24 v5, 112, v3
    s_lshl_b32 s40, s34, 4
    s_lshl_b32 s41, s36, 3
    s_add_u32 s40, s40, s41
    v_cmp_gt_u32 vcc, 32, v1
    s_and_saveexec_b64 s[44:45], vcc
    buffer_store_dwordx2 v[6:7], v5, s[28:31], s40 offen
    s_endpgm
.section .rodata,"a"
.p2align 6
.amdhsa_kernel k3b_kernel
  .amdhsa_next_free_vgpr 208
  .amdhsa_next_free_sgpr 64
  .amdhsa_accum_offset 208
  .amdhsa_group_segment_fixed_size 0
  .amdhsa_kernarg_size 80
  .amdhsa_user_sgpr_count 2
  .amdhsa_user_sgpr_kernarg_segment_ptr 1
  .amdhsa_system_sgpr_workgroup_id_x 1
.end_amdhsa_kernel
.text
.globl k4b_kernel
.p2align 8
.type k4b_kernel,@function
k4b_kernel:
    s_cmp_ge_u32 s2, 224
    s_cbranch_scc0 k4b_kernel_go1
    s_endpgm
k4b_kernel_go1:
    s_load_dwordx2 s[4:5], s[0:1], 72
    s_waitcnt lgkmcnt(0)
    s_add_u32 s12, s4, 20971520
    s_addc_u32 s13, s5, 0
    s_mov_b32 s14, 1835008
    s_mov_b32 s15, 0x00020000
    s_add_u32 s16, s4, 2097152
    s_addc_u32 s17, s5, 0
    s_mov_b32 s18, 1605632
    s_mov_b32 s19, 0x00020000
    s_add_u32 s20, s4, 32243712
    s_addc_u32 s21, s5, 0
    s_mov_b32 s22, 229376
    s_mov_b32 s23, 0x00020000
    s_add_u32 s24, s4, 8134656
    s_addc_u32 s25, s5, 0
    s_mov_b32 s26, 7168
    s_mov_b32 s27, 0x00020000
    s_add_u32 s56, s4, 23068672
    s_addc_u32 s57, s5, 0
    s_mov_b32 s58, 7340032
    s_mov_b32 s59, 0x00020000
    s_add_u32 s48, s4, 4194304
    s_addc_u32 s49, s5, 0
    s_mov_b32 s50, 1605632
    s_mov_b32 s51, 0x00020000
    s_add_u32 s52, s4, 8142848
    s_addc_u32 s53, s5, 0
    s_mov_b32 s54, 7168
    s_mov_b32 s55, 0x00020000
    v_lshrrev_b32 v1, 6, v0
    s_nop 0
    v_readfirstlane_b32 s32, v1
    s_lshr_b32 s30, s2, 4
    s_and_b32 s31, s2, 15
    s_lshl_b32 s34, s31, 7
    s_lshl_b32 s33, s30, 2
    s_add_u32 s33, s33, s32
    s_mul_i32 s35, s33, 28672
    v_and_b32 v1, 63, v0
    v_lshlrev_b32 v2, 4, v1
    buffer_load_dwordx4 v[16:19], v2, s[16:19], s35 offen offset:0
    buffer_load_dwordx4 v[20:23], v2, s[48:51], s35 offen offset:0
    buffer_load_dwordx4 v[24:27], v2, s[16:19], s35 offen offset:1024
    buffer_load_dwordx4 v[28:31], v2, s[48:51], s35 offen offset:1024
    buffer_load_dwordx4 v[32:35], v2, s[16:19], s35 offen offset:2048
    buffer_load_dwordx4 v[36:39], v2, s[48:51], s35 offen offset:2048
    buffer_load_dwordx4 v[40:43], v2, s[16:19], s35 offen offset:3072
    buffer_load_dwordx4 v[44:47], v2, s[48:51], s35 offen offset:3072
    s_add_u32 s35, s35, 4096
    v_lshlrev_b32 v3, 4, v0
    s_mul_i32 s40, s34, 896
    s_add_u32 s41, s40, 0
    buffer_load_dwordx4 v[112:115], v3, s[12:15], s41 offen
    s_add_u32 s41, s40, 4096
    buffer_load_dwordx4 v[116:119], v3, s[12:15], s41 offen
    s_add_u32 s41, s40, 8192
    buffer_load_dwordx4 v[120:123], v3, s[12:15], s41 offen
    s_add_u32 s41, s40, 12288
    buffer_load_dwordx4 v[124:127], v3, s[12:15], s41 offen
    s_add_u32 s41, s40, 16384
    buffer_load_dwordx4 v[128:131], v3, s[12:15], s41 offen
    s_add_u32 s41, s40, 20480
    buffer_load_dwordx4 v[132:135], v3, s[12:15], s41 offen
    s_add_u32 s41, s40, 24576
    buffer_load_dwordx4 v[136:139], v3, s[12:15], s41 offen
    s_add_u32 s41, s40, 28672
    buffer_load_dwordx4 v[140:143], v3, s[12:15], s41 offen
    s_add_u32 s41, s40, 32768
    buffer_load_dwordx4 v[144:147], v3, s[12:15], s41 offen
    s_add_u32 s41, s40, 36864
    buffer_load_dwordx4 v[148:151], v3, s[12:15], s41 offen
    s_add_u32 s41, s40, 40960
    buffer_load_dwordx4 v[152:155], v3, s[12:15], s41 offen
    s_add_u32 s41, s40, 45056
    buffer_load_dwordx4 v[156:159], v3, s[12:15], s41 offen
    s_add_u32 s41, s40, 49152
    buffer_load_dwordx4 v[160:163], v3, s[12:15], s41 offen
    s_add_u32 s41, s40, 53248
    buffer_load_dwordx4 v[164:167], v3, s[12:15], s41 offen
    s_add_u32 s41, s40, 57344
    buffer_load_dwordx4 v[168:171], v3, s[12:15], s41 offen
    s_add_u32 s41, s40, 61440
    buffer_load_dwordx4 v[172:175], v3, s[12:15], s41 offen
    s_add_u32 s41, s40, 65536
    buffer_load_dwordx4 v[176:179], v3, s[12:15], s41 offen
    s_add_u32 s41, s40, 69632
    buffer_load_dwordx4 v[180:183], v3, s[12:15], s41 offen
    s_add_u32 s41, s40, 73728
    buffer_load_dwordx4 v[184:187], v3, s[12:15], s41 offen
    s_add_u32 s41, s40, 77824
    buffer_load_dwordx4 v[188:191], v3, s[12:15], s41 offen
    s_add_u32 s41, s40, 81920
    buffer_load_dwordx4 v[192:195], v3, s[12:15], s41 offen
    s_add_u32 s41, s40, 86016
    buffer_load_dwordx4 v[196:199], v3, s[12:15], s41 offen
    s_add_u32 s41, s40, 90112
    buffer_load_dwordx4 v[200:203], v3, s[12:15], s41 offen
    s_add_u32 s41, s40, 94208
    buffer_load_dwordx4 v[204:207], v3, s[12:15], s41 offen
    s_add_u32 s41, s40, 98304
    buffer_load_dwordx4 v[208:211], v3, s[12:15], s41 offen
    s_add_u32 s41, s40, 102400
    buffer_load_dwordx4 v[212:215], v3, s[12:15], s41 offen
    s_add_u32 s41, s40, 106496
    buffer_load_dwordx4 v[216:219], v3, s[12:15], s41 offen
    s_add_u32 s41, s40, 110592
    buffer_load_dwordx4 v[220:223], v3, s[12:15], s41 offen
    v_add_u32 v4, 0, v0
    v_mul_u32_u24 v5, 9363, v4
    v_lshrrev_b32 v5, 19, v5
    v_add_lshl_u32 v4, v4, v5, 4
    s_waitcnt vmcnt(27)
    ds_write_b128 v4, v[112:115] offset:1024
    v_add_u32 v4, 256, v0
    v_mul_u32_u24 v5, 9363, v4
    v_lshrrev_b32 v5, 19, v5
    v_add_lshl_u32 v4, v4, v5, 4
    s_waitcnt vmcnt(26)
    ds_write_b128 v4, v[116:119] offset:1024
    v_add_u32 v4, 512, v0
    v_mul_u32_u24 v5, 9363, v4
    v_lshrrev_b32 v5, 19, v5
    v_add_lshl_u32 v4, v4, v5, 4
    s_waitcnt vmcnt(25)
    ds_write_b128 v4, v[120:123] offset:1024
    v_add_u32 v4, 768, v0
    v_mul_u32_u24 v5, 9363, v4
    v_lshrrev_b32 v5, 19, v5
    v_add_lshl_u32 v4, v4, v5, 4
    s_waitcnt vmcnt(24)
    ds_write_b128 v4, v[124:127] offset:1024
    v_add_u32 v4, 1024, v0
    v_mul_u32_u24 v5, 9363, v4
    v_lshrrev_b32 v5, 19, v5
    v_add_lshl_u32 v4, v4, v5, 4
    s_waitcnt vmcnt(23)
    ds_write_b128 v4, v[128:131] offset:1024
    v_add_u32 v4, 1280, v0
    v_mul_u32_u24 v5, 9363, v4
    v_lshrrev_b32 v5, 19, v5
    v_add_lshl_u32 v4, v4, v5, 4
    s_waitcnt vmcnt(22)
    ds_write_b128 v4, v[132:135] offset:1024
    v_add_u32 v4, 1536, v0
    v_mul_u32_u24 v5, 9363, v4
    v_lshrrev_b32 v5, 19, v5
    v_add_lshl_u32 v4, v4, v5, 4
    s_waitcnt vmcnt(21)
    ds_write_b128 v4, v[136:139] offset:1024
    s_waitcnt lgkmcnt(0)
    v_add_u32 v7, s34, v0
    v_and_b32 v7, 2047, v7
    v_mul_u32_u24 v7, 112, v7
    buffer_load_dwordx4 v[112:115], v7, s[20:23], 0 offen offset:0
    buffer_load_dwordx4 v[116:119], v7, s[20:23], 0 offen offset:16
    buffer_load_dwordx4 v[120:123], v7, s[20:23], 0 offen offset:32
    buffer_load_dwordx4 v[124:127], v7, s[20:23], 0 offen offset:48
    buffer_load_dwordx4 v[128:131], v7, s[20:23], 0 offen offset:64
    buffer_load_dwordx4 v[132:135], v7, s[20:23], 0 offen offset:80
    buffer_load_dwordx4 v[136:139], v7, s[20:23], 0 offen offset:96
    v_add_u32 v4, 1792, v0
    v_mul_u32_u24 v5, 9363, v4
    v_lshrrev_b32 v5, 19, v5
    v_add_lshl_u32 v4, v4, v5, 4
    s_waitcnt vmcnt(27)
    ds_write_b128 v4, v[140:143] offset:1024
    v_add_u32 v4, 2048, v0
    v_mul_u32_u24 v5, 9363, v4
    v_lshrrev_b32 v5, 19, v5
    v_add_lshl_u32 v4, v4, v5, 4
    s_waitcnt vmcnt(26)
    ds_write_b128 v4, v[144:147] offset:1024
    v_add_u32 v4, 2304, v0
    v_mul_u32_u24 v5, 9363, v4
    v_lshrrev_b32 v5, 19, v5
    v_add_lshl_u32 v4, v4, v5, 4
    s_waitcnt vmcnt(25)
    ds_write_b128 v4, v[148:151] offset:1024
    v_add_u32 v4, 2560, v0
    v_mul_u32_u24 v5, 9363, v4
    v_lshrrev_b32 v5, 19, v5
    v_add_lshl_u32 v4, v4, v5, 4
    s_waitcnt vmcnt(24)
    ds_write_b128 v4, v[152:155] offset:1024
    v_add_u32 v4, 2816, v0
    v_mul_u32_u24 v5, 9363, v4
    v_lshrrev_b32 v5, 19, v5
    v_add_lshl_u32 v4, v4, v5, 4
    s_waitcnt vmcnt(23)
    ds_write_b128 v4, v[156:159] offset:1024
    v_add_u32 v4, 3072, v0
    v_mul_u32_u24 v5, 9363, v4
    v_lshrrev_b32 v5, 19, v5
    v_add_lshl_u32 v4, v4, v5, 4
    s_waitcnt vmcnt(22)
    ds_write_b128 v4, v[160:163] offset:1024
    v_add_u32 v4, 3328, v0
    v_mul_u32_u24 v5, 9363, v4
    v_lshrrev_b32 v5, 19, v5
    v_add_lshl_u32 v4, v4, v5, 4
    s_waitcnt vmcnt(21)
    ds_write_b128 v4, v[164:167] offset:1024
    v_add_u32 v4, 3584, v0
    v_mul_u32_u24 v5, 9363, v4
    v_lshrrev_b32 v5, 19, v5
    v_add_lshl_u32 v4, v4, v5, 4
    s_waitcnt vmcnt(20)
    ds_write_b128 v4, v[168:171] offset:1024
    v_add_u32 v4, 3840, v0
    v_mul_u32_u24 v5, 9363, v4
    v_lshrrev_b32 v5, 19, v5
    v_add_lshl_u32 v4, v4, v5, 4
    s_waitcnt vmcnt(19)
    ds_write_b128 v4, v[172:175] offset:1024
    v_add_u32 v4, 4096, v0
    v_mul_u32_u24 v5, 9363, v4
    v_lshrrev_b32 v5, 19, v5
    v_add_lshl_u32 v4, v4, v5, 4
    s_waitcnt vmcnt(18)
    ds_write_b128 v4, v[176:179] offset:1024
    v_add_u32 v4, 4352, v0
    v_mul_u32_u24 v5, 9363, v4
    v_lshrrev_b32 v5, 19, v5
    v_add_lshl_u32 v4, v4, v5, 4
    s_waitcnt vmcnt(17)
    ds_write_b128 v4, v[180:183] offset:1024
    v_add_u32 v4, 4608, v0
    v_mul_u32_u24 v5, 9363, v4
    v_lshrrev_b32 v5, 19, v5
    v_add_lshl_u32 v4, v4, v5, 4
    s_waitcnt vmcnt(16)
    ds_write_b128 v4, v[184:187] offset:1024
    v_add_u32 v4, 4864, v0
    v_mul_u32_u24 v5, 9363, v4
    v_lshrrev_b32 v5, 19, v5
    v_add_lshl_u32 v4, v4, v5, 4
    s_waitcnt vmcnt(15)
    ds_write_b128 v4, v[188:191] offset:1024
    v_add_u32 v4, 5120, v0
    v_mul_u32_u24 v5, 9363, v4
    v_lshrrev_b32 v5, 19, v5
    v_add_lshl_u32 v4, v4, v5, 4
    s_waitcnt vmcnt(14)
    ds_write_b128 v4, v[192:195] offset:1024
    v_add_u32 v4, 5376, v0
    v_mul_u32_u24 v5, 9363, v4
    v_lshrrev_b32 v5, 19, v5
    v_add_lshl_u32 v4, v4, v5, 4
    s_waitcnt vmcnt(13)
    ds_write_b128 v4, v[196:199] offset:1024
    v_add_u32 v4, 5632, v0
    v_mul_u32_u24 v5, 9363, v4
    v_lshrrev_b32 v5, 19, v5
    v_add_lshl_u32 v4, v4, v5, 4
    s_waitcnt vmcnt(12)
    ds_write_b128 v4, v[200:203] offset:1024
    v_add_u32 v4, 5888, v0
    v_mul_u32_u24 v5, 9363, v4
    v_lshrrev_b32 v5, 19, v5
    v_add_lshl_u32 v4, v4, v5, 4
    s_waitcnt vmcnt(11)
    ds_write_b128 v4, v[204:207] offset:1024
    v_add_u32 v4, 6144, v0
    v_mul_u32_u24 v5, 9363, v4
    v_lshrrev_b32 v5, 19, v5
    v_add_lshl_u32 v4, v4, v5, 4
    s_waitcnt vmcnt(10)
    ds_write_b128 v4, v[208:211] offset:1024
    v_add_u32 v4, 6400, v0
    v_mul_u32_u24 v5, 9363, v4
    v_lshrrev_b32 v5, 19, v5
    v_add_lshl_u32 v4, v4, v5, 4
    s_waitcnt vmcnt(9)
    ds_write_b128 v4, v[212:215] offset:1024
    v_add_u32 v4, 6656, v0
    v_mul_u32_u24 v5, 9363, v4
    v_lshrrev_b32 v5, 19, v5
    v_add_lshl_u32 v4, v4, v5, 4
    s_waitcnt vmcnt(8)
    ds_write_b128 v4, v[216:219] offset:1024
    v_add_u32 v4, 6912, v0
    v_mul_u32_u24 v5, 9363, v4
    v_lshrrev_b32 v5, 19, v5
    v_add_lshl_u32 v4, v4, v5, 4
    s_waitcnt vmcnt(7)
    ds_write_b128 v4, v[220:223] offset:1024
    v_cmp_gt_u32 vcc, 128, v0
    s_and_saveexec_b64 s[42:43], vcc
    s_cbranch_execz k4b_kernel_st2
    v_mov_b32 v5, 0
    v_mov_b32 v6, 0
    s_waitcnt vmcnt(6)
    v_add_f32 v5, v5, v112
    v_add_f32 v6, v6, v113
    v_add_f32 v5, v5, v114
    v_add_f32 v6, v6, v115
    s_waitcnt vmcnt(5)
    v_add_f32 v5, v5, v116
    v_add_f32 v6, v6, v117
    v_add_f32 v5, v5, v118
    v_add_f32 v6, v6, v119
    s_waitcnt vmcnt(4)
    v_add_f32 v5, v5, v120
    v_add_f32 v6, v6, v121
    v_add_f32 v5, v5, v122
    v_add_f32 v6, v6, v123
    s_waitcnt vmcnt(3)
    v_add_f32 v5, v5, v124
    v_add_f32 v6, v6, v125
    v_add_f32 v5, v5, v126
    v_add_f32 v6, v6, v127
    s_waitcnt vmcnt(2)
    v_add_f32 v5, v5, v128
    v_add_f32 v6, v6, v129
    v_add_f32 v5, v5, v130
    v_add_f32 v6, v6, v131
    s_waitcnt vmcnt(1)
    v_add_f32 v5, v5, v132
    v_add_f32 v6, v6, v133
    v_add_f32 v5, v5, v134
    v_add_f32 v6, v6, v135
    s_waitcnt vmcnt(0)
    v_add_f32 v5, v5, v136
    v_add_f32 v6, v6, v137
    v_add_f32 v5, v5, v138
    v_add_f32 v6, v6, v139
    v_mul_f32 v5, 0.002232142857142857, v5
    v_mul_f32 v6, 0.002232142857142857, v6
    v_fma_f32 v6, -v5, v5, v6
    v_max_f32 v6, 0, v6
    v_add_f32 v6, 1e-05, v6
    v_rsq_f32 v6, v6
    s_nop 0
    v_mul_f32 v5, v5, v6
    v_lshlrev_b32 v4, 2, v0
    ds_write_b32 v4, v6 offset:0
    ds_write_b32 v4, v5 offset:512
k4b_kernel_st2:
    s_waitcnt vmcnt(0)
    s_mov_b64 exec, s[42:43]
    s_waitcnt lgkmcnt(0)
    s_barrier
    v_and_b32 v3, 31, v1
    v_mul_u32_u24 v3, 912, v3
    v_lshrrev_b32 v4, 5, v1
    v_lshl_add_u32 v8, v4, 4, v3
    v_add_u32 v9, 58368, v8
    ds_read_b128 v[80:83], v8 offset:1024
    ds_read_b128 v[84:87], v8 offset:30208
    ds_read_b128 v[88:91], v9 offset:1024
    ds_read_b128 v[92:95], v9 offset:30208
    buffer_load_dwordx4 v[48:51], v2, s[16:19], s35 offen offset:0
    buffer_load_dwordx4 v[52:55], v2, s[48:51], s35 offen offset:0
    buffer_load_dwordx4 v[56:59], v2, s[16:19], s35 offen offset:1024
    buffer_load_dwordx4 v[60:63], v2, s[48:51], s35 offen offset:1024
    buffer_load_dwordx4 v[64:67], v2, s[16:19], s35 offen offset:2048
    buffer_load_dwordx4 v[68:71], v2, s[48:51], s35 offen offset:2048
    buffer_load_dwordx4 v[72:75], v2, s[16:19], s35 offen offset:3072
    buffer_load_dwordx4 v[76:79], v2, s[48:51], s35 offen offset:3072
    s_add_u32 s35, s35, 4096
    ds_read_b128 v[96:99], v8 offset:1056
    ds_read_b128 v[100:103], v8 offset:30240
    ds_read_b128 v[104:107], v9 offset:1056
    ds_read_b128 v[108:111], v9 offset:30240
    s_waitcnt lgkmcnt(7)
    v_mfma_f32_32x32x16_bf16 v[112:127], v[16:19], v[80:83], 0
    v_mfma_f32_32x32x16_bf16 v[176:191], v[20:23], v[80:83], 0
    s_waitcnt lgkmcnt(6)
    v_mfma_f32_32x32x16_bf16 v[128:143], v[16:19], v[84:87], 0
    v_mfma_f32_32x32x16_bf16 v[192:207], v[20:23], v[84:87], 0
    s_waitcnt lgkmcnt(5)
    v_mfma_f32_32x32x16_bf16 v[144:159], v[16:19], v[88:91], 0
    v_mfma_f32_32x32x16_bf16 v[208:223], v[20:23], v[88:91], 0
    s_waitcnt lgkmcnt(4)
    v_mfma_f32_32x32x16_bf16 v[160:175], v[16:19], v[92:95], 0
    v_mfma_f32_32x32x16_bf16 v[224:239], v[20:23], v[92:95], 0
    ds_read_b128 v[80:83], v8 offset:1088
    ds_read_b128 v[84:87], v8 offset:30272
    ds_read_b128 v[88:91], v9 offset:1088
    ds_read_b128 v[92:95], v9 offset:30272
    s_waitcnt lgkmcnt(7)
    v_mfma_f32_32x32x16_bf16 v[112:127], v[24:27], v[96:99], v[112:127]
    v_mfma_f32_32x32x16_bf16 v[176:191], v[28:31], v[96:99], v[176:191]
    s_waitcnt lgkmcnt(6)
    v_mfma_f32_32x32x16_bf16 v[128:143], v[24:27], v[100:103], v[128:143]
    v_mfma_f32_32x32x16_bf16 v[192:207], v[28:31], v[100:103], v[192:207]
    s_waitcnt lgkmcnt(5)
    v_mfma_f32_32x32x16_bf16 v[144:159], v[24:27], v[104:107], v[144:159]
    v_mfma_f32_32x32x16_bf16 v[208:223], v[28:31], v[104:107], v[208:223]
    s_waitcnt lgkmcnt(4)
    v_mfma_f32_32x32x16_bf16 v[160:175], v[24:27], v[108:111], v[160:175]
    v_mfma_f32_32x32x16_bf16 v[224:239], v[28:31], v[108:111], v[224:239]
    ds_read_b128 v[96:99], v8 offset:1120
    ds_read_b128 v[100:103], v8 offset:30304
    ds_read_b128 v[104:107], v9 offset:1120
    ds_read_b128 v[108:111], v9 offset:30304
    s_waitcnt lgkmcnt(7)
    v_mfma_f32_32x32x16_bf16 v[112:127], v[32:35], v[80:83], v[112:127]
    v_mfma_f32_32x32x16_bf16 v[176:191], v[36:39], v[80:83], v[176:191]
    s_waitcnt lgkmcnt(6)
    v_mfma_f32_32x32x16_bf16 v[128:143], v[32:35], v[84:87], v[128:143]
    v_mfma_f32_32x32x16_bf16 v[192:207], v[36:39], v[84:87], v[192:207]
    s_waitcnt lgkmcnt(5)
    v_mfma_f32_32x32x16_bf16 v[144:159], v[32:35], v[88:91], v[144:159]
    v_mfma_f32_32x32x16_bf16 v[208:223], v[36:39], v[88:91], v[208:223]
    s_waitcnt lgkmcnt(4)
    v_mfma_f32_32x32x16_bf16 v[160:175], v[32:35], v[92:95], v[160:175]
    v_mfma_f32_32x32x16_bf16 v[224:239], v[36:39], v[92:95], v[224:239]
    ds_read_b128 v[80:83], v8 offset:1152
    ds_read_b128 v[84:87], v8 offset:30336
    ds_read_b128 v[88:91], v9 offset:1152
    ds_read_b128 v[92:95], v9 offset:30336
    s_waitcnt lgkmcnt(7)
    v_mfma_f32_32x32x16_bf16 v[112:127], v[40:43], v[96:99], v[112:127]
    v_mfma_f32_32x32x16_bf16 v[176:191], v[44:47], v[96:99], v[176:191]
    s_waitcnt lgkmcnt(6)
    v_mfma_f32_32x32x16_bf16 v[128:143], v[40:43], v[100:103], v[128:143]
    v_mfma_f32_32x32x16_bf16 v[192:207], v[44:47], v[100:103], v[192:207]
    s_waitcnt lgkmcnt(5)
    v_mfma_f32_32x32x16_bf16 v[144:159], v[40:43], v[104:107], v[144:159]
    v_mfma_f32_32x32x16_bf16 v[208:223], v[44:47], v[104:107], v[208:223]
    s_waitcnt lgkmcnt(4)
    v_mfma_f32_32x32x16_bf16 v[160:175], v[40:43], v[108:111], v[160:175]
    v_mfma_f32_32x32x16_bf16 v[224:239], v[44:47], v[108:111], v[224:239]
    buffer_load_dwordx4 v[16:19], v2, s[16:19], s35 offen offset:0
    buffer_load_dwordx4 v[20:23], v2, s[48:51], s35 offen offset:0
    buffer_load_dwordx4 v[24:27], v2, s[16:19], s35 offen offset:1024
    buffer_load_dwordx4 v[28:31], v2, s[48:51], s35 offen offset:1024
    buffer_load_dwordx4 v[32:35], v2, s[16:19], s35 offen offset:2048
    buffer_load_dwordx4 v[36:39], v2, s[48:51], s35 offen offset:2048
    buffer_load_dwordx4 v[40:43], v2, s[16:19], s35 offen offset:3072
    buffer_load_dwordx4 v[44:47], v2, s[48:51], s35 offen offset:3072
    s_add_u32 s35, s35, 4096
    ds_read_b128 v[96:99], v8 offset:1184
    ds_read_b128 v[100:103], v8 offset:30368
    ds_read_b128 v[104:107], v9 offset:1184
    ds_read_b128 v[108:111], v9 offset:30368
    s_waitcnt vmcnt(15) lgkmcnt(7)
    v_mfma_f32_32x32x16_bf16 v[112:127], v[48:51], v[80:83], v[112:127]
    s_waitcnt vmcnt(14)
    v_mfma_f32_32x32x16_bf16 v[176:191], v[52:55], v[80:83], v[176:191]
    s_waitcnt lgkmcnt(6)
    v_mfma_f32_32x32x16_bf16 v[128:143], v[48:51], v[84:87], v[128:143]
    v_mfma_f32_32x32x16_bf16 v[192:207], v[52:55], v[84:87], v[192:207]
    s_waitcnt lgkmcnt(5)
    v_mfma_f32_32x32x16_bf16 v[144:159], v[48:51], v[88:91], v[144:159]
    v_mfma_f32_32x32x16_bf16 v[208:223], v[52:55], v[88:91], v[208:223]
    s_waitcnt lgkmcnt(4)
    v_mfma_f32_32x32x16_bf16 v[160:175], v[48:51], v[92:95], v[160:175]
    v_mfma_f32_32x32x16_bf16 v[224:239], v[52:55], v[92:95], v[224:239]
    ds_read_b128 v[80:83], v8 offset:1216
    ds_read_b128 v[84:87], v8 offset:30400
    ds_read_b128 v[88:91], v9 offset:1216
    ds_read_b128 v[92:95], v9 offset:30400
    s_waitcnt vmcnt(13) lgkmcnt(7)
    v_mfma_f32_32x32x16_bf16 v[112:127], v[56:59], v[96:99], v[112:127]
    s_waitcnt vmcnt(12)
    v_mfma_f32_32x32x16_bf16 v[176:191], v[60:63], v[96:99], v[176:191]
    s_waitcnt lgkmcnt(6)
    v_mfma_f32_32x32x16_bf16 v[128:143], v[56:59], v[100:103], v[128:143]
    v_mfma_f32_32x32x16_bf16 v[192:207], v[60:63], v[100:103], v[192:207]
    s_waitcnt lgkmcnt(5)
    v_mfma_f32_32x32x16_bf16 v[144:159], v[56:59], v[104:107], v[144:159]
    v_mfma_f32_32x32x16_bf16 v[208:223], v[60:63], v[104:107], v[208:223]
    s_waitcnt lgkmcnt(4)
    v_mfma_f32_32x32x16_bf16 v[160:175], v[56:59], v[108:111], v[160:175]
    v_mfma_f32_32x32x16_bf16 v[224:239], v[60:63], v[108:111], v[224:239]
    ds_read_b128 v[96:99], v8 offset:1248
    ds_read_b128 v[100:103], v8 offset:30432
    ds_read_b128 v[104:107], v9 offset:1248
    ds_read_b128 v[108:111], v9 offset:30432
    s_waitcnt vmcnt(11) lgkmcnt(7)
    v_mfma_f32_32x32x16_bf16 v[112:127], v[64:67], v[80:83], v[112:127]
    s_waitcnt vmcnt(10)
    v_mfma_f32_32x32x16_bf16 v[176:191], v[68:71], v[80:83], v[176:191]
    s_waitcnt lgkmcnt(6)
    v_mfma_f32_32x32x16_bf16 v[128:143], v[64:67], v[84:87], v[128:143]
    v_mfma_f32_32x32x16_bf16 v[192:207], v[68:71], v[84:87], v[192:207]
    s_waitcnt lgkmcnt(5)
    v_mfma_f32_32x32x16_bf16 v[144:159], v[64:67], v[88:91], v[144:159]
    v_mfma_f32_32x32x16_bf16 v[208:223], v[68:71], v[88:91], v[208:223]
    s_waitcnt lgkmcnt(4)
    v_mfma_f32_32x32x16_bf16 v[160:175], v[64:67], v[92:95], v[160:175]
    v_mfma_f32_32x32x16_bf16 v[224:239], v[68:71], v[92:95], v[224:239]
    ds_read_b128 v[80:83], v8 offset:1280
    ds_read_b128 v[84:87], v8 offset:30464
    ds_read_b128 v[88:91], v9 offset:1280
    ds_read_b128 v[92:95], v9 offset:30464
    s_waitcnt vmcnt(9) lgkmcnt(7)
    v_mfma_f32_32x32x16_bf16 v[112:127], v[72:75], v[96:99], v[112:127]
    s_waitcnt vmcnt(8)
    v_mfma_f32_32x32x16_bf16 v[176:191], v[76:79], v[96:99], v[176:191]
    s_waitcnt lgkmcnt(6)
    v_mfma_f32_32x32x16_bf16 v[128:143], v[72:75], v[100:103], v[128:143]
    v_mfma_f32_32x32x16_bf16 v[192:207], v[76:79], v[100:103], v[192:207]
    s_waitcnt lgkmcnt(5)
    v_mfma_f32_32x32x16_bf16 v[144:159], v[72:75], v[104:107], v[144:159]
    v_mfma_f32_32x32x16_bf16 v[208:223], v[76:79], v[104:107], v[208:223]
    s_waitcnt lgkmcnt(4)
    v_mfma_f32_32x32x16_bf16 v[160:175], v[72:75], v[108:111], v[160:175]
    v_mfma_f32_32x32x16_bf16 v[224:239], v[76:79], v[108:111], v[224:239]
    buffer_load_dwordx4 v[48:51], v2, s[16:19], s35 offen offset:0
    buffer_load_dwordx4 v[52:55], v2, s[48:51], s35 offen offset:0
    buffer_load_dwordx4 v[56:59], v2, s[16:19], s35 offen offset:1024
    buffer_load_dwordx4 v[60:63], v2, s[48:51], s35 offen offset:1024
    buffer_load_dwordx4 v[64:67], v2, s[16:19], s35 offen offset:2048
    buffer_load_dwordx4 v[68:71], v2, s[48:51], s35 offen offset:2048
    buffer_load_dwordx4 v[72:75], v2, s[16:19], s35 offen offset:3072
    buffer_load_dwordx4 v[76:79], v2, s[48:51], s35 offen offset:3072
    s_add_u32 s35, s35, 4096
    ds_read_b128 v[96:99], v8 offset:1312
    ds_read_b128 v[100:103], v8 offset:30496
    ds_read_b128 v[104:107], v9 offset:1312
    ds_read_b128 v[108:111], v9 offset:30496
    s_waitcnt vmcnt(15) lgkmcnt(7)
    v_mfma_f32_32x32x16_bf16 v[112:127], v[16:19], v[80:83], v[112:127]
    s_waitcnt vmcnt(14)
    v_mfma_f32_32x32x16_bf16 v[176:191], v[20:23], v[80:83], v[176:191]
    s_waitcnt lgkmcnt(6)
    v_mfma_f32_32x32x16_bf16 v[128:143], v[16:19], v[84:87], v[128:143]
    v_mfma_f32_32x32x16_bf16 v[192:207], v[20:23], v[84:87], v[192:207]
    s_waitcnt lgkmcnt(5)
    v_mfma_f32_32x32x16_bf16 v[144:159], v[16:19], v[88:91], v[144:159]
    v_mfma_f32_32x32x16_bf16 v[208:223], v[20:23], v[88:91], v[208:223]
    s_waitcnt lgkmcnt(4)
    v_mfma_f32_32x32x16_bf16 v[160:175], v[16:19], v[92:95], v[160:175]
    v_mfma_f32_32x32x16_bf16 v[224:239], v[20:23], v[92:95], v[224:239]
    ds_read_b128 v[80:83], v8 offset:1344
    ds_read_b128 v[84:87], v8 offset:30528
    ds_read_b128 v[88:91], v9 offset:1344
    ds_read_b128 v[92:95], v9 offset:30528
    s_waitcnt vmcnt(13) lgkmcnt(7)
    v_mfma_f32_32x32x16_bf16 v[112:127], v[24:27], v[96:99], v[112:127]
    s_waitcnt vmcnt(12)
    v_mfma_f32_32x32x16_bf16 v[176:191], v[28:31], v[96:99], v[176:191]
    s_waitcnt lgkmcnt(6)
    v_mfma_f32_32x32x16_bf16 v[128:143], v[24:27], v[100:103], v[128:143]
    v_mfma_f32_32x32x16_bf16 v[192:207], v[28:31], v[100:103], v[192:207]
    s_waitcnt lgkmcnt(5)
    v_mfma_f32_32x32x16_bf16 v[144:159], v[24:27], v[104:107], v[144:159]
    v_mfma_f32_32x32x16_bf16 v[208:223], v[28:31], v[104:107], v[208:223]
    s_waitcnt lgkmcnt(4)
    v_mfma_f32_32x32x16_bf16 v[160:175], v[24:27], v[108:111], v[160:175]
    v_mfma_f32_32x32x16_bf16 v[224:239], v[28:31], v[108:111], v[224:239]
    ds_read_b128 v[96:99], v8 offset:1376
    ds_read_b128 v[100:103], v8 offset:30560
    ds_read_b128 v[104:107], v9 offset:1376
    ds_read_b128 v[108:111], v9 offset:30560
    s_waitcnt vmcnt(11) lgkmcnt(7)
    v_mfma_f32_32x32x16_bf16 v[112:127], v[32:35], v[80:83], v[112:127]
    s_waitcnt vmcnt(10)
    v_mfma_f32_32x32x16_bf16 v[176:191], v[36:39], v[80:83], v[176:191]
    s_waitcnt lgkmcnt(6)
    v_mfma_f32_32x32x16_bf16 v[128:143], v[32:35], v[84:87], v[128:143]
    v_mfma_f32_32x32x16_bf16 v[192:207], v[36:39], v[84:87], v[192:207]
    s_waitcnt lgkmcnt(5)
    v_mfma_f32_32x32x16_bf16 v[144:159], v[32:35], v[88:91], v[144:159]
    v_mfma_f32_32x32x16_bf16 v[208:223], v[36:39], v[88:91], v[208:223]
    s_waitcnt lgkmcnt(4)
    v_mfma_f32_32x32x16_bf16 v[160:175], v[32:35], v[92:95], v[160:175]
    v_mfma_f32_32x32x16_bf16 v[224:239], v[36:39], v[92:95], v[224:239]
    ds_read_b128 v[80:83], v8 offset:1408
    ds_read_b128 v[84:87], v8 offset:30592
    ds_read_b128 v[88:91], v9 offset:1408
    ds_read_b128 v[92:95], v9 offset:30592
    s_waitcnt vmcnt(9) lgkmcnt(7)
    v_mfma_f32_32x32x16_bf16 v[112:127], v[40:43], v[96:99], v[112:127]
    s_waitcnt vmcnt(8)
    v_mfma_f32_32x32x16_bf16 v[176:191], v[44:47], v[96:99], v[176:191]
    s_waitcnt lgkmcnt(6)
    v_mfma_f32_32x32x16_bf16 v[128:143], v[40:43], v[100:103], v[128:143]
    v_mfma_f32_32x32x16_bf16 v[192:207], v[44:47], v[100:103], v[192:207]
    s_waitcnt lgkmcnt(5)
    v_mfma_f32_32x32x16_bf16 v[144:159], v[40:43], v[104:107], v[144:159]
    v_mfma_f32_32x32x16_bf16 v[208:223], v[44:47], v[104:107], v[208:223]
    s_waitcnt lgkmcnt(4)
    v_mfma_f32_32x32x16_bf16 v[160:175], v[40:43], v[108:111], v[160:175]
    v_mfma_f32_32x32x16_bf16 v[224:239], v[44:47], v[108:111], v[224:239]
    buffer_load_dwordx4 v[16:19], v2, s[16:19], s35 offen offset:0
    buffer_load_dwordx4 v[20:23], v2, s[48:51], s35 offen offset:0
    buffer_load_dwordx4 v[24:27], v2, s[16:19], s35 offen offset:1024
    buffer_load_dwordx4 v[28:31], v2, s[48:51], s35 offen offset:1024
    buffer_load_dwordx4 v[32:35], v2, s[16:19], s35 offen offset:2048
    buffer_load_dwordx4 v[36:39], v2, s[48:51], s35 offen offset:2048
    buffer_load_dwordx4 v[40:43], v2, s[16:19], s35 offen offset:3072
    buffer_load_dwordx4 v[44:47], v2, s[48:51], s35 offen offset:3072
    s_add_u32 s35, s35, 4096
    ds_read_b128 v[96:99], v8 offset:1440
    ds_read_b128 v[100:103], v8 offset:30624
    ds_read_b128 v[104:107], v9 offset:1440
    ds_read_b128 v[108:111], v9 offset:30624
    s_waitcnt vmcnt(15) lgkmcnt(7)
    v_mfma_f32_32x32x16_bf16 v[112:127], v[48:51], v[80:83], v[112:127]
    s_waitcnt vmcnt(14)
    v_mfma_f32_32x32x16_bf16 v[176:191], v[52:55], v[80:83], v[176:191]
    s_waitcnt lgkmcnt(6)
    v_mfma_f32_32x32x16_bf16 v[128:143], v[48:51], v[84:87], v[128:143]
    v_mfma_f32_32x32x16_bf16 v[192:207], v[52:55], v[84:87], v[192:207]
    s_waitcnt lgkmcnt(5)
    v_mfma_f32_32x32x16_bf16 v[144:159], v[48:51], v[88:91], v[144:159]
    v_mfma_f32_32x32x16_bf16 v[208:223], v[52:55], v[88:91], v[208:223]
    s_waitcnt lgkmcnt(4)
    v_mfma_f32_32x32x16_bf16 v[160:175], v[48:51], v[92:95], v[160:175]
    v_mfma_f32_32x32x16_bf16 v[224:239], v[52:55], v[92:95], v[224:239]
    ds_read_b128 v[80:83], v8 offset:1472
    ds_read_b128 v[84:87], v8 offset:30656
    ds_read_b128 v[88:91], v9 offset:1472
    ds_read_b128 v[92:95], v9 offset:30656
    s_waitcnt vmcnt(13) lgkmcnt(7)
    v_mfma_f32_32x32x16_bf16 v[112:127], v[56:59], v[96:99], v[112:127]
    s_waitcnt vmcnt(12)
    v_mfma_f32_32x32x16_bf16 v[176:191], v[60:63], v[96:99], v[176:191]
    s_waitcnt lgkmcnt(6)
    v_mfma_f32_32x32x16_bf16 v[128:143], v[56:59], v[100:103], v[128:143]
    v_mfma_f32_32x32x16_bf16 v[192:207], v[60:63], v[100:103], v[192:207]
    s_waitcnt lgkmcnt(5)
    v_mfma_f32_32x32x16_bf16 v[144:159], v[56:59], v[104:107], v[144:159]
    v_mfma_f32_32x32x16_bf16 v[208:223], v[60:63], v[104:107], v[208:223]
    s_waitcnt lgkmcnt(4)
    v_mfma_f32_32x32x16_bf16 v[160:175], v[56:59], v[108:111], v[160:175]
    v_mfma_f32_32x32x16_bf16 v[224:239], v[60:63], v[108:111], v[224:239]
    ds_read_b128 v[96:99], v8 offset:1504
    ds_read_b128 v[100:103], v8 offset:30688
    ds_read_b128 v[104:107], v9 offset:1504
    ds_read_b128 v[108:111], v9 offset:30688
    s_waitcnt vmcnt(11) lgkmcnt(7)
    v_mfma_f32_32x32x16_bf16 v[112:127], v[64:67], v[80:83], v[112:127]
    s_waitcnt vmcnt(10)
    v_mfma_f32_32x32x16_bf16 v[176:191], v[68:71], v[80:83], v[176:191]
    s_waitcnt lgkmcnt(6)
    v_mfma_f32_32x32x16_bf16 v[128:143], v[64:67], v[84:87], v[128:143]
    v_mfma_f32_32x32x16_bf16 v[192:207], v[68:71], v[84:87], v[192:207]
    s_waitcnt lgkmcnt(5)
    v_mfma_f32_32x32x16_bf16 v[144:159], v[64:67], v[88:91], v[144:159]
    v_mfma_f32_32x32x16_bf16 v[208:223], v[68:71], v[88:91], v[208:223]
    s_waitcnt lgkmcnt(4)
    v_mfma_f32_32x32x16_bf16 v[160:175], v[64:67], v[92:95], v[160:175]
    v_mfma_f32_32x32x16_bf16 v[224:239], v[68:71], v[92:95], v[224:239]
    ds_read_b128 v[80:83], v8 offset:1536
    ds_read_b128 v[84:87], v8 offset:30720
    ds_read_b128 v[88:91], v9 offset:1536
    ds_read_b128 v[92:95], v9 offset:30720
    s_waitcnt vmcnt(9) lgkmcnt(7)
    v_mfma_f32_32x32x16_bf16 v[112:127], v[72:75], v[96:99], v[112:127]
    s_waitcnt vmcnt(8)
    v_mfma_f32_32x32x16_bf16 v[176:191], v[76:79], v[96:99], v[176:191]
    s_waitcnt lgkmcnt(6)
    v_mfma_f32_32x32x16_bf16 v[128:143], v[72:75], v[100:103], v[128:143]
    v_mfma_f32_32x32x16_bf16 v[192:207], v[76:79], v[100:103], v[192:207]
    s_waitcnt lgkmcnt(5)
    v_mfma_f32_32x32x16_bf16 v[144:159], v[72:75], v[104:107], v[144:159]
    v_mfma_f32_32x32x16_bf16 v[208:223], v[76:79], v[104:107], v[208:223]
    s_waitcnt lgkmcnt(4)
    v_mfma_f32_32x32x16_bf16 v[160:175], v[72:75], v[108:111], v[160:175]
    v_mfma_f32_32x32x16_bf16 v[224:239], v[76:79], v[108:111], v[224:239]
    buffer_load_dwordx4 v[48:51], v2, s[16:19], s35 offen offset:0
    buffer_load_dwordx4 v[52:55], v2, s[48:51], s35 offen offset:0
    buffer_load_dwordx4 v[56:59], v2, s[16:19], s35 offen offset:1024
    buffer_load_dwordx4 v[60:63], v2, s[48:51], s35 offen offset:1024
    buffer_load_dwordx4 v[64:67], v2, s[16:19], s35 offen offset:2048
    buffer_load_dwordx4 v[68:71], v2, s[48:51], s35 offen offset:2048
    buffer_load_dwordx4 v[72:75], v2, s[16:19], s35 offen offset:3072
    buffer_load_dwordx4 v[76:79], v2, s[48:51], s35 offen offset:3072
    s_add_u32 s35, s35, 4096
    ds_read_b128 v[96:99], v8 offset:1568
    ds_read_b128 v[100:103], v8 offset:30752
    ds_read_b128 v[104:107], v9 offset:1568
    ds_read_b128 v[108:111], v9 offset:30752
    s_waitcnt vmcnt(15) lgkmcnt(7)
    v_mfma_f32_32x32x16_bf16 v[112:127], v[16:19], v[80:83], v[112:127]
    s_waitcnt vmcnt(14)
    v_mfma_f32_32x32x16_bf16 v[176:191], v[20:23], v[80:83], v[176:191]
    s_waitcnt lgkmcnt(6)
    v_mfma_f32_32x32x16_bf16 v[128:143], v[16:19], v[84:87], v[128:143]
    v_mfma_f32_32x32x16_bf16 v[192:207], v[20:23], v[84:87], v[192:207]
    s_waitcnt lgkmcnt(5)
    v_mfma_f32_32x32x16_bf16 v[144:159], v[16:19], v[88:91], v[144:159]
    v_mfma_f32_32x32x16_bf16 v[208:223], v[20:23], v[88:91], v[208:223]
    s_waitcnt lgkmcnt(4)
    v_mfma_f32_32x32x16_bf16 v[160:175], v[16:19], v[92:95], v[160:175]
    v_mfma_f32_32x32x16_bf16 v[224:239], v[20:23], v[92:95], v[224:239]
    ds_read_b128 v[80:83], v8 offset:1600
    ds_read_b128 v[84:87], v8 offset:30784
    ds_read_b128 v[88:91], v9 offset:1600
    ds_read_b128 v[92:95], v9 offset:30784
    s_waitcnt vmcnt(13) lgkmcnt(7)
    v_mfma_f32_32x32x16_bf16 v[112:127], v[24:27], v[96:99], v[112:127]
    s_waitcnt vmcnt(12)
    v_mfma_f32_32x32x16_bf16 v[176:191], v[28:31], v[96:99], v[176:191]
    s_waitcnt lgkmcnt(6)
    v_mfma_f32_32x32x16_bf16 v[128:143], v[24:27], v[100:103], v[128:143]
    v_mfma_f32_32x32x16_bf16 v[192:207], v[28:31], v[100:103], v[192:207]
    s_waitcnt lgkmcnt(5)
    v_mfma_f32_32x32x16_bf16 v[144:159], v[24:27], v[104:107], v[144:159]
    v_mfma_f32_32x32x16_bf16 v[208:223], v[28:31], v[104:107], v[208:223]
    s_waitcnt lgkmcnt(4)
    v_mfma_f32_32x32x16_bf16 v[160:175], v[24:27], v[108:111], v[160:175]
    v_mfma_f32_32x32x16_bf16 v[224:239], v[28:31], v[108:111], v[224:239]
    ds_read_b128 v[96:99], v8 offset:1632
    ds_read_b128 v[100:103], v8 offset:30816
    ds_read_b128 v[104:107], v9 offset:1632
    ds_read_b128 v[108:111], v9 offset:30816
    s_waitcnt vmcnt(11) lgkmcnt(7)
    v_mfma_f32_32x32x16_bf16 v[112:127], v[32:35], v[80:83], v[112:127]
    s_waitcnt vmcnt(10)
    v_mfma_f32_32x32x16_bf16 v[176:191], v[36:39], v[80:83], v[176:191]
    s_waitcnt lgkmcnt(6)
    v_mfma_f32_32x32x16_bf16 v[128:143], v[32:35], v[84:87], v[128:143]
    v_mfma_f32_32x32x16_bf16 v[192:207], v[36:39], v[84:87], v[192:207]
    s_waitcnt lgkmcnt(5)
    v_mfma_f32_32x32x16_bf16 v[144:159], v[32:35], v[88:91], v[144:159]
    v_mfma_f32_32x32x16_bf16 v[208:223], v[36:39], v[88:91], v[208:223]
    s_waitcnt lgkmcnt(4)
    v_mfma_f32_32x32x16_bf16 v[160:175], v[32:35], v[92:95], v[160:175]
    v_mfma_f32_32x32x16_bf16 v[224:239], v[36:39], v[92:95], v[224:239]
    ds_read_b128 v[80:83], v8 offset:1664
    ds_read_b128 v[84:87], v8 offset:30848
    ds_read_b128 v[88:91], v9 offset:1664
    ds_read_b128 v[92:95], v9 offset:30848
    s_waitcnt vmcnt(9) lgkmcnt(7)
    v_mfma_f32_32x32x16_bf16 v[112:127], v[40:43], v[96:99], v[112:127]
    s_waitcnt vmcnt(8)
    v_mfma_f32_32x32x16_bf16 v[176:191], v[44:47], v[96:99], v[176:191]
    s_waitcnt lgkmcnt(6)
    v_mfma_f32_32x32x16_bf16 v[128:143], v[40:43], v[100:103], v[128:143]
    v_mfma_f32_32x32x16_bf16 v[192:207], v[44:47], v[100:103], v[192:207]
    s_waitcnt lgkmcnt(5)
    v_mfma_f32_32x32x16_bf16 v[144:159], v[40:43], v[104:107], v[144:159]
    v_mfma_f32_32x32x16_bf16 v[208:223], v[44:47], v[104:107], v[208:223]
    s_waitcnt lgkmcnt(4)
    v_mfma_f32_32x32x16_bf16 v[160:175], v[40:43], v[108:111], v[160:175]
    v_mfma_f32_32x32x16_bf16 v[224:239], v[44:47], v[108:111], v[224:239]
    buffer_load_dwordx4 v[16:19], v2, s[16:19], s35 offen offset:0
    buffer_load_dwordx4 v[20:23], v2, s[48:51], s35 offen offset:0
    buffer_load_dwordx4 v[24:27], v2, s[16:19], s35 offen offset:1024
    buffer_load_dwordx4 v[28:31], v2, s[48:51], s35 offen offset:1024
    buffer_load_dwordx4 v[32:35], v2, s[16:19], s35 offen offset:2048
    buffer_load_dwordx4 v[36:39], v2, s[48:51], s35 offen offset:2048
    buffer_load_dwordx4 v[40:43], v2, s[16:19], s35 offen offset:3072
    buffer_load_dwordx4 v[44:47], v2, s[48:51], s35 offen offset:3072
    s_add_u32 s35, s35, 4096
    ds_read_b128 v[96:99], v8 offset:1696
    ds_read_b128 v[100:103], v8 offset:30880
    ds_read_b128 v[104:107], v9 offset:1696
    ds_read_b128 v[108:111], v9 offset:30880
    s_waitcnt vmcnt(15) lgkmcnt(7)
    v_mfma_f32_32x32x16_bf16 v[112:127], v[48:51], v[80:83], v[112:127]
    s_waitcnt vmcnt(14)
    v_mfma_f32_32x32x16_bf16 v[176:191], v[52:55], v[80:83], v[176:191]
    s_waitcnt lgkmcnt(6)
    v_mfma_f32_32x32x16_bf16 v[128:143], v[48:51], v[84:87], v[128:143]
    v_mfma_f32_32x32x16_bf16 v[192:207], v[52:55], v[84:87], v[192:207]
    s_waitcnt lgkmcnt(5)
    v_mfma_f32_32x32x16_bf16 v[144:159], v[48:51], v[88:91], v[144:159]
    v_mfma_f32_32x32x16_bf16 v[208:223], v[52:55], v[88:91], v[208:223]
    s_waitcnt lgkmcnt(4)
    v_mfma_f32_32x32x16_bf16 v[160:175], v[48:51], v[92:95], v[160:175]
    v_mfma_f32_32x32x16_bf16 v[224:239], v[52:55], v[92:95], v[224:239]
    ds_read_b128 v[80:83], v8 offset:1728
    ds_read_b128 v[84:87], v8 offset:30912
    ds_read_b128 v[88:91], v9 offset:1728
    ds_read_b128 v[92:95], v9 offset:30912
    s_waitcnt vmcnt(13) lgkmcnt(7)
    v_mfma_f32_32x32x16_bf16 v[112:127], v[56:59], v[96:99], v[112:127]
    s_waitcnt vmcnt(12)
    v_mfma_f32_32x32x16_bf16 v[176:191], v[60:63], v[96:99], v[176:191]
    s_waitcnt lgkmcnt(6)
    v_mfma_f32_32x32x16_bf16 v[128:143], v[56:59], v[100:103], v[128:143]
    v_mfma_f32_32x32x16_bf16 v[192:207], v[60:63], v[100:103], v[192:207]
    s_waitcnt lgkmcnt(5)
    v_mfma_f32_32x32x16_bf16 v[144:159], v[56:59], v[104:107], v[144:159]
    v_mfma_f32_32x32x16_bf16 v[208:223], v[60:63], v[104:107], v[208:223]
    s_waitcnt lgkmcnt(4)
    v_mfma_f32_32x32x16_bf16 v[160:175], v[56:59], v[108:111], v[160:175]
    v_mfma_f32_32x32x16_bf16 v[224:239], v[60:63], v[108:111], v[224:239]
    ds_read_b128 v[96:99], v8 offset:1760
    ds_read_b128 v[100:103], v8 offset:30944
    ds_read_b128 v[104:107], v9 offset:1760
    ds_read_b128 v[108:111], v9 offset:30944
    s_waitcnt vmcnt(11) lgkmcnt(7)
    v_mfma_f32_32x32x16_bf16 v[112:127], v[64:67], v[80:83], v[112:127]
    s_waitcnt vmcnt(10)
    v_mfma_f32_32x32x16_bf16 v[176:191], v[68:71], v[80:83], v[176:191]
    s_waitcnt lgkmcnt(6)
    v_mfma_f32_32x32x16_bf16 v[128:143], v[64:67], v[84:87], v[128:143]
    v_mfma_f32_32x32x16_bf16 v[192:207], v[68:71], v[84:87], v[192:207]
    s_waitcnt lgkmcnt(5)
    v_mfma_f32_32x32x16_bf16 v[144:159], v[64:67], v[88:91], v[144:159]
    v_mfma_f32_32x32x16_bf16 v[208:223], v[68:71], v[88:91], v[208:223]
    s_waitcnt lgkmcnt(4)
    v_mfma_f32_32x32x16_bf16 v[160:175], v[64:67], v[92:95], v[160:175]
    v_mfma_f32_32x32x16_bf16 v[224:239], v[68:71], v[92:95], v[224:239]
    ds_read_b128 v[80:83], v8 offset:1792
    ds_read_b128 v[84:87], v8 offset:30976
    ds_read_b128 v[88:91], v9 offset:1792
    ds_read_b128 v[92:95], v9 offset:30976
    s_waitcnt vmcnt(9) lgkmcnt(7)
    v_mfma_f32_32x32x16_bf16 v[112:127], v[72:75], v[96:99], v[112:127]
    s_waitcnt vmcnt(8)
    v_mfma_f32_32x32x16_bf16 v[176:191], v[76:79], v[96:99], v[176:191]
    s_waitcnt lgkmcnt(6)
    v_mfma_f32_32x32x16_bf16 v[128:143], v[72:75], v[100:103], v[128:143]
    v_mfma_f32_32x32x16_bf16 v[192:207], v[76:79], v[100:103], v[192:207]
    s_waitcnt lgkmcnt(5)
    v_mfma_f32_32x32x16_bf16 v[144:159], v[72:75], v[104:107], v[144:159]
    v_mfma_f32_32x32x16_bf16 v[208:223], v[76:79], v[104:107], v[208:223]
    s_waitcnt lgkmcnt(4)
    v_mfma_f32_32x32x16_bf16 v[160:175], v[72:75], v[108:111], v[160:175]
    v_mfma_f32_32x32x16_bf16 v[224:239], v[76:79], v[108:111], v[224:239]
    ds_read_b128 v[96:99], v8 offset:1824
    ds_read_b128 v[100:103], v8 offset:31008
    ds_read_b128 v[104:107], v9 offset:1824
    ds_read_b128 v[108:111], v9 offset:31008
    s_waitcnt vmcnt(7) lgkmcnt(7)
    v_mfma_f32_32x32x16_bf16 v[112:127], v[16:19], v[80:83], v[112:127]
    s_waitcnt vmcnt(6)
    v_mfma_f32_32x32x16_bf16 v[176:191], v[20:23], v[80:83], v[176:191]
    s_waitcnt lgkmcnt(6)
    v_mfma_f32_32x32x16_bf16 v[128:143], v[16:19], v[84:87], v[128:143]
    v_mfma_f32_32x32x16_bf16 v[192:207], v[20:23], v[84:87], v[192:207]
    s_waitcnt lgkmcnt(5)
    v_mfma_f32_32x32x16_bf16 v[144:159], v[16:19], v[88:91], v[144:159]
    v_mfma_f32_32x32x16_bf16 v[208:223], v[20:23], v[88:91], v[208:223]
    s_waitcnt lgkmcnt(4)
    v_mfma_f32_32x32x16_bf16 v[160:175], v[16:19], v[92:95], v[160:175]
    v_mfma_f32_32x32x16_bf16 v[224:239], v[20:23], v[92:95], v[224:239]
    ds_read_b128 v[80:83], v8 offset:1856
    ds_read_b128 v[84:87], v8 offset:31040
    ds_read_b128 v[88:91], v9 offset:1856
    ds_read_b128 v[92:95], v9 offset:31040
    s_waitcnt vmcnt(5) lgkmcnt(7)
    v_mfma_f32_32x32x16_bf16 v[112:127], v[24:27], v[96:99], v[112:127]
    s_waitcnt vmcnt(4)
    v_mfma_f32_32x32x16_bf16 v[176:191], v[28:31], v[96:99], v[176:191]
    s_waitcnt lgkmcnt(6)
    v_mfma_f32_32x32x16_bf16 v[128:143], v[24:27], v[100:103], v[128:143]
    v_mfma_f32_32x32x16_bf16 v[192:207], v[28:31], v[100:103], v[192:207]
    s_waitcnt lgkmcnt(5)
    v_mfma_f32_32x32x16_bf16 v[144:159], v[24:27], v[104:107], v[144:159]
    v_mfma_f32_32x32x16_bf16 v[208:223], v[28:31], v[104:107], v[208:223]
    s_waitcnt lgkmcnt(4)
    v_mfma_f32_32x32x16_bf16 v[160:175], v[24:27], v[108:111], v[160:175]
    v_mfma_f32_32x32x16_bf16 v[224:239], v[28:31], v[108:111], v[224:239]
    ds_read_b128 v[96:99], v8 offset:1888
    ds_read_b128 v[100:103], v8 offset:31072
    ds_read_b128 v[104:107], v9 offset:1888
    ds_read_b128 v[108:111], v9 offset:31072
    s_waitcnt vmcnt(3) lgkmcnt(7)
    v_mfma_f32_32x32x16_bf16 v[112:127], v[32:35], v[80:83], v[112:127]
    s_waitcnt vmcnt(2)
    v_mfma_f32_32x32x16_bf16 v[176:191], v[36:39], v[80:83], v[176:191]
    s_waitcnt lgkmcnt(6)
    v_mfma_f32_32x32x16_bf16 v[128:143], v[32:35], v[84:87], v[128:143]
    v_mfma_f32_32x32x16_bf16 v[192:207], v[36:39], v[84:87], v[192:207]
    s_waitcnt lgkmcnt(5)
    v_mfma_f32_32x32x16_bf16 v[144:159], v[32:35], v[88:91], v[144:159]
    v_mfma_f32_32x32x16_bf16 v[208:223], v[36:39], v[88:91], v[208:223]
    s_waitcnt lgkmcnt(4)
    v_mfma_f32_32x32x16_bf16 v[160:175], v[32:35], v[92:95], v[160:175]
    v_mfma_f32_32x32x16_bf16 v[224:239], v[36:39], v[92:95], v[224:239]
    s_waitcnt vmcnt(1) lgkmcnt(3)
    v_mfma_f32_32x32x16_bf16 v[112:127], v[40:43], v[96:99], v[112:127]
    s_waitcnt vmcnt(0)
    v_mfma_f32_32x32x16_bf16 v[176:191], v[44:47], v[96:99], v[176:191]
    s_waitcnt lgkmcnt(2)
    v_mfma_f32_32x32x16_bf16 v[128:143], v[40:43], v[100:103], v[128:143]
    v_mfma_f32_32x32x16_bf16 v[192:207], v[44:47], v[100:103], v[192:207]
    s_waitcnt lgkmcnt(1)
    v_mfma_f32_32x32x16_bf16 v[144:159], v[40:43], v[104:107], v[144:159]
    v_mfma_f32_32x32x16_bf16 v[208:223], v[44:47], v[104:107], v[208:223]
    s_waitcnt lgkmcnt(0)
    v_mfma_f32_32x32x16_bf16 v[160:175], v[40:43], v[108:111], v[160:175]
    v_mfma_f32_32x32x16_bf16 v[224:239], v[44:47], v[108:111], v[224:239]
    v_lshrrev_b32 v4, 5, v1
    v_lshlrev_b32 v4, 4, v4
    s_lshl_b32 s37, s33, 7
    buffer_load_dwordx4 v[16:19], v4, s[24:27], s37 offen offset:0
    buffer_load_dwordx4 v[32:35], v4, s[52:55], s37 offen offset:0
    buffer_load_dwordx4 v[20:23], v4, s[24:27], s37 offen offset:32
    buffer_load_dwordx4 v[36:39], v4, s[52:55], s37 offen offset:32
    buffer_load_dwordx4 v[24:27], v4, s[24:27], s37 offen offset:64
    buffer_load_dwordx4 v[40:43], v4, s[52:55], s37 offen offset:64
    buffer_load_dwordx4 v[28:31], v4, s[24:27], s37 offen offset:96
    buffer_load_dwordx4 v[44:47], v4, s[52:55], s37 offen offset:96
    v_and_b32 v5, 31, v1
    v_lshlrev_b32 v5, 2, v5
    ds_read_b32 v48, v5 offset:0
    ds_read_b32 v52, v5 offset:512
    ds_read_b32 v49, v5 offset:128
    ds_read_b32 v53, v5 offset:640
    ds_read_b32 v50, v5 offset:256
    ds_read_b32 v54, v5 offset:768
    ds_read_b32 v51, v5 offset:384
    ds_read_b32 v55, v5 offset:896
    v_and_b32 v5, 31, v1
    v_lshlrev_b32 v5, 4, v5
    v_lshrrev_b32 v6, 5, v1
    v_lshl_add_u32 v5, v6, 3, v5
    s_lshl_b32 s36, s31, 2
    s_mul_i32 s36, s36, 114688
    s_lshl_b32 s37, s33, 11
    s_add_u32 s36, s36, s37
    s_waitcnt lgkmcnt(7)
    v_mul_f32 v112, v112, v48
    s_waitcnt vmcnt(7) lgkmcnt(6)
    v_fma_f32 v112, -v52, v16, v112
    v_mul_f32 v112, -1.4426950408889634, v112
    v_exp_f32 v112, v112
    v_mul_f32 v176, v176, v48
    s_waitcnt vmcnt(6)
    v_fma_f32 v176, -v52, v32, v176
    v_add_f32 v112, 1.0, v112
    v_rcp_f32 v112, v112
    s_nop 0
    v_mul_f32 v176, v176, v112
    v_mul_f32 v113, v113, v48
    v_fma_f32 v113, -v52, v17, v113
    v_mul_f32 v113, -1.4426950408889634, v113
    v_exp_f32 v113, v113
    v_mul_f32 v177, v177, v48
    v_fma_f32 v177, -v52, v33, v177
    v_add_f32 v113, 1.0, v113
    v_rcp_f32 v113, v113
    s_nop 0
    v_mul_f32 v177, v177, v113
    v_mul_f32 v114, v114, v48
    v_fma_f32 v114, -v52, v18, v114
    v_mul_f32 v114, -1.4426950408889634, v114
    v_exp_f32 v114, v114
    v_mul_f32 v178, v178, v48
    v_fma_f32 v178, -v52, v34, v178
    v_add_f32 v114, 1.0, v114
    v_rcp_f32 v114, v114
    s_nop 0
    v_mul_f32 v178, v178, v114
    v_mul_f32 v115, v115, v48
    v_fma_f32 v115, -v52, v19, v115
    v_mul_f32 v115, -1.4426950408889634, v115
    v_exp_f32 v115, v115
    v_mul_f32 v179, v179, v48
    v_fma_f32 v179, -v52, v35, v179
    v_add_f32 v115, 1.0, v115
    v_rcp_f32 v115, v115
    s_nop 0
    v_mul_f32 v179, v179, v115
    v_cvt_pk_bf16_f32 v56, v176, v177
    v_cvt_pk_bf16_f32 v57, v178, v179
    buffer_store_dwordx2 v[56:57], v5, s[56:59], s36 offen offset:0
    v_mul_f32 v116, v116, v48
    s_waitcnt vmcnt(6)
    v_fma_f32 v116, -v52, v20, v116
    v_mul_f32 v116, -1.4426950408889634, v116
    v_exp_f32 v116, v116
    v_mul_f32 v180, v180, v48
    s_waitcnt vmcnt(5)
    v_fma_f32 v180, -v52, v36, v180
    v_add_f32 v116, 1.0, v116
    v_rcp_f32 v116, v116
    s_nop 0
    v_mul_f32 v180, v180, v116
    v_mul_f32 v117, v117, v48
    v_fma_f32 v117, -v52, v21, v117
    v_mul_f32 v117, -1.4426950408889634, v117
    v_exp_f32 v117, v117
    v_mul_f32 v181, v181, v48
    v_fma_f32 v181, -v52, v37, v181
    v_add_f32 v117, 1.0, v117
    v_rcp_f32 v117, v117
    s_nop 0
    v_mul_f32 v181, v181, v117
    v_mul_f32 v118, v118, v48
    v_fma_f32 v118, -v52, v22, v118
    v_mul_f32 v118, -1.4426950408889634, v118
    v_exp_f32 v118, v118
    v_mul_f32 v182, v182, v48
    v_fma_f32 v182, -v52, v38, v182
    v_add_f32 v118, 1.0, v118
    v_rcp_f32 v118, v118
    s_nop 0
    v_mul_f32 v182, v182, v118
    v_mul_f32 v119, v119, v48
    v_fma_f32 v119, -v52, v23, v119
    v_mul_f32 v119, -1.4426950408889634, v119
    v_exp_f32 v119, v119
    v_mul_f32 v183, v183, v48
    v_fma_f32 v183, -v52, v39, v183
    v_add_f32 v119, 1.0, v119
    v_rcp_f32 v119, v119
    s_nop 0
    v_mul_f32 v183, v183, v119
    v_cvt_pk_bf16_f32 v56, v180, v181
    v_cvt_pk_bf16_f32 v57, v182, v183
    buffer_store_dwordx2 v[56:57], v5, s[56:59], s36 offen offset:512
    v_mul_f32 v120, v120, v48
    s_waitcnt vmcnt(5)
    v_fma_f32 v120, -v52, v24, v120
    v_mul_f32 v120, -1.4426950408889634, v120
    v_exp_f32 v120, v120
    v_mul_f32 v184, v184, v48
    s_waitcnt vmcnt(4)
    v_fma_f32 v184, -v52, v40, v184
    v_add_f32 v120, 1.0, v120
    v_rcp_f32 v120, v120
    s_nop 0
    v_mul_f32 v184, v184, v120
    v_mul_f32 v121, v121, v48
    v_fma_f32 v121, -v52, v25, v121
    v_mul_f32 v121, -1.4426950408889634, v121
    v_exp_f32 v121, v121
    v_mul_f32 v185, v185, v48
    v_fma_f32 v185, -v52, v41, v185
    v_add_f32 v121, 1.0, v121
    v_rcp_f32 v121, v121
    s_nop 0
    v_mul_f32 v185, v185, v121
    v_mul_f32 v122, v122, v48
    v_fma_f32 v122, -v52, v26, v122
    v_mul_f32 v122, -1.4426950408889634, v122
    v_exp_f32 v122, v122
    v_mul_f32 v186, v186, v48
    v_fma_f32 v186, -v52, v42, v186
    v_add_f32 v122, 1.0, v122
    v_rcp_f32 v122, v122
    s_nop 0
    v_mul_f32 v186, v186, v122
    v_mul_f32 v123, v123, v48
    v_fma_f32 v123, -v52, v27, v123
    v_mul_f32 v123, -1.4426950408889634, v123
    v_exp_f32 v123, v123
    v_mul_f32 v187, v187, v48
    v_fma_f32 v187, -v52, v43, v187
    v_add_f32 v123, 1.0, v123
    v_rcp_f32 v123, v123
    s_nop 0
    v_mul_f32 v187, v187, v123
    v_cvt_pk_bf16_f32 v56, v184, v185
    v_cvt_pk_bf16_f32 v57, v186, v187
    buffer_store_dwordx2 v[56:57], v5, s[56:59], s36 offen offset:1024
    v_mul_f32 v124, v124, v48
    s_waitcnt vmcnt(4)
    v_fma_f32 v124, -v52, v28, v124
    v_mul_f32 v124, -1.4426950408889634, v124
    v_exp_f32 v124, v124
    v_mul_f32 v188, v188, v48
    s_waitcnt vmcnt(3)
    v_fma_f32 v188, -v52, v44, v188
    v_add_f32 v124, 1.0, v124
    v_rcp_f32 v124, v124
    s_nop 0
    v_mul_f32 v188, v188, v124
    v_mul_f32 v125, v125, v48
    v_fma_f32 v125, -v52, v29, v125
    v_mul_f32 v125, -1.4426950408889634, v125
    v_exp_f32 v125, v125
    v_mul_f32 v189, v189, v48
    v_fma_f32 v189, -v52, v45, v189
    v_add_f32 v125, 1.0, v125
    v_rcp_f32 v125, v125
    s_nop 0
    v_mul_f32 v189, v189, v125
    v_mul_f32 v126, v126, v48
    v_fma_f32 v126, -v52, v30, v126
    v_mul_f32 v126, -1.4426950408889634, v126
    v_exp_f32 v126, v126
    v_mul_f32 v190, v190, v48
    v_fma_f32 v190, -v52, v46, v190
    v_add_f32 v126, 1.0, v126
    v_rcp_f32 v126, v126
    s_nop 0
    v_mul_f32 v190, v190, v126
    v_mul_f32 v127, v127, v48
    v_fma_f32 v127, -v52, v31, v127
    v_mul_f32 v127, -1.4426950408889634, v127
    v_exp_f32 v127, v127
    v_mul_f32 v191, v191, v48
    v_fma_f32 v191, -v52, v47, v191
    v_add_f32 v127, 1.0, v127
    v_rcp_f32 v127, v127
    s_nop 0
    v_mul_f32 v191, v191, v127
    v_cvt_pk_bf16_f32 v56, v188, v189
    v_cvt_pk_bf16_f32 v57, v190, v191
    buffer_store_dwordx2 v[56:57], v5, s[56:59], s36 offen offset:1536
    s_add_u32 s36, s36, 114688
    s_waitcnt lgkmcnt(5)
    v_mul_f32 v128, v128, v49
    s_waitcnt lgkmcnt(4)
    v_fma_f32 v128, -v53, v16, v128
    v_mul_f32 v128, -1.4426950408889634, v128
    v_exp_f32 v128, v128
    v_mul_f32 v192, v192, v49
    v_fma_f32 v192, -v53, v32, v192
    v_add_f32 v128, 1.0, v128
    v_rcp_f32 v128, v128
    s_nop 0
    v_mul_f32 v192, v192, v128
    v_mul_f32 v129, v129, v49
    v_fma_f32 v129, -v53, v17, v129
    v_mul_f32 v129, -1.4426950408889634, v129
    v_exp_f32 v129, v129
    v_mul_f32 v193, v193, v49
    v_fma_f32 v193, -v53, v33, v193
    v_add_f32 v129, 1.0, v129
    v_rcp_f32 v129, v129
    s_nop 0
    v_mul_f32 v193, v193, v129
    v_mul_f32 v130, v130, v49
    v_fma_f32 v130, -v53, v18, v130
    v_mul_f32 v130, -1.4426950408889634, v130
    v_exp_f32 v130, v130
    v_mul_f32 v194, v194, v49
    v_fma_f32 v194, -v53, v34, v194
    v_add_f32 v130, 1.0, v130
    v_rcp_f32 v130, v130
    s_nop 0
    v_mul_f32 v194, v194, v130
    v_mul_f32 v131, v131, v49
    v_fma_f32 v131, -v53, v19, v131
    v_mul_f32 v131, -1.4426950408889634, v131
    v_exp_f32 v131, v131
    v_mul_f32 v195, v195, v49
    v_fma_f32 v195, -v53, v35, v195
    v_add_f32 v131, 1.0, v131
    v_rcp_f32 v131, v131
    s_nop 0
    v_mul_f32 v195, v195, v131
    v_cvt_pk_bf16_f32 v56, v192, v193
    v_cvt_pk_bf16_f32 v57, v194, v195
    buffer_store_dwordx2 v[56:57], v5, s[56:59], s36 offen offset:0
    v_mul_f32 v132, v132, v49
    v_fma_f32 v132, -v53, v20, v132
    v_mul_f32 v132, -1.4426950408889634, v132
    v_exp_f32 v132, v132
    v_mul_f32 v196, v196, v49
    v_fma_f32 v196, -v53, v36, v196
    v_add_f32 v132, 1.0, v132
    v_rcp_f32 v132, v132
    s_nop 0
    v_mul_f32 v196, v196, v132
    v_mul_f32 v133, v133, v49
    v_fma_f32 v133, -v53, v21, v133
    v_mul_f32 v133, -1.4426950408889634, v133
    v_exp_f32 v133, v133
    v_mul_f32 v197, v197, v49
    v_fma_f32 v197, -v53, v37, v197
    v_add_f32 v133, 1.0, v133
    v_rcp_f32 v133, v133
    s_nop 0
    v_mul_f32 v197, v197, v133
    v_mul_f32 v134, v134, v49
    v_fma_f32 v134, -v53, v22, v134
    v_mul_f32 v134, -1.4426950408889634, v134
    v_exp_f32 v134, v134
    v_mul_f32 v198, v198, v49
    v_fma_f32 v198, -v53, v38, v198
    v_add_f32 v134, 1.0, v134
    v_rcp_f32 v134, v134
    s_nop 0
    v_mul_f32 v198, v198, v134
    v_mul_f32 v135, v135, v49
    v_fma_f32 v135, -v53, v23, v135
    v_mul_f32 v135, -1.4426950408889634, v135
    v_exp_f32 v135, v135
    v_mul_f32 v199, v199, v49
    v_fma_f32 v199, -v53, v39, v199
    v_add_f32 v135, 1.0, v135
    v_rcp_f32 v135, v135
    s_nop 0
    v_mul_f32 v199, v199, v135
    v_cvt_pk_bf16_f32 v56, v196, v197
    v_cvt_pk_bf16_f32 v57, v198, v199
    buffer_store_dwordx2 v[56:57], v5, s[56:59], s36 offen offset:512
    v_mul_f32 v136, v136, v49
    v_fma_f32 v136, -v53, v24, v136
    v_mul_f32 v136, -1.4426950408889634, v136
    v_exp_f32 v136, v136
    v_mul_f32 v200, v200, v49
    v_fma_f32 v200, -v53, v40, v200
    v_add_f32 v136, 1.0, v136
    v_rcp_f32 v136, v136
    s_nop 0
    v_mul_f32 v200, v200, v136
    v_mul_f32 v137, v137, v49
    v_fma_f32 v137, -v53, v25, v137
    v_mul_f32 v137, -1.4426950408889634, v137
    v_exp_f32 v137, v137
    v_mul_f32 v201, v201, v49
    v_fma_f32 v201, -v53, v41, v201
    v_add_f32 v137, 1.0, v137
    v_rcp_f32 v137, v137
    s_nop 0
    v_mul_f32 v201, v201, v137
    v_mul_f32 v138, v138, v49
    v_fma_f32 v138, -v53, v26, v138
    v_mul_f32 v138, -1.4426950408889634, v138
    v_exp_f32 v138, v138
    v_mul_f32 v202, v202, v49
    v_fma_f32 v202, -v53, v42, v202
    v_add_f32 v138, 1.0, v138
    v_rcp_f32 v138, v138
    s_nop 0
    v_mul_f32 v202, v202, v138
    v_mul_f32 v139, v139, v49
    v_fma_f32 v139, -v53, v27, v139
    v_mul_f32 v139, -1.4426950408889634, v139
    v_exp_f32 v139, v139
    v_mul_f32 v203, v203, v49
    v_fma_f32 v203, -v53, v43, v203
    v_add_f32 v139, 1.0, v139
    v_rcp_f32 v139, v139
    s_nop 0
    v_mul_f32 v203, v203, v139
    v_cvt_pk_bf16_f32 v56, v200, v201
    v_cvt_pk_bf16_f32 v57, v202, v203
    buffer_store_dwordx2 v[56:57], v5, s[56:59], s36 offen offset:1024
    v_mul_f32 v140, v140, v49
    v_fma_f32 v140, -v53, v28, v140
    v_mul_f32 v140, -1.4426950408889634, v140
    v_exp_f32 v140, v140
    v_mul_f32 v204, v204, v49
    v_fma_f32 v204, -v53, v44, v204
    v_add_f32 v140, 1.0, v140
    v_rcp_f32 v140, v140
    s_nop 0
    v_mul_f32 v204, v204, v140
    v_mul_f32 v141, v141, v49
    v_fma_f32 v141, -v53, v29, v141
    v_mul_f32 v141, -1.4426950408889634, v141
    v_exp_f32 v141, v141
    v_mul_f32 v205, v205, v49
    v_fma_f32 v205, -v53, v45, v205
    v_add_f32 v141, 1.0, v141
    v_rcp_f32 v141, v141
    s_nop 0
    v_mul_f32 v205, v205, v141
    v_mul_f32 v142, v142, v49
    v_fma_f32 v142, -v53, v30, v142
    v_mul_f32 v142, -1.4426950408889634, v142
    v_exp_f32 v142, v142
    v_mul_f32 v206, v206, v49
    v_fma_f32 v206, -v53, v46, v206
    v_add_f32 v142, 1.0, v142
    v_rcp_f32 v142, v142
    s_nop 0
    v_mul_f32 v206, v206, v142
    v_mul_f32 v143, v143, v49
    v_fma_f32 v143, -v53, v31, v143
    v_mul_f32 v143, -1.4426950408889634, v143
    v_exp_f32 v143, v143
    v_mul_f32 v207, v207, v49
    v_fma_f32 v207, -v53, v47, v207
    v_add_f32 v143, 1.0, v143
    v_rcp_f32 v143, v143
    s_nop 0
    v_mul_f32 v207, v207, v143
    v_cvt_pk_bf16_f32 v56, v204, v205
    v_cvt_pk_bf16_f32 v57, v206, v207
    buffer_store_dwordx2 v[56:57], v5, s[56:59], s36 offen offset:1536
    s_add_u32 s36, s36, 114688
    s_waitcnt lgkmcnt(3)
    v_mul_f32 v144, v144, v50
    s_waitcnt lgkmcnt(2)
    v_fma_f32 v144, -v54, v16, v144
    v_mul_f32 v144, -1.4426950408889634, v144
    v_exp_f32 v144, v144
    v_mul_f32 v208, v208, v50
    v_fma_f32 v208, -v54, v32, v208
    v_add_f32 v144, 1.0, v144
    v_rcp_f32 v144, v144
    s_nop 0
    v_mul_f32 v208, v208, v144
    v_mul_f32 v145, v145, v50
    v_fma_f32 v145, -v54, v17, v145
    v_mul_f32 v145, -1.4426950408889634, v145
    v_exp_f32 v145, v145
    v_mul_f32 v209, v209, v50
    v_fma_f32 v209, -v54, v33, v209
    v_add_f32 v145, 1.0, v145
    v_rcp_f32 v145, v145
    s_nop 0
    v_mul_f32 v209, v209, v145
    v_mul_f32 v146, v146, v50
    v_fma_f32 v146, -v54, v18, v146
    v_mul_f32 v146, -1.4426950408889634, v146
    v_exp_f32 v146, v146
    v_mul_f32 v210, v210, v50
    v_fma_f32 v210, -v54, v34, v210
    v_add_f32 v146, 1.0, v146
    v_rcp_f32 v146, v146
    s_nop 0
    v_mul_f32 v210, v210, v146
    v_mul_f32 v147, v147, v50
    v_fma_f32 v147, -v54, v19, v147
    v_mul_f32 v147, -1.4426950408889634, v147
    v_exp_f32 v147, v147
    v_mul_f32 v211, v211, v50
    v_fma_f32 v211, -v54, v35, v211
    v_add_f32 v147, 1.0, v147
    v_rcp_f32 v147, v147
    s_nop 0
    v_mul_f32 v211, v211, v147
    v_cvt_pk_bf16_f32 v56, v208, v209
    v_cvt_pk_bf16_f32 v57, v210, v211
    buffer_store_dwordx2 v[56:57], v5, s[56:59], s36 offen offset:0
    v_mul_f32 v148, v148, v50
    v_fma_f32 v148, -v54, v20, v148
    v_mul_f32 v148, -1.4426950408889634, v148
    v_exp_f32 v148, v148
    v_mul_f32 v212, v212, v50
    v_fma_f32 v212, -v54, v36, v212
    v_add_f32 v148, 1.0, v148
    v_rcp_f32 v148, v148
    s_nop 0
    v_mul_f32 v212, v212, v148
    v_mul_f32 v149, v149, v50
    v_fma_f32 v149, -v54, v21, v149
    v_mul_f32 v149, -1.4426950408889634, v149
    v_exp_f32 v149, v149
    v_mul_f32 v213, v213, v50
    v_fma_f32 v213, -v54, v37, v213
    v_add_f32 v149, 1.0, v149
    v_rcp_f32 v149, v149
    s_nop 0
    v_mul_f32 v213, v213, v149
    v_mul_f32 v150, v150, v50
    v_fma_f32 v150, -v54, v22, v150
    v_mul_f32 v150, -1.4426950408889634, v150
    v_exp_f32 v150, v150
    v_mul_f32 v214, v214, v50
    v_fma_f32 v214, -v54, v38, v214
    v_add_f32 v150, 1.0, v150
    v_rcp_f32 v150, v150
    s_nop 0
    v_mul_f32 v214, v214, v150
    v_mul_f32 v151, v151, v50
    v_fma_f32 v151, -v54, v23, v151
    v_mul_f32 v151, -1.4426950408889634, v151
    v_exp_f32 v151, v151
    v_mul_f32 v215, v215, v50
    v_fma_f32 v215, -v54, v39, v215
    v_add_f32 v151, 1.0, v151
    v_rcp_f32 v151, v151
    s_nop 0
    v_mul_f32 v215, v215, v151
    v_cvt_pk_bf16_f32 v56, v212, v213
    v_cvt_pk_bf16_f32 v57, v214, v215
    buffer_store_dwordx2 v[56:57], v5, s[56:59], s36 offen offset:512
    v_mul_f32 v152, v152, v50
    v_fma_f32 v152, -v54, v24, v152
    v_mul_f32 v152, -1.4426950408889634, v152
    v_exp_f32 v152, v152
    v_mul_f32 v216, v216, v50
    v_fma_f32 v216, -v54, v40, v216
    v_add_f32 v152, 1.0, v152
    v_rcp_f32 v152, v152
    s_nop 0
    v_mul_f32 v216, v216, v152
    v_mul_f32 v153, v153, v50
    v_fma_f32 v153, -v54, v25, v153
    v_mul_f32 v153, -1.4426950408889634, v153
    v_exp_f32 v153, v153
    v_mul_f32 v217, v217, v50
    v_fma_f32 v217, -v54, v41, v217
    v_add_f32 v153, 1.0, v153
    v_rcp_f32 v153, v153
    s_nop 0
    v_mul_f32 v217, v217, v153
    v_mul_f32 v154, v154, v50
    v_fma_f32 v154, -v54, v26, v154
    v_mul_f32 v154, -1.4426950408889634, v154
    v_exp_f32 v154, v154
    v_mul_f32 v218, v218, v50
    v_fma_f32 v218, -v54, v42, v218
    v_add_f32 v154, 1.0, v154
    v_rcp_f32 v154, v154
    s_nop 0
    v_mul_f32 v218, v218, v154
    v_mul_f32 v155, v155, v50
    v_fma_f32 v155, -v54, v27, v155
    v_mul_f32 v155, -1.4426950408889634, v155
    v_exp_f32 v155, v155
    v_mul_f32 v219, v219, v50
    v_fma_f32 v219, -v54, v43, v219
    v_add_f32 v155, 1.0, v155
    v_rcp_f32 v155, v155
    s_nop 0
    v_mul_f32 v219, v219, v155
    v_cvt_pk_bf16_f32 v56, v216, v217
    v_cvt_pk_bf16_f32 v57, v218, v219
    buffer_store_dwordx2 v[56:57], v5, s[56:59], s36 offen offset:1024
    v_mul_f32 v156, v156, v50
    v_fma_f32 v156, -v54, v28, v156
    v_mul_f32 v156, -1.4426950408889634, v156
    v_exp_f32 v156, v156
    v_mul_f32 v220, v220, v50
    v_fma_f32 v220, -v54, v44, v220
    v_add_f32 v156, 1.0, v156
    v_rcp_f32 v156, v156
    s_nop 0
    v_mul_f32 v220, v220, v156
    v_mul_f32 v157, v157, v50
    v_fma_f32 v157, -v54, v29, v157
    v_mul_f32 v157, -1.4426950408889634, v157
    v_exp_f32 v157, v157
    v_mul_f32 v221, v221, v50
    v_fma_f32 v221, -v54, v45, v221
    v_add_f32 v157, 1.0, v157
    v_rcp_f32 v157, v157
    s_nop 0
    v_mul_f32 v221, v221, v157
    v_mul_f32 v158, v158, v50
    v_fma_f32 v158, -v54, v30, v158
    v_mul_f32 v158, -1.4426950408889634, v158
    v_exp_f32 v158, v158
    v_mul_f32 v222, v222, v50
    v_fma_f32 v222, -v54, v46, v222
    v_add_f32 v158, 1.0, v158
    v_rcp_f32 v158, v158
    s_nop 0
    v_mul_f32 v222, v222, v158
    v_mul_f32 v159, v159, v50
    v_fma_f32 v159, -v54, v31, v159
    v_mul_f32 v159, -1.4426950408889634, v159
    v_exp_f32 v159, v159
    v_mul_f32 v223, v223, v50
    v_fma_f32 v223, -v54, v47, v223
    v_add_f32 v159, 1.0, v159
    v_rcp_f32 v159, v159
    s_nop 0
    v_mul_f32 v223, v223, v159
    v_cvt_pk_bf16_f32 v56, v220, v221
    v_cvt_pk_bf16_f32 v57, v222, v223
    buffer_store_dwordx2 v[56:57], v5, s[56:59], s36 offen offset:1536
    s_add_u32 s36, s36, 114688
    s_waitcnt lgkmcnt(1)
    v_mul_f32 v160, v160, v51
    s_waitcnt lgkmcnt(0)
    v_fma_f32 v160, -v55, v16, v160
    v_mul_f32 v160, -1.4426950408889634, v160
    v_exp_f32 v160, v160
    v_mul_f32 v224, v224, v51
    v_fma_f32 v224, -v55, v32, v224
    v_add_f32 v160, 1.0, v160
    v_rcp_f32 v160, v160
    s_nop 0
    v_mul_f32 v224, v224, v160
    v_mul_f32 v161, v161, v51
    v_fma_f32 v161, -v55, v17, v161
    v_mul_f32 v161, -1.4426950408889634, v161
    v_exp_f32 v161, v161
    v_mul_f32 v225, v225, v51
    v_fma_f32 v225, -v55, v33, v225
    v_add_f32 v161, 1.0, v161
    v_rcp_f32 v161, v161
    s_nop 0
    v_mul_f32 v225, v225, v161
    v_mul_f32 v162, v162, v51
    v_fma_f32 v162, -v55, v18, v162
    v_mul_f32 v162, -1.4426950408889634, v162
    v_exp_f32 v162, v162
    v_mul_f32 v226, v226, v51
    v_fma_f32 v226, -v55, v34, v226
    v_add_f32 v162, 1.0, v162
    v_rcp_f32 v162, v162
    s_nop 0
    v_mul_f32 v226, v226, v162
    v_mul_f32 v163, v163, v51
    v_fma_f32 v163, -v55, v19, v163
    v_mul_f32 v163, -1.4426950408889634, v163
    v_exp_f32 v163, v163
    v_mul_f32 v227, v227, v51
    v_fma_f32 v227, -v55, v35, v227
    v_add_f32 v163, 1.0, v163
    v_rcp_f32 v163, v163
    s_nop 0
    v_mul_f32 v227, v227, v163
    v_cvt_pk_bf16_f32 v56, v224, v225
    v_cvt_pk_bf16_f32 v57, v226, v227
    buffer_store_dwordx2 v[56:57], v5, s[56:59], s36 offen offset:0
    v_mul_f32 v164, v164, v51
    v_fma_f32 v164, -v55, v20, v164
    v_mul_f32 v164, -1.4426950408889634, v164
    v_exp_f32 v164, v164
    v_mul_f32 v228, v228, v51
    v_fma_f32 v228, -v55, v36, v228
    v_add_f32 v164, 1.0, v164
    v_rcp_f32 v164, v164
    s_nop 0
    v_mul_f32 v228, v228, v164
    v_mul_f32 v165, v165, v51
    v_fma_f32 v165, -v55, v21, v165
    v_mul_f32 v165, -1.4426950408889634, v165
    v_exp_f32 v165, v165
    v_mul_f32 v229, v229, v51
    v_fma_f32 v229, -v55, v37, v229
    v_add_f32 v165, 1.0, v165
    v_rcp_f32 v165, v165
    s_nop 0
    v_mul_f32 v229, v229, v165
    v_mul_f32 v166, v166, v51
    v_fma_f32 v166, -v55, v22, v166
    v_mul_f32 v166, -1.4426950408889634, v166
    v_exp_f32 v166, v166
    v_mul_f32 v230, v230, v51
    v_fma_f32 v230, -v55, v38, v230
    v_add_f32 v166, 1.0, v166
    v_rcp_f32 v166, v166
    s_nop 0
    v_mul_f32 v230, v230, v166
    v_mul_f32 v167, v167, v51
    v_fma_f32 v167, -v55, v23, v167
    v_mul_f32 v167, -1.4426950408889634, v167
    v_exp_f32 v167, v167
    v_mul_f32 v231, v231, v51
    v_fma_f32 v231, -v55, v39, v231
    v_add_f32 v167, 1.0, v167
    v_rcp_f32 v167, v167
    s_nop 0
    v_mul_f32 v231, v231, v167
    v_cvt_pk_bf16_f32 v56, v228, v229
    v_cvt_pk_bf16_f32 v57, v230, v231
    buffer_store_dwordx2 v[56:57], v5, s[56:59], s36 offen offset:512
    v_mul_f32 v168, v168, v51
    v_fma_f32 v168, -v55, v24, v168
    v_mul_f32 v168, -1.4426950408889634, v168
    v_exp_f32 v168, v168
    v_mul_f32 v232, v232, v51
    v_fma_f32 v232, -v55, v40, v232
    v_add_f32 v168, 1.0, v168
    v_rcp_f32 v168, v168
    s_nop 0
    v_mul_f32 v232, v232, v168
    v_mul_f32 v169, v169, v51
    v_fma_f32 v169, -v55, v25, v169
    v_mul_f32 v169, -1.4426950408889634, v169
    v_exp_f32 v169, v169
    v_mul_f32 v233, v233, v51
    v_fma_f32 v233, -v55, v41, v233
    v_add_f32 v169, 1.0, v169
    v_rcp_f32 v169, v169
    s_nop 0
    v_mul_f32 v233, v233, v169
    v_mul_f32 v170, v170, v51
    v_fma_f32 v170, -v55, v26, v170
    v_mul_f32 v170, -1.4426950408889634, v170
    v_exp_f32 v170, v170
    v_mul_f32 v234, v234, v51
    v_fma_f32 v234, -v55, v42, v234
    v_add_f32 v170, 1.0, v170
    v_rcp_f32 v170, v170
    s_nop 0
    v_mul_f32 v234, v234, v170
    v_mul_f32 v171, v171, v51
    v_fma_f32 v171, -v55, v27, v171
    v_mul_f32 v171, -1.4426950408889634, v171
    v_exp_f32 v171, v171
    v_mul_f32 v235, v235, v51
    v_fma_f32 v235, -v55, v43, v235
    v_add_f32 v171, 1.0, v171
    v_rcp_f32 v171, v171
    s_nop 0
    v_mul_f32 v235, v235, v171
    v_cvt_pk_bf16_f32 v56, v232, v233
    v_cvt_pk_bf16_f32 v57, v234, v235
    buffer_store_dwordx2 v[56:57], v5, s[56:59], s36 offen offset:1024
    v_mul_f32 v172, v172, v51
    v_fma_f32 v172, -v55, v28, v172
    v_mul_f32 v172, -1.4426950408889634, v172
    v_exp_f32 v172, v172
    v_mul_f32 v236, v236, v51
    v_fma_f32 v236, -v55, v44, v236
    v_add_f32 v172, 1.0, v172
    v_rcp_f32 v172, v172
    s_nop 0
    v_mul_f32 v236, v236, v172
    v_mul_f32 v173, v173, v51
    v_fma_f32 v173, -v55, v29, v173
    v_mul_f32 v173, -1.4426950408889634, v173
    v_exp_f32 v173, v173
    v_mul_f32 v237, v237, v51
    v_fma_f32 v237, -v55, v45, v237
    v_add_f32 v173, 1.0, v173
    v_rcp_f32 v173, v173
    s_nop 0
    v_mul_f32 v237, v237, v173
    v_mul_f32 v174, v174, v51
    v_fma_f32 v174, -v55, v30, v174
    v_mul_f32 v174, -1.4426950408889634, v174
    v_exp_f32 v174, v174
    v_mul_f32 v238, v238, v51
    v_fma_f32 v238, -v55, v46, v238
    v_add_f32 v174, 1.0, v174
    v_rcp_f32 v174, v174
    s_nop 0
    v_mul_f32 v238, v238, v174
    v_mul_f32 v175, v175, v51
    v_fma_f32 v175, -v55, v31, v175
    v_mul_f32 v175, -1.4426950408889634, v175
    v_exp_f32 v175, v175
    v_mul_f32 v239, v239, v51
    v_fma_f32 v239, -v55, v47, v239
    v_add_f32 v175, 1.0, v175
    v_rcp_f32 v175, v175
    s_nop 0
    v_mul_f32 v239, v239, v175
    v_cvt_pk_bf16_f32 v56, v236, v237
    v_cvt_pk_bf16_f32 v57, v238, v239
    buffer_store_dwordx2 v[56:57], v5, s[56:59], s36 offen offset:1536
    s_add_u32 s36, s36, 114688
    s_endpgm
.section .rodata,"a"
.p2align 6
.amdhsa_kernel k4b_kernel
  .amdhsa_next_free_vgpr 240
  .amdhsa_next_free_sgpr 64
  .amdhsa_accum_offset 240
  .amdhsa_group_segment_fixed_size 0
  .amdhsa_kernarg_size 80
  .amdhsa_user_sgpr_count 2
  .amdhsa_user_sgpr_kernarg_segment_ptr 1
  .amdhsa_system_sgpr_workgroup_id_x 1
.end_amdhsa_kernel
.text
.globl k5b_kernel
.p2align 8
.type k5b_kernel,@function
k5b_kernel:
    s_cmp_ge_u32 s2, 224
    s_cbranch_scc0 k5b_kernel_go1
    s_endpgm
k5b_kernel_go1:
    s_load_dwordx2 s[4:5], s[0:1], 72
    s_load_dwordx2 s[8:9], s[0:1], 56
    s_waitcnt lgkmcnt(0)
    s_add_u32 s12, s4, 23068672
    s_addc_u32 s13, s5, 0
    s_mov_b32 s14, 7340032
    s_mov_b32 s15, 0x00020000
    s_add_u32 s16, s4, 6291456
    s_addc_u32 s17, s5, 0
    s_mov_b32 s18, 1605632
    s_mov_b32 s19, 0x00020000
    s_add_u32 s20, s4, 20971520
    s_addc_u32 s21, s5, 0
    s_mov_b32 s22, 1835008
    s_mov_b32 s23, 0x00020000
    s_mov_b32 s24, s8
    s_mov_b32 s25, s9
    s_mov_b32 s26, 1835008
    s_mov_b32 s27, 0x00020000
    v_lshrrev_b32 v1, 6, v0
    s_nop 0
    v_readfirstlane_b32 s32, v1
    s_and_b32 s33, s2, 7
    s_lshl_b32 s33, s33, 2
    s_bfe_u32 s34, s2, 0x20003
    s_add_u32 s33, s33, s34
    s_lshr_b32 s34, s2, 5
    v_and_b32 v1, 63, v0
    v_lshlrev_b32 v2, 4, v1
    s_lshr_b32 s35, s32, 1
    s_and_b32 s36, s32, 1
    s_lshl_b32 s37, s33, 6
    s_lshl_b32 s38, s35, 5
    s_add_u32 s37, s37, s38
    v_and_b32 v3, 31, v1
    v_add_u32 v3, s37, v3
    v_mul_u32_u24 v4, 896, v3
    v_lshrrev_b32 v5, 5, v1
    v_lshl_add_u32 v4, v5, 3, v4
    s_lshl_b32 s38, s34, 7
    s_lshl_b32 s39, s36, 6
    s_add_u32 s38, s38, s39
    buffer_load_dwordx2 v[8:9], v4, s[20:23], s38 offen offset:0
    buffer_load_dwordx2 v[10:11], v4, s[20:23], s38 offen offset:16
    buffer_load_dwordx2 v[12:13], v4, s[20:23], s38 offen offset:32
    buffer_load_dwordx2 v[14:15], v4, s[20:23], s38 offen offset:48
    s_mul_i32 s40, s32, 28672
    s_mul_i32 s41, s33, 229376
    s_add_u32 s41, s41, s40
    s_add_u32 s42, s41, 114688
    s_mul_i32 s43, s34, 229376
    s_add_u32 s43, s43, s40
    s_add_u32 s44, s43, 114688
    buffer_load_dwordx4 v[80:83], v2, s[12:15], s41 offen offset:0
    buffer_load_dwordx4 v[84:87], v2, s[12:15], s42 offen offset:0
    buffer_load_dwordx4 v[88:91], v2, s[16:19], s43 offen offset:0
    buffer_load_dwordx4 v[92:95], v2, s[16:19], s44 offen offset:0
    buffer_load_dwordx4 v[96:99], v2, s[12:15], s41 offen offset:1024
    buffer_load_dwordx4 v[100:103], v2, s[12:15], s42 offen offset:1024
    buffer_load_dwordx4 v[104:107], v2, s[16:19], s43 offen offset:1024
    buffer_load_dwordx4 v[108:111], v2, s[16:19], s44 offen offset:1024
    buffer_load_dwordx4 v[112:115], v2, s[12:15], s41 offen offset:2048
    buffer_load_dwordx4 v[116:119], v2, s[12:15], s42 offen offset:2048
    buffer_load_dwordx4 v[120:123], v2, s[16:19], s43 offen offset:2048
    buffer_load_dwordx4 v[124:127], v2, s[16:19], s44 offen offset:2048
    buffer_load_dwordx4 v[128:131], v2, s[12:15], s41 offen offset:3072
    buffer_load_dwordx4 v[132:135], v2, s[12:15], s42 offen offset:3072
    buffer_load_dwordx4 v[136:139], v2, s[16:19], s43 offen offset:3072
    buffer_load_dwordx4 v[140:143], v2, s[16:19], s44 offen offset:3072
    s_add_u32 s41, s41, 4096
    s_add_u32 s42, s42, 4096
    s_add_u32 s43, s43, 4096
    s_add_u32 s44, s44, 4096
    buffer_load_dwordx4 v[144:147], v2, s[12:15], s41 offen offset:0
    buffer_load_dwordx4 v[148:151], v2, s[12:15], s42 offen offset:0
    buffer_load_dwordx4 v[152:155], v2, s[16:19], s43 offen offset:0
    buffer_load_dwordx4 v[156:159], v2, s[16:19], s44 offen offset:0
    buffer_load_dwordx4 v[160:163], v2, s[12:15], s41 offen offset:1024
    buffer_load_dwordx4 v[164:167], v2, s[12:15], s42 offen offset:1024
    buffer_load_dwordx4 v[168:171], v2, s[16:19], s43 offen offset:1024
    buffer_load_dwordx4 v[172:175], v2, s[16:19], s44 offen offset:1024
    buffer_load_dwordx4 v[176:179], v2, s[12:15], s41 offen offset:2048
    buffer_load_dwordx4 v[180:183], v2, s[12:15], s42 offen offset:2048
    buffer_load_dwordx4 v[184:187], v2, s[16:19], s43 offen offset:2048
    buffer_load_dwordx4 v[188:191], v2, s[16:19], s44 offen offset:2048
    buffer_load_dwordx4 v[192:195], v2, s[12:15], s41 offen offset:3072
    buffer_load_dwordx4 v[196:199], v2, s[12:15], s42 offen offset:3072
    buffer_load_dwordx4 v[200:203], v2, s[16:19], s43 offen offset:3072
    buffer_load_dwordx4 v[204:207], v2, s[16:19], s44 offen offset:3072
    s_add_u32 s41, s41, 4096
    s_add_u32 s42, s42, 4096
    s_add_u32 s43, s43, 4096
    s_add_u32 s44, s44, 4096
    s_waitcnt vmcnt(29)
    v_mfma_f32_32x32x16_bf16 v[16:31], v[88:91], v[80:83], 0
    s_waitcnt vmcnt(28)
    v_mfma_f32_32x32x16_bf16 v[32:47], v[92:95], v[80:83], 0
    v_mfma_f32_32x32x16_bf16 v[48:63], v[88:91], v[84:87], 0
    v_mfma_f32_32x32x16_bf16 v[64:79], v[92:95], v[84:87], 0
    s_waitcnt vmcnt(25)
    v_mfma_f32_32x32x16_bf16 v[16:31], v[104:107], v[96:99], v[16:31]
    s_waitcnt vmcnt(24)
    v_mfma_f32_32x32x16_bf16 v[32:47], v[108:111], v[96:99], v[32:47]
    v_mfma_f32_32x32x16_bf16 v[48:63], v[104:107], v[100:103], v[48:63]
    v_mfma_f32_32x32x16_bf16 v[64:79], v[108:111], v[100:103], v[64:79]
    s_waitcnt vmcnt(21)
    v_mfma_f32_32x32x16_bf16 v[16:31], v[120:123], v[112:115], v[16:31]
    s_waitcnt vmcnt(20)
    v_mfma_f32_32x32x16_bf16 v[32:47], v[124:127], v[112:115], v[32:47]
    v_mfma_f32_32x32x16_bf16 v[48:63], v[120:123], v[116:119], v[48:63]
    v_mfma_f32_32x32x16_bf16 v[64:79], v[124:127], v[116:119], v[64:79]
    s_waitcnt vmcnt(17)
    v_mfma_f32_32x32x16_bf16 v[16:31], v[136:139], v[128:131], v[16:31]
    s_waitcnt vmcnt(16)
    v_mfma_f32_32x32x16_bf16 v[32:47], v[140:143], v[128:131], v[32:47]
    v_mfma_f32_32x32x16_bf16 v[48:63], v[136:139], v[132:135], v[48:63]
    v_mfma_f32_32x32x16_bf16 v[64:79], v[140:143], v[132:135], v[64:79]
    buffer_load_dwordx4 v[80:83], v2, s[12:15], s41 offen offset:0
    buffer_load_dwordx4 v[84:87], v2, s[12:15], s42 offen offset:0
    buffer_load_dwordx4 v[88:91], v2, s[16:19], s43 offen offset:0
    buffer_load_dwordx4 v[92:95], v2, s[16:19], s44 offen offset:0
    buffer_load_dwordx4 v[96:99], v2, s[12:15], s41 offen offset:1024
    buffer_load_dwordx4 v[100:103], v2, s[12:15], s42 offen offset:1024
    buffer_load_dwordx4 v[104:107], v2, s[16:19], s43 offen offset:1024
    buffer_load_dwordx4 v[108:111], v2, s[16:19], s44 offen offset:1024
    buffer_load_dwordx4 v[112:115], v2, s[12:15], s41 offen offset:2048
    buffer_load_dwordx4 v[116:119], v2, s[12:15], s42 offen offset:2048
    buffer_load_dwordx4 v[120:123], v2, s[16:19], s43 offen offset:2048
    buffer_load_dwordx4 v[124:127], v2, s[16:19], s44 offen offset:2048
    buffer_load_dwordx4 v[128:131], v2, s[12:15], s41 offen offset:3072
    buffer_load_dwordx4 v[132:135], v2, s[12:15], s42 offen offset:3072
    buffer_load_dwordx4 v[136:139], v2, s[16:19], s43 offen offset:3072
    buffer_load_dwordx4 v[140:143], v2, s[16:19], s44 offen offset:3072
    s_add_u32 s41, s41, 4096
    s_add_u32 s42, s42, 4096
    s_add_u32 s43, s43, 4096
    s_add_u32 s44, s44, 4096
    s_waitcnt vmcnt(29)
    v_mfma_f32_32x32x16_bf16 v[16:31], v[152:155], v[144:147], v[16:31]
    s_waitcnt vmcnt(28)
    v_mfma_f32_32x32x16_bf16 v[32:47], v[156:159], v[144:147], v[32:47]
    v_mfma_f32_32x32x16_bf16 v[48:63], v[152:155], v[148:151], v[48:63]
    v_mfma_f32_32x32x16_bf16 v[64:79], v[156:159], v[148:151], v[64:79]
    s_waitcnt vmcnt(25)
    v_mfma_f32_32x32x16_bf16 v[16:31], v[168:171], v[160:163], v[16:31]
    s_waitcnt vmcnt(24)
    v_mfma_f32_32x32x16_bf16 v[32:47], v[172:175], v[160:163], v[32:47]
    v_mfma_f32_32x32x16_bf16 v[48:63], v[168:171], v[164:167], v[48:63]
    v_mfma_f32_32x32x16_bf16 v[64:79], v[172:175], v[164:167], v[64:79]
    s_waitcnt vmcnt(21)
    v_mfma_f32_32x32x16_bf16 v[16:31], v[184:187], v[176:179], v[16:31]
    s_waitcnt vmcnt(20)
    v_mfma_f32_32x32x16_bf16 v[32:47], v[188:191], v[176:179], v[32:47]
    v_mfma_f32_32x32x16_bf16 v[48:63], v[184:187], v[180:183], v[48:63]
    v_mfma_f32_32x32x16_bf16 v[64:79], v[188:191], v[180:183], v[64:79]
    s_waitcnt vmcnt(17)
    v_mfma_f32_32x32x16_bf16 v[16:31], v[200:203], v[192:195], v[16:31]
    s_waitcnt vmcnt(16)
    v_mfma_f32_32x32x16_bf16 v[32:47], v[204:207], v[192:195], v[32:47]
    v_mfma_f32_32x32x16_bf16 v[48:63], v[200:203], v[196:199], v[48:63]
    v_mfma_f32_32x32x16_bf16 v[64:79], v[204:207], v[196:199], v[64:79]
    buffer_load_dwordx4 v[144:147], v2, s[12:15], s41 offen offset:0
    buffer_load_dwordx4 v[148:151], v2, s[12:15], s42 offen offset:0
    buffer_load_dwordx4 v[152:155], v2, s[16:19], s43 offen offset:0
    buffer_load_dwordx4 v[156:159], v2, s[16:19], s44 offen offset:0
    buffer_load_dwordx4 v[160:163], v2, s[12:15], s41 offen offset:1024
    buffer_load_dwordx4 v[164:167], v2, s[12:15], s42 offen offset:1024
    buffer_load_dwordx4 v[168:171], v2, s[16:19], s43 offen offset:1024
    buffer_load_dwordx4 v[172:175], v2, s[16:19], s44 offen offset:1024
    buffer_load_dwordx4 v[176:179], v2, s[12:15], s41 offen offset:2048
    buffer_load_dwordx4 v[180:183], v2, s[12:15], s42 offen offset:2048
    buffer_load_dwordx4 v[184:187], v2, s[16:19], s43 offen offset:2048
    buffer_load_dwordx4 v[188:191], v2, s[16:19], s44 offen offset:2048
    buffer_load_dwordx4 v[192:195], v2, s[12:15], s41 offen offset:3072
    buffer_load_dwordx4 v[196:199], v2, s[12:15], s42 offen offset:3072
    buffer_load_dwordx4 v[200:203], v2, s[16:19], s43 offen offset:3072
    buffer_load_dwordx4 v[204:207], v2, s[16:19], s44 offen offset:3072
    s_add_u32 s41, s41, 4096
    s_add_u32 s42, s42, 4096
    s_add_u32 s43, s43, 4096
    s_add_u32 s44, s44, 4096
    s_waitcnt vmcnt(29)
    v_mfma_f32_32x32x16_bf16 v[16:31], v[88:91], v[80:83], v[16:31]
    s_waitcnt vmcnt(28)
    v_mfma_f32_32x32x16_bf16 v[32:47], v[92:95], v[80:83], v[32:47]
    v_mfma_f32_32x32x16_bf16 v[48:63], v[88:91], v[84:87], v[48:63]
    v_mfma_f32_32x32x16_bf16 v[64:79], v[92:95], v[84:87], v[64:79]
    s_waitcnt vmcnt(25)
    v_mfma_f32_32x32x16_bf16 v[16:31], v[104:107], v[96:99], v[16:31]
    s_waitcnt vmcnt(24)
    v_mfma_f32_32x32x16_bf16 v[32:47], v[108:111], v[96:99], v[32:47]
    v_mfma_f32_32x32x16_bf16 v[48:63], v[104:107], v[100:103], v[48:63]
    v_mfma_f32_32x32x16_bf16 v[64:79], v[108:111], v[100:103], v[64:79]
    s_waitcnt vmcnt(21)
    v_mfma_f32_32x32x16_bf16 v[16:31], v[120:123], v[112:115], v[16:31]
    s_waitcnt vmcnt(20)
    v_mfma_f32_32x32x16_bf16 v[32:47], v[124:127], v[112:115], v[32:47]
    v_mfma_f32_32x32x16_bf16 v[48:63], v[120:123], v[116:119], v[48:63]
    v_mfma_f32_32x32x16_bf16 v[64:79], v[124:127], v[116:119], v[64:79]
    s_waitcnt vmcnt(17)
    v_mfma_f32_32x32x16_bf16 v[16:31], v[136:139], v[128:131], v[16:31]
    s_waitcnt vmcnt(16)
    v_mfma_f32_32x32x16_bf16 v[32:47], v[140:143], v[128:131], v[32:47]
    v_mfma_f32_32x32x16_bf16 v[48:63], v[136:139], v[132:135], v[48:63]
    v_mfma_f32_32x32x16_bf16 v[64:79], v[140:143], v[132:135], v[64:79]
    buffer_load_dwordx4 v[80:83], v2, s[12:15], s41 offen offset:0
    buffer_load_dwordx4 v[84:87], v2, s[12:15], s42 offen offset:0
    buffer_load_dwordx4 v[88:91], v2, s[16:19], s43 offen offset:0
    buffer_load_dwordx4 v[92:95], v2, s[16:19], s44 offen offset:0
    buffer_load_dwordx4 v[96:99], v2, s[12:15], s41 offen offset:1024
    buffer_load_dwordx4 v[100:103], v2, s[12:15], s42 offen offset:1024
    buffer_load_dwordx4 v[104:107], v2, s[16:19], s43 offen offset:1024
    buffer_load_dwordx4 v[108:111], v2, s[16:19], s44 offen offset:1024
    buffer_load_dwordx4 v[112:115], v2, s[12:15], s41 offen offset:2048
    buffer_load_dwordx4 v[116:119], v2, s[12:15], s42 offen offset:2048
    buffer_load_dwordx4 v[120:123], v2, s[16:19], s43 offen offset:2048
    buffer_load_dwordx4 v[124:127], v2, s[16:19], s44 offen offset:2048
    buffer_load_dwordx4 v[128:131], v2, s[12:15], s41 offen offset:3072
    buffer_load_dwordx4 v[132:135], v2, s[12:15], s42 offen offset:3072
    buffer_load_dwordx4 v[136:139], v2, s[16:19], s43 offen offset:3072
    buffer_load_dwordx4 v[140:143], v2, s[16:19], s44 offen offset:3072
    s_add_u32 s41, s41, 4096
    s_add_u32 s42, s42, 4096
    s_add_u32 s43, s43, 4096
    s_add_u32 s44, s44, 4096
    s_waitcnt vmcnt(29)
    v_mfma_f32_32x32x16_bf16 v[16:31], v[152:155], v[144:147], v[16:31]
    s_waitcnt vmcnt(28)
    v_mfma_f32_32x32x16_bf16 v[32:47], v[156:159], v[144:147], v[32:47]
    v_mfma_f32_32x32x16_bf16 v[48:63], v[152:155], v[148:151], v[48:63]
    v_mfma_f32_32x32x16_bf16 v[64:79], v[156:159], v[148:151], v[64:79]
    s_waitcnt vmcnt(25)
    v_mfma_f32_32x32x16_bf16 v[16:31], v[168:171], v[160:163], v[16:31]
    s_waitcnt vmcnt(24)
    v_mfma_f32_32x32x16_bf16 v[32:47], v[172:175], v[160:163], v[32:47]
    v_mfma_f32_32x32x16_bf16 v[48:63], v[168:171], v[164:167], v[48:63]
    v_mfma_f32_32x32x16_bf16 v[64:79], v[172:175], v[164:167], v[64:79]
    s_waitcnt vmcnt(21)
    v_mfma_f32_32x32x16_bf16 v[16:31], v[184:187], v[176:179], v[16:31]
    s_waitcnt vmcnt(20)
    v_mfma_f32_32x32x16_bf16 v[32:47], v[188:191], v[176:179], v[32:47]
    v_mfma_f32_32x32x16_bf16 v[48:63], v[184:187], v[180:183], v[48:63]
    v_mfma_f32_32x32x16_bf16 v[64:79], v[188:191], v[180:183], v[64:79]
    s_waitcnt vmcnt(17)
    v_mfma_f32_32x32x16_bf16 v[16:31], v[200:203], v[192:195], v[16:31]
    s_waitcnt vmcnt(16)
    v_mfma_f32_32x32x16_bf16 v[32:47], v[204:207], v[192:195], v[32:47]
    v_mfma_f32_32x32x16_bf16 v[48:63], v[200:203], v[196:199], v[48:63]
    v_mfma_f32_32x32x16_bf16 v[64:79], v[204:207], v[196:199], v[64:79]
    buffer_load_dwordx4 v[144:147], v2, s[12:15], s41 offen offset:0
    buffer_load_dwordx4 v[148:151], v2, s[12:15], s42 offen offset:0
    buffer_load_dwordx4 v[152:155], v2, s[16:19], s43 offen offset:0
    buffer_load_dwordx4 v[156:159], v2, s[16:19], s44 offen offset:0
    buffer_load_dwordx4 v[160:163], v2, s[12:15], s41 offen offset:1024
    buffer_load_dwordx4 v[164:167], v2, s[12:15], s42 offen offset:1024
    buffer_load_dwordx4 v[168:171], v2, s[16:19], s43 offen offset:1024
    buffer_load_dwordx4 v[172:175], v2, s[16:19], s44 offen offset:1024
    buffer_load_dwordx4 v[176:179], v2, s[12:15], s41 offen offset:2048
    buffer_load_dwordx4 v[180:183], v2, s[12:15], s42 offen offset:2048
    buffer_load_dwordx4 v[184:187], v2, s[16:19], s43 offen offset:2048
    buffer_load_dwordx4 v[188:191], v2, s[16:19], s44 offen offset:2048
    buffer_load_dwordx4 v[192:195], v2, s[12:15], s41 offen offset:3072
    buffer_load_dwordx4 v[196:199], v2, s[12:15], s42 offen offset:3072
    buffer_load_dwordx4 v[200:203], v2, s[16:19], s43 offen offset:3072
    buffer_load_dwordx4 v[204:207], v2, s[16:19], s44 offen offset:3072
    s_add_u32 s41, s41, 4096
    s_add_u32 s42, s42, 4096
    s_add_u32 s43, s43, 4096
    s_add_u32 s44, s44, 4096
    s_waitcnt vmcnt(29)
    v_mfma_f32_32x32x16_bf16 v[16:31], v[88:91], v[80:83], v[16:31]
    s_waitcnt vmcnt(28)
    v_mfma_f32_32x32x16_bf16 v[32:47], v[92:95], v[80:83], v[32:47]
    v_mfma_f32_32x32x16_bf16 v[48:63], v[88:91], v[84:87], v[48:63]
    v_mfma_f32_32x32x16_bf16 v[64:79], v[92:95], v[84:87], v[64:79]
    s_waitcnt vmcnt(25)
    v_mfma_f32_32x32x16_bf16 v[16:31], v[104:107], v[96:99], v[16:31]
    s_waitcnt vmcnt(24)
    v_mfma_f32_32x32x16_bf16 v[32:47], v[108:111], v[96:99], v[32:47]
    v_mfma_f32_32x32x16_bf16 v[48:63], v[104:107], v[100:103], v[48:63]
    v_mfma_f32_32x32x16_bf16 v[64:79], v[108:111], v[100:103], v[64:79]
    s_waitcnt vmcnt(21)
    v_mfma_f32_32x32x16_bf16 v[16:31], v[120:123], v[112:115], v[16:31]
    s_waitcnt vmcnt(20)
    v_mfma_f32_32x32x16_bf16 v[32:47], v[124:127], v[112:115], v[32:47]
    v_mfma_f32_32x32x16_bf16 v[48:63], v[120:123], v[116:119], v[48:63]
    v_mfma_f32_32x32x16_bf16 v[64:79], v[124:127], v[116:119], v[64:79]
    s_waitcnt vmcnt(17)
    v_mfma_f32_32x32x16_bf16 v[16:31], v[136:139], v[128:131], v[16:31]
    s_waitcnt vmcnt(16)
    v_mfma_f32_32x32x16_bf16 v[32:47], v[140:143], v[128:131], v[32:47]
    v_mfma_f32_32x32x16_bf16 v[48:63], v[136:139], v[132:135], v[48:63]
    v_mfma_f32_32x32x16_bf16 v[64:79], v[140:143], v[132:135], v[64:79]
    buffer_load_dwordx4 v[80:83], v2, s[12:15], s41 offen offset:0
    buffer_load_dwordx4 v[84:87], v2, s[12:15], s42 offen offset:0
    buffer_load_dwordx4 v[88:91], v2, s[16:19], s43 offen offset:0
    buffer_load_dwordx4 v[92:95], v2, s[16:19], s44 offen offset:0
    buffer_load_dwordx4 v[96:99], v2, s[12:15], s41 offen offset:1024
    buffer_load_dwordx4 v[100:103], v2, s[12:15], s42 offen offset:1024
    buffer_load_dwordx4 v[104:107], v2, s[16:19], s43 offen offset:1024
    buffer_load_dwordx4 v[108:111], v2, s[16:19], s44 offen offset:1024
    buffer_load_dwordx4 v[112:115], v2, s[12:15], s41 offen offset:2048
    buffer_load_dwordx4 v[116:119], v2, s[12:15], s42 offen offset:2048
    buffer_load_dwordx4 v[120:123], v2, s[16:19], s43 offen offset:2048
    buffer_load_dwordx4 v[124:127], v2, s[16:19], s44 offen offset:2048
    buffer_load_dwordx4 v[128:131], v2, s[12:15], s41 offen offset:3072
    buffer_load_dwordx4 v[132:135], v2, s[12:15], s42 offen offset:3072
    buffer_load_dwordx4 v[136:139], v2, s[16:19], s43 offen offset:3072
    buffer_load_dwordx4 v[140:143], v2, s[16:19], s44 offen offset:3072
    s_add_u32 s41, s41, 4096
    s_add_u32 s42, s42, 4096
    s_add_u32 s43, s43, 4096
    s_add_u32 s44, s44, 4096
    s_waitcnt vmcnt(29)
    v_mfma_f32_32x32x16_bf16 v[16:31], v[152:155], v[144:147], v[16:31]
    s_waitcnt vmcnt(28)
    v_mfma_f32_32x32x16_bf16 v[32:47], v[156:159], v[144:147], v[32:47]
    v_mfma_f32_32x32x16_bf16 v[48:63], v[152:155], v[148:151], v[48:63]
    v_mfma_f32_32x32x16_bf16 v[64:79], v[156:159], v[148:151], v[64:79]
    s_waitcnt vmcnt(25)
    v_mfma_f32_32x32x16_bf16 v[16:31], v[168:171], v[160:163], v[16:31]
    s_waitcnt vmcnt(24)
    v_mfma_f32_32x32x16_bf16 v[32:47], v[172:175], v[160:163], v[32:47]
    v_mfma_f32_32x32x16_bf16 v[48:63], v[168:171], v[164:167], v[48:63]
    v_mfma_f32_32x32x16_bf16 v[64:79], v[172:175], v[164:167], v[64:79]
    s_waitcnt vmcnt(21)
    v_mfma_f32_32x32x16_bf16 v[16:31], v[184:187], v[176:179], v[16:31]
    s_waitcnt vmcnt(20)
    v_mfma_f32_32x32x16_bf16 v[32:47], v[188:191], v[176:179], v[32:47]
    v_mfma_f32_32x32x16_bf16 v[48:63], v[184:187], v[180:183], v[48:63]
    v_mfma_f32_32x32x16_bf16 v[64:79], v[188:191], v[180:183], v[64:79]
    s_waitcnt vmcnt(17)
    v_mfma_f32_32x32x16_bf16 v[16:31], v[200:203], v[192:195], v[16:31]
    s_waitcnt vmcnt(16)
    v_mfma_f32_32x32x16_bf16 v[32:47], v[204:207], v[192:195], v[32:47]
    v_mfma_f32_32x32x16_bf16 v[48:63], v[200:203], v[196:199], v[48:63]
    v_mfma_f32_32x32x16_bf16 v[64:79], v[204:207], v[196:199], v[64:79]
    s_waitcnt vmcnt(13)
    v_mfma_f32_32x32x16_bf16 v[16:31], v[88:91], v[80:83], v[16:31]
    s_waitcnt vmcnt(12)
    v_mfma_f32_32x32x16_bf16 v[32:47], v[92:95], v[80:83], v[32:47]
    v_mfma_f32_32x32x16_bf16 v[48:63], v[88:91], v[84:87], v[48:63]
    v_mfma_f32_32x32x16_bf16 v[64:79], v[92:95], v[84:87], v[64:79]
    s_waitcnt vmcnt(9)
    v_mfma_f32_32x32x16_bf16 v[16:31], v[104:107], v[96:99], v[16:31]
    s_waitcnt vmcnt(8)
    v_mfma_f32_32x32x16_bf16 v[32:47], v[108:111], v[96:99], v[32:47]
    v_mfma_f32_32x32x16_bf16 v[48:63], v[104:107], v[100:103], v[48:63]
    v_mfma_f32_32x32x16_bf16 v[64:79], v[108:111], v[100:103], v[64:79]
    s_waitcnt vmcnt(5)
    v_mfma_f32_32x32x16_bf16 v[16:31], v[120:123], v[112:115], v[16:31]
    s_waitcnt vmcnt(4)
    v_mfma_f32_32x32x16_bf16 v[32:47], v[124:127], v[112:115], v[32:47]
    v_mfma_f32_32x32x16_bf16 v[48:63], v[120:123], v[116:119], v[48:63]
    v_mfma_f32_32x32x16_bf16 v[64:79], v[124:127], v[116:119], v[64:79]
    s_waitcnt vmcnt(1)
    v_mfma_f32_32x32x16_bf16 v[16:31], v[136:139], v[128:131], v[16:31]
    s_waitcnt vmcnt(0)
    v_mfma_f32_32x32x16_bf16 v[32:47], v[140:143], v[128:131], v[32:47]
    v_mfma_f32_32x32x16_bf16 v[48:63], v[136:139], v[132:135], v[48:63]
    v_mfma_f32_32x32x16_bf16 v[64:79], v[140:143], v[132:135], v[64:79]
    s_lshl_b32 s40, s32, 14
    v_add_u32 v5, s40, v2
    s_nop 5
    ds_write_b128 v5, v[16:19] offset:0
    ds_write_b128 v5, v[20:23] offset:1024
    ds_write_b128 v5, v[24:27] offset:2048
    ds_write_b128 v5, v[28:31] offset:3072
    ds_write_b128 v5, v[32:35] offset:4096
    ds_write_b128 v5, v[36:39] offset:5120
    ds_write_b128 v5, v[40:43] offset:6144
    ds_write_b128 v5, v[44:47] offset:7168
    ds_write_b128 v5, v[48:51] offset:8192
    ds_write_b128 v5, v[52:55] offset:9216
    ds_write_b128 v5, v[56:59] offset:10240
    ds_write_b128 v5, v[60:63] offset:11264
    ds_write_b128 v5, v[64:67] offset:12288
    ds_write_b128 v5, v[68:71] offset:13312
    ds_write_b128 v5, v[72:75] offset:14336
    ds_write_b128 v5, v[76:79] offset:15360
    s_waitcnt lgkmcnt(0)
    s_barrier
    s_lshl_b32 s40, s32, 12
    v_add_u32 v5, s40, v2
    ds_read_b128 v[80:83], v5 offset:0
    ds_read_b128 v[84:87], v5 offset:1024
    ds_read_b128 v[88:91], v5 offset:2048
    ds_read_b128 v[92:95], v5 offset:3072
    ds_read_b128 v[96:99], v5 offset:16384
    ds_read_b128 v[100:103], v5 offset:17408
    ds_read_b128 v[104:107], v5 offset:18432
    ds_read_b128 v[108:111], v5 offset:19456
    ds_read_b128 v[112:115], v5 offset:32768
    ds_read_b128 v[116:119], v5 offset:33792
    ds_read_b128 v[120:123], v5 offset:34816
    ds_read_b128 v[124:127], v5 offset:35840
    ds_read_b128 v[128:131], v5 offset:49152
    ds_read_b128 v[132:135], v5 offset:50176
    ds_read_b128 v[136:139], v5 offset:51200
    ds_read_b128 v[140:143], v5 offset:52224
    s_waitcnt lgkmcnt(11)
    v_add_f32 v80, v80, v96
    s_waitcnt lgkmcnt(3)
    v_add_f32 v112, v112, v128
    v_add_f32 v80, v80, v112
    v_add_f32 v81, v81, v97
    v_add_f32 v113, v113, v129
    v_add_f32 v81, v81, v113
    v_add_f32 v82, v82, v98
    v_add_f32 v114, v114, v130
    v_add_f32 v82, v82, v114
    v_add_f32 v83, v83, v99
    v_add_f32 v115, v115, v131
    v_add_f32 v83, v83, v115
    v_add_f32 v84, v84, v100
    s_waitcnt lgkmcnt(2)
    v_add_f32 v116, v116, v132
    v_add_f32 v84, v84, v116
    v_add_f32 v85, v85, v101
    v_add_f32 v117, v117, v133
    v_add_f32 v85, v85, v117
    v_add_f32 v86, v86, v102
    v_add_f32 v118, v118, v134
    v_add_f32 v86, v86, v118
    v_add_f32 v87, v87, v103
    v_add_f32 v119, v119, v135
    v_add_f32 v87, v87, v119
    v_add_f32 v88, v88, v104
    s_waitcnt lgkmcnt(1)
    v_add_f32 v120, v120, v136
    v_add_f32 v88, v88, v120
    v_add_f32 v89, v89, v105
    v_add_f32 v121, v121, v137
    v_add_f32 v89, v89, v121
    v_add_f32 v90, v90, v106
    v_add_f32 v122, v122, v138
    v_add_f32 v90, v90, v122
    v_add_f32 v91, v91, v107
    v_add_f32 v123, v123, v139
    v_add_f32 v91, v91, v123
    v_add_f32 v92, v92, v108
    s_waitcnt lgkmcnt(0)
    v_add_f32 v124, v124, v140
    v_add_f32 v92, v92, v124
    v_add_f32 v93, v93, v109
    v_add_f32 v125, v125, v141
    v_add_f32 v93, v93, v125
    v_add_f32 v94, v94, v110
    v_add_f32 v126, v126, v142
    v_add_f32 v94, v94, v126
    v_add_f32 v95, v95, v111
    v_add_f32 v127, v127, v143
    v_add_f32 v95, v95, v127
    v_mov_b32 v20, 0xffff0000
    v_lshlrev_b32 v16, 16, v8
    v_and_b32 v17, v20, v8
    v_add_f32 v80, v80, v16
    v_add_f32 v81, v81, v17
    v_cvt_pk_bf16_f32 v18, v80, v81
    v_lshlrev_b32 v16, 16, v9
    v_and_b32 v17, v20, v9
    v_add_f32 v82, v82, v16
    v_add_f32 v83, v83, v17
    v_cvt_pk_bf16_f32 v19, v82, v83
    buffer_store_dwordx2 v[18:19], v4, s[24:27], s38 offen offset:0
    v_lshlrev_b32 v16, 16, v10
    v_and_b32 v17, v20, v10
    v_add_f32 v84, v84, v16
    v_add_f32 v85, v85, v17
    v_cvt_pk_bf16_f32 v18, v84, v85
    v_lshlrev_b32 v16, 16, v11
    v_and_b32 v17, v20, v11
    v_add_f32 v86, v86, v16
    v_add_f32 v87, v87, v17
    v_cvt_pk_bf16_f32 v19, v86, v87
    buffer_store_dwordx2 v[18:19], v4, s[24:27], s38 offen offset:16
    v_lshlrev_b32 v16, 16, v12
    v_and_b32 v17, v20, v12
    v_add_f32 v88, v88, v16
    v_add_f32 v89, v89, v17
    v_cvt_pk_bf16_f32 v18, v88, v89
    v_lshlrev_b32 v16, 16, v13
    v_and_b32 v17, v20, v13
    v_add_f32 v90, v90, v16
    v_add_f32 v91, v91, v17
    v_cvt_pk_bf16_f32 v19, v90, v91
    buffer_store_dwordx2 v[18:19], v4, s[24:27], s38 offen offset:32
    v_lshlrev_b32 v16, 16, v14
    v_and_b32 v17, v20, v14
    v_add_f32 v92, v92, v16
    v_add_f32 v93, v93, v17
    v_cvt_pk_bf16_f32 v18, v92, v93
    v_lshlrev_b32 v16, 16, v15
    v_and_b32 v17, v20, v15
    v_add_f32 v94, v94, v16
    v_add_f32 v95, v95, v17
    v_cvt_pk_bf16_f32 v19, v94, v95
    buffer_store_dwordx2 v[18:19], v4, s[24:27], s38 offen offset:48
    s_endpgm
.section .rodata,"a"
.p2align 6
.amdhsa_kernel k5b_kernel
  .amdhsa_next_free_vgpr 208
  .amdhsa_next_free_sgpr 64
  .amdhsa_accum_offset 208
  .amdhsa_group_segment_fixed_size 0
  .amdhsa_kernarg_size 80
  .amdhsa_user_sgpr_count 2
  .amdhsa_user_sgpr_kernarg_segment_ptr 1
  .amdhsa_system_sgpr_workgroup_id_x 1
.end_amdhsa_kernel
```
